```python
import torch

def _softmax(x, axis=-1):
    return torch.softmax(x, dim=axis)
def _gelu(x):
    return torch.nn.functional.gelu(x, approximate="tanh")
def _silu(x):
    return torch.nn.functional.silu(x)
def _sigmoid(x):
    return torch.sigmoid(x)
def _layernorm(x, axis=-1, eps=1e-5):
    m = x.mean(dim=axis, keepdim=True)
    v = x.var(dim=axis, keepdim=True, unbiased=False)
    return (x - m) / torch.sqrt(v + eps)
def _scatter_add(tgt, idx, src, axis=0):
    return tgt.clone().index_add_(axis, idx, src)
def _segment_sum(src, seg, n):
    out = torch.zeros((n,) + src.shape[1:], dtype=src.dtype)
    return out.index_add_(0, seg, src)
def _pad(x, pw):
    flat = tuple(v for pair in reversed(pw) for v in pair)
    return torch.nn.functional.pad(x, flat)

kernel_name = 'concat_heads__linear_kernel_hedgehog__linear_attn_block__prompt'

def setup_inputs():

    _w = (lambda a: (lambda t: t.to(torch.bfloat16) if t.is_floating_point() else t)(torch.as_tensor(a)))
    def _A_setup():
        B, S, D, H = 1, 2048, 640, 32
        Dh = D // H
        return {
            "x": _w((lambda *s: torch.randn(*s, dtype=torch.bfloat16) * 0.4)(B, S, D)),
            "wqkv": _w((lambda *s: torch.randn(*s, dtype=torch.bfloat16) * 0.4)(D, 3 * D)),
            "w_phi": _w((lambda *s: torch.randn(*s, dtype=torch.bfloat16) * 0.4)(H, Dh, Dh) * (Dh ** -0.5)),
            "wo": _w((lambda *s: torch.randn(*s, dtype=torch.bfloat16) * 0.05)(D, D)),
        }
    _A_in = _A_setup()

    def _B_setup():
        B, S, D = 1, 2048, 640
        return {
            "x": _w((lambda *s: torch.randn(*s, dtype=torch.bfloat16) * 0.05)(B, S, D)),
            "wqkv": _w((lambda *s: torch.randn(*s, dtype=torch.bfloat16) * 0.8)(D, 3 * D)),
            "wo": _w((lambda *s: torch.randn(*s, dtype=torch.bfloat16) * 0.4)(D, D)),
        }
    _B_in = _B_setup()

    return {
        "A_x": _A_in["x"],
        "A_wqkv": _A_in["wqkv"],
        "A_w_phi": _A_in["w_phi"],
        "A_wo": _A_in["wo"],
        "B_x": _B_in["x"],
        "B_wqkv": _B_in["wqkv"],
        "B_wo": _B_in["wo"],
    }

def reference(A_x, A_wqkv, A_w_phi, A_wo, B_x, B_wqkv, B_wo):
    def _A_ref(x, wqkv, w_phi, wo):
        B, S, D = x.shape
        H = 32; Dh = D // H
        qkv = (lambda x, *d: x.permute(*d))((x @ wqkv).reshape(B, S, 3, H, Dh), 2, 0, 3, 1, 4)
        q, k, v = qkv[0], qkv[1], qkv[2]
        pq = torch.einsum("bhsd,hdf->bhsf", q, w_phi)
        pk = torch.einsum("bhsd,hdf->bhsf", k, w_phi)
        phi_q = torch.concatenate([_softmax(pq, axis=-1), _softmax(-pq, axis=-1)], axis=-1)
        phi_k = torch.concatenate([_softmax(pk, axis=-1), _softmax(-pk, axis=-1)], axis=-1)
        kv = torch.einsum("bhsf,bhsd->bhfd", phi_k, v)
        z  = torch.einsum("bhsf->bhf", phi_k)
        num = torch.einsum("bhqf,bhfd->bhqd", phi_q, kv)
        den = torch.einsum("bhqf,bhf->bhq", phi_q, z)[..., None] + 1e-6
        o = num / den
        return (lambda x, *d: x.permute(*d))(o, 0, 2, 1, 3).reshape(B, S, D) @ wo

    def _B_ref(x, wqkv, wo):
        B, S, D = x.shape
        H = 32; Dh = D // H
        qkv = (lambda x, *d: x.permute(*d))((x @ wqkv).reshape(B, S, 3, H, Dh), 2, 0, 3, 1, 4)
        q, k, v = qkv[0], qkv[1], qkv[2]
        phi = lambda t: torch.where(t > 0, t + 1, torch.exp(t)) + 1e-6
        pq, pk = phi(q), phi(k)
        kv = torch.einsum("bhsd,bhse->bhde", pk, v)
        z = torch.einsum("bhsd->bhd", pk)
        num = torch.einsum("bhqd,bhde->bhqe", pq, kv)
        den = torch.einsum("bhqd,bhd->bhq", pq, z)[..., None] + 1e-6
        o = num / den
        return (lambda x, *d: x.permute(*d))(o, 0, 2, 1, 3).reshape(B, S, D) @ wo

    a = _A_ref(A_x, A_wqkv, A_w_phi, A_wo)
    b = _B_ref(B_x, B_wqkv, B_wo)
    return torch.concatenate([a, b], axis=-1)
```

```asm
; @launch grid=(256,1,1) block=(512,1,1) lds=163840
.amdgcn_target "amdgcn-amd-amdhsa--gfx950"
.text
.p2align 12
.globl concat_heads__linear_kernel_hedgehog__linear_attn_block__prompt_kernel
.p2align 8
.type concat_heads__linear_kernel_hedgehog__linear_attn_block__prompt_kernel,@function
concat_heads__linear_kernel_hedgehog__linear_attn_block__prompt_kernel:
    s_cmp_ge_u32 s2, 256
    s_cbranch_scc1 L_end
    s_load_dwordx16 s[4:19], s[0:1], 0
    s_load_dwordx4 s[20:23], s[0:1], 64
    s_and_b32 s3, s2, 1
    s_bfe_u32 s56, s2, 0x20001
    s_lshl2_add_u32 s3, s3, s56
    s_andn2_b32 s2, s2, 7
    s_or_b32 s2, s2, s3
    v_lshrrev_b32 v2, 6, v0
    v_and_b32 v1, 63, v0
    v_readfirstlane_b32 s51, v2
    s_bfe_u32 s48, s2, 0x10002
    s_and_b32 s56, s2, 3
    s_bfe_u32 s52, s2, 0x20003
    s_lshl2_add_u32 s49, s56, s52
    s_lshr_b32 s50, s2, 5
    s_add_u32 s57, s52, s50
    s_and_b32 s73, s57, 3
    s_lshl_b32 s56, s56, 3
    s_lshr_b32 s56, 0x7050200, s56
    s_and_b32 s56, s56, 15
    s_mul_i32 s67, s56, 0x01010101
    s_mov_b32 s70, 0x2030100
    s_cmp_eq_u32 s73, 1
    s_cselect_b32 s70, 0x4000201, s70
    s_cmp_eq_u32 s73, 2
    s_cselect_b32 s70, 0x3010002, s70
    s_cmp_eq_u32 s73, 3
    s_cselect_b32 s70, 0x3020100, s70
    s_add_u32 s70, s70, s67
    s_add_u32 s57, s70, 0x76767676
    s_lshr_b32 s57, s57, 7
    s_and_b32 s57, s57, 0x01010101
    s_mul_i32 s57, s57, 10
    s_sub_u32 s70, s70, s57
    s_mov_b32 s27, 0x20000
    s_cmp_lt_u32 s51, 4
    s_cbranch_scc1 L_proa
    s_and_b32 s51, s51, 3
    s_getpc_b64 s[40:41]
L_pc:
    s_mov_b32 s42, CODE_BYTES
    s_mov_b32 s43, 0x20000
    s_lshr_b32 s56, s2, 3
    s_lshl2_add_u32 s56, s56, s51
    s_lshl_b32 s56, s56, 9
    v_lshlrev_b32 v72, 7, v1
    s_mov_b64 exec, 15
    buffer_load_dword v76, v72, s[40:43], s56 offen
    s_mov_b64 exec, -1
    v_lshrrev_b32 v72, 3, v1
    v_lshrrev_b32 v73, 4, v1
    v_and_b32 v74, 7, v1
    v_mul_u32_u24 v72, 1280, v72
    v_xor_b32 v74, v74, v73
    v_lshl_add_u32 v18, v74, 4, v72
    v_xor_b32 v72, 64, v18
    v_add_u32 v19, 9216, v72
    v_add_u32 v20, 18432, v18
    v_add_u32 v21, 27648, v72
    s_lshl2_add_u32 s56, s49, s51
    s_mul_i32 s53, s56, 40960
    s_mul_i32 s55, s51, 9216
    s_mov_b32 s26, 2621440
    s_cmp_eq_u32 s48, 0
    s_waitcnt lgkmcnt(0)
    s_cselect_b32 s24, s4, s12
    s_cselect_b32 s25, s5, s13
    s_bfe_u32 s56, s70, 0x40000
    s_add_u32 m0, s55, 0
    s_lshl_b32 s56, s56, 7
    s_add_u32 s56, s56, s53
    buffer_load_dwordx4 v18, s[24:27], s56 offen offset:0 lds
    buffer_load_dwordx4 v19, s[24:27], s56 offen offset:1024 lds
    buffer_load_dwordx4 v20, s[24:27], s56 offen offset:2048 lds
    s_branch L_mainb
L_proa:
    v_mul_u32_u24 v96, 0xccd, v1
    v_lshlrev_b32 v7, 4, v1
    s_movk_i32 s56, 3680
    s_movk_i32 s57, 3840
    v_lshrrev_b32 v23, 15, v96
    v_and_b32 v97, 12, v23
    v_mad_u32_u24 v18, v23, s56, v7
    v_mad_u32_u24 v18, v97, s57, v18
    v_add_u32 v96, 209728, v96
    v_lshrrev_b32 v24, 15, v96
    v_and_b32 v97, 12, v24
    v_mad_u32_u24 v19, v24, s56, v7
    v_mad_u32_u24 v19, v97, s57, v19
    v_add_u32 v96, 209728, v96
    v_lshrrev_b32 v25, 15, v96
    v_and_b32 v97, 12, v25
    v_mad_u32_u24 v20, v25, s56, v7
    v_mad_u32_u24 v20, v97, s57, v20
    v_lshrrev_b32 v97, 4, v25
    v_mul_u32_u24 v97, 46080, v97
    v_sub_u32 v20, v20, v97
    v_add_u32 v96, 209728, v96
    v_lshrrev_b32 v26, 15, v96
    v_and_b32 v97, 12, v26
    v_mad_u32_u24 v21, v26, s56, v7
    v_mad_u32_u24 v21, v97, s57, v21
    v_subrev_u32 v21, 46080, v21
    v_add_u32 v96, 209728, v96
    v_lshrrev_b32 v27, 15, v96
    v_and_b32 v97, 12, v27
    v_mad_u32_u24 v22, v27, s56, v7
    v_mad_u32_u24 v22, v97, s57, v22
    v_subrev_u32 v22, 41984, v22
    s_and_b32 s56, s51, 1
    s_mul_i32 s56, s56, 122880
    s_mul_i32 s57, s50, 160
    s_add_u32 s54, s56, s57
    s_lshr_b32 s56, s51, 1
    s_add_u32 s56, s56, 1
    s_mulk_i32 s56, 1280
    s_add_u32 s53, s54, s56
    s_mul_i32 s55, s51, 9216
    s_mov_b32 s26, 2457600
    s_cmp_eq_u32 s48, 0
    s_waitcnt lgkmcnt(0)
    s_cselect_b32 s24, s6, s14
    s_cselect_b32 s25, s7, s15
    s_cselect_b32 s28, s10, s16
    s_cselect_b32 s29, s11, s17
    s_add_u32 m0, s55, 4096
    s_bfe_u32 s56, s70, 0x40000
    s_mul_i32 s56, s56, 245760
    s_add_u32 s56, s56, s53
    buffer_load_dwordx4 v18, s[24:27], s56 offen offset:0 lds
    buffer_load_dwordx4 v19, s[24:27], s56 offen offset:1024 lds
    buffer_load_dwordx4 v20, s[24:27], s56 offen offset:2048 lds
    v_lshrrev_b32 v56, 2, v1
    v_and_b32 v57, 3, v1
    v_mul_u32_u24 v56, 160, v56
    v_lshl_add_u32 v2, v57, 3, v56
    v_and_b32 v58, 15, v1
    v_lshrrev_b32 v59, 4, v1
    v_lshrrev_b32 v56, 1, v58
    v_xor_b32 v56, v56, v59
    v_lshlrev_b32 v56, 4, v56
    v_lshl_add_u32 v56, v58, 7, v56
    v_add_u32 v14, s55, v56
    s_and_b32 s57, s51, 1
    s_lshl_b32 s57, s57, 5
    v_mov_b32 v3, v2
    v_add_u32 v4, s57, v2
    s_xor_b32 s57, s51, 1
    s_mulk_i32 s57, 9216
    v_xor_b32 v15, 64, v14
    v_add_u32 v16, s57, v56
    v_xor_b32 v17, 64, v16
    s_mov_b32 s71, 0x6070504
    s_mov_b32 s72, 0x908
    s_cmp_eq_u32 s73, 1
    s_cselect_b32 s71, 0x8060503, s71
    s_cselect_b32 s72, 0x907, s72
    s_cmp_eq_u32 s73, 2
    s_cselect_b32 s71, 0x7060405, s71
    s_cselect_b32 s72, 0x809, s72
    s_cmp_eq_u32 s73, 3
    s_cselect_b32 s71, 0x7050604, s71
    s_cselect_b32 s72, 0x908, s72
    s_add_u32 s71, s71, s67
    s_add_u32 s57, s71, 0x76767676
    s_lshr_b32 s57, s57, 7
    s_and_b32 s57, s57, 0x01010101
    s_mul_i32 s57, s57, 10
    s_sub_u32 s71, s71, s57
    s_add_u32 s72, s72, s67
    s_add_u32 s57, s72, 0x76767676
    s_lshr_b32 s57, s57, 7
    s_and_b32 s57, s57, 0x01010101
    s_mul_i32 s57, s57, 10
    s_sub_u32 s72, s72, s57
    s_mov_b32 s32, s22
    s_mov_b32 s33, s23
    s_mov_b32 s34, 0x10000000
    s_mov_b32 s35, 0x20000
    s_mov_b32 s36, s18
    s_mov_b32 s37, s19
    s_mov_b32 s38, 5242880
    s_mov_b32 s39, 0x20000
    s_mov_b32 s44, s20
    s_mov_b32 s45, s21
    s_movk_i32 s46, 256
    s_mov_b32 s47, 0x20000
    s_mov_b32 s74, 0x3fb8aa3b
    s_mov_b32 s75, 0x3fb8aa3b
    v_lshlrev_b32 v7, 4, v1
    v_lshrrev_b32 v104, 4, v1
    v_and_b32 v105, 15, v1
    v_lshrrev_b32 v106, 5, v1
    v_and_b32 v107, 31, v1
    v_mov_b32 v108, 0x40000000
    v_and_b32 v109, 3, v1
    s_and_b32 s68, s2, 7
    s_lshl_b32 s68, s68, 12
    s_add_u32 s68, s68, 0x280000
    s_lshl2_add_u32 s57, s49, s51
    s_mul_i32 s57, s57, 81920
    s_mul_i32 s58, s48, 1280
    s_add_u32 s57, s57, s58
    s_mov_b32 s63, s57
    s_mul_i32 s64, s50, 160
    s_add_u32 s66, s63, s64
    s_mul_i32 s58, s50, 5120
    s_add_u32 s57, s57, s58
    s_add_u32 s62, s57, 0
    v_and_b32 v96, 1, v104
    v_mul_u32_u24 v96, 40960, v96
    v_cmp_gt_u32 vcc, 32, v1
    v_lshl_add_u32 v96, v105, 4, v96
    s_nop 0
    v_cndmask_b32 v13, v108, v96, vcc
    v_lshrrev_b32 v96, 3, v107
    v_lshl_add_u32 v96, v96, 2, v109
    v_bfe_u32 v97, v1, 2, 1
    v_lshl_add_u32 v98, v97, 3, v96
    v_add_u32 v99, 8, v96
    v_cmp_gt_u32 vcc, 8, v96
    v_min_u32 v99, 20, v99
    v_min_u32 v96, 9, v96
    v_cndmask_b32 v110, v99, v98, vcc
    v_mad_u32_u24 v111, v97, 10, v96
    s_lshl3_add_u32 s57, s48, s50
    s_lshl2_add_u32 s57, s57, s51
    s_mul_i32 s60, s57, 7168
    s_add_u32 s60, s60, 0x200000
    s_mul_i32 s58, s52, 327680
    s_sub_u32 s59, s62, s58
    s_cmp_eq_u32 s48, 0
    s_cbranch_scc0 L_setBa
    v_cmp_gt_u32 vcc, 16, v110
    v_mov_b32 v98, 80
    v_mov_b32 v99, 154368
    v_mov_b32 v96, 256
    v_mov_b32 v97, 153600
    v_cndmask_b32 v98, v98, v96, vcc
    v_cndmask_b32 v99, v99, v97, vcc
    v_lshl_add_u32 v99, v110, 4, v99
    v_mad_u32_u24 v9, v106, v98, v99
    v_lshl_add_u32 v10, v98, 1, v9
    v_lshlrev_b32 v98, 3, v106
    v_lshl_add_u32 v98, v110, 4, v98
    v_add_u32 v11, 154944, v98
    v_mov_b32 v50, v7
    v_mul_u32_u24 v96, 80, v104
    v_lshl_add_u32 v96, v105, 4, v96
    v_cmp_gt_u32 vcc, 5, v105
    v_add_u32 v96, 2560, v96
    v_add_u32 v52, 2880, v7
    v_cndmask_b32 v51, v108, v96, vcc
    v_and_b32 v98, 1, v1
    v_mul_i32_i24 v41, -40960, v98
    s_movk_i32 s57, 105
    s_mov_b32 s58, 32
    s_branch L_setJa
L_setBa:
    v_mul_u32_u24 v98, 336, v106
    v_cmp_gt_u32 vcc, 32, v1
    v_lshl_add_u32 v9, v110, 4, v98
    v_lshlrev_b32 v99, 4, v110
    v_add_u32 v9, 153600, v9
    v_add_u32 v99, 154272, v99
    v_mov_b32 v10, 160784
    v_cndmask_b32 v11, v10, v99, vcc
    v_cmp_gt_u32 vcc, 21, v107
    v_lshl_add_u32 v96, v107, 4, v98
    v_mov_b32 v51, v108
    v_cndmask_b32 v50, v108, v96, vcc
    v_add_u32 v52, 672, v7
    v_mov_b32 v41, 0
    s_mov_b32 s57, 63
    s_mov_b32 s58, 16
L_setJa:
    s_nop 1
    v_cmp_gt_u32 vcc, 21, v1
    s_mul_i32 s69, s52, s58
    v_mul_u32_u24 v97, 1792, v104
    v_cndmask_b32 v52, v108, v52, vcc
    v_lshl_add_u32 v33, v105, 4, v97
    s_sub_u32 s57, s57, s69
    s_min_u32 s57, s57, s58
    s_lshl_b32 s69, s69, 4
    v_mul_u32_u24 v97, 327680, v104
    s_cmp_ge_u32 s69, 1024
    s_cselect_b32 s58, 1536, 0
    s_add_u32 s58, s58, s69
    v_lshl_add_u32 v97, v105, 4, v97
    v_add_u32 v53, s58, v97
    v_cmp_gt_u32 vcc, s57, v1
    s_lshr_b32 s58, s49, 2
    s_mulk_i32 s58, 1792
    s_add_u32 s69, s69, s58
    v_add_u32 v96, s69, v7
    v_cndmask_b32 v54, v108, v96, vcc
    s_mul_i32 s57, s51, 1280
    s_add_u32 s57, s57, 102400
    v_mul_u32_u24 v96, 40, v105
    v_add_u32 v96, s57, v96
    s_and_b32 s58, s51, 1
    s_mul_i32 s69, s58, 2560
    s_sub_u32 s69, 1280, s69
    s_lshl_b32 s58, s58, 2
    v_add_u32 v99, s58, v104
    v_add_u32 v97, 0, v99
    v_mul_u32_u24 v98, 52, v97
    v_lshrrev_b32 v98, 8, v98
    v_mul_u32_u24 v98, 5080, v98
    v_lshl_add_u32 v98, v97, 3, v98
    v_add_u32 v34, v98, v96
    v_add_u32 v35, s69, v34
    v_add_u32 v97, 8, v99
    v_mul_u32_u24 v98, 52, v97
    v_lshrrev_b32 v98, 8, v98
    v_mul_u32_u24 v98, 5080, v98
    v_lshl_add_u32 v98, v97, 3, v98
    v_add_u32 v36, v98, v96
    v_add_u32 v37, s69, v36
    v_add_u32 v97, 16, v104
    v_mul_u32_u24 v98, 52, v97
    v_lshrrev_b32 v98, 8, v98
    v_mul_u32_u24 v98, 5080, v98
    v_lshl_add_u32 v98, v97, 3, v98
    v_add_u32 v38, v98, v96
    s_add_u32 s57, s57, 0
    v_mul_u32_u24 v96, 40, v107
    v_add_u32 v96, s57, v96
    v_lshl_add_u32 v5, v106, 4, v96
    v_add_u32 v6, 32, v96
    v_mul_i32_i24 v97, -40960, v106
    v_add_u32 v39, v96, v97
    v_lshlrev_b32 v96, 3, v1
    v_add_u32 v8, 147456, v96
    s_mov_b32 s30, 819200
    s_mov_b32 s31, 0x20000
    s_mul_i32 s57, s51, 5120
    v_bfe_u32 v96, v1, 2, 3
    v_lshlrev_b32 v97, 1, v106
    v_lshl_add_u32 v96, v96, 2, v97
    v_mul_u32_u24 v96, 40, v96
    v_add_u32 v96, s57, v96
    v_lshl_add_u32 v40, v109, 3, v96
    v_add_u32 v40, 61440, v40
    v_add_u32 v97, 102432, v96
    v_add_u32 v41, v41, v97
    v_cmp_eq_u32 vcc, 0, v109
    v_mov_b32 v97, 160768
    v_add_u32 v98, 122912, v96
    v_cndmask_b32 v98, v97, v98, vcc
    v_accvgpr_write_b32 a100, v98
    v_add_u32 v98, 122952, v96
    v_cndmask_b32 v98, v97, v98, vcc
    v_accvgpr_write_b32 a101, v98
    v_add_u32 v98, 124192, v96
    v_cndmask_b32 v98, v97, v98, vcc
    v_accvgpr_write_b32 a102, v98
    v_add_u32 v98, 124232, v96
    v_cndmask_b32 v98, v97, v98, vcc
    v_accvgpr_write_b32 a103, v98
    v_add_u32 v98, 125472, v96
    v_cndmask_b32 v98, v97, v98, vcc
    v_accvgpr_write_b32 a104, v98
    v_add_u32 v98, 125512, v96
    v_cndmask_b32 v98, v97, v98, vcc
    v_accvgpr_write_b32 a105, v98
    v_add_u32 v98, 126752, v96
    v_cndmask_b32 v98, v97, v98, vcc
    v_accvgpr_write_b32 a106, v98
    v_add_u32 v98, 126792, v96
    v_cndmask_b32 v98, v97, v98, vcc
    v_accvgpr_write_b32 a107, v98
    v_mov_b32 v98, 0x3f803f80
    v_mov_b32 v99, 0x3f803f80
    ds_write_b64 v97, v[98:99]
    v_mov_b32 v98, 0
    v_mov_b32 v99, 0
    ds_write2_b64 v97, v[98:99], v[98:99] offset0:2 offset1:3
    ds_write2_b64 v97, v[98:99], v[98:99] offset0:226 offset1:227
    v_mov_b32 v98, 0x3f80
    v_and_b32 v99, 1, v1
    v_lshlrev_b32 v99, 4, v99
    v_lshlrev_b32 v98, v99, v98
    v_lshrrev_b32 v99, 1, v105
    v_cmp_eq_u32 vcc, 0, v99
    s_nop 1
    v_cndmask_b32 v96, 0, v98, vcc
    v_accvgpr_write_b32 a120, v96
    v_cmp_eq_u32 vcc, 1, v99
    s_nop 1
    v_cndmask_b32 v96, 0, v98, vcc
    v_accvgpr_write_b32 a121, v96
    v_cmp_eq_u32 vcc, 2, v99
    s_nop 1
    v_cndmask_b32 v96, 0, v98, vcc
    v_accvgpr_write_b32 a122, v96
    v_cmp_eq_u32 vcc, 3, v99
    s_nop 1
    v_cndmask_b32 v96, 0, v98, vcc
    v_accvgpr_write_b32 a123, v96
    v_cmp_eq_u32 vcc, 4, v99
    s_nop 1
    v_cndmask_b32 v96, 0, v98, vcc
    v_accvgpr_write_b32 a124, v96
    v_cmp_eq_u32 vcc, 5, v99
    s_nop 1
    v_cndmask_b32 v96, 0, v98, vcc
    v_accvgpr_write_b32 a125, v96
    v_cmp_eq_u32 vcc, 6, v99
    s_nop 1
    v_cndmask_b32 v96, 0, v98, vcc
    v_accvgpr_write_b32 a126, v96
    v_cmp_eq_u32 vcc, 7, v99
    s_nop 1
    v_cndmask_b32 v96, 0, v98, vcc
    v_accvgpr_write_b32 a127, v96
    v_mul_u32_u24 v96, 160, v23
    v_sub_u32 v28, v7, v96
    v_bfe_u32 v96, v23, 2, 2
    v_lshrrev_b32 v97, 4, v23
    v_and_b32 v98, 3, v23
    v_lshl_add_u32 v99, v96, 2, v97
    v_mad_u32_u24 v99, v99, 20, v98
    v_add_u32 v99, 16, v99
    v_lshl_add_u32 v98, v97, 2, v98
    v_lshl_add_u32 v98, v96, 2, v98
    v_and_b32 v96, 1, v96
    v_lshl_add_u32 v98, v96, 4, v98
    v_mul_u32_u24 v98, 1280, v98
    v_mul_u32_u24 v99, 1280, v99
    v_add_u32 v23, v98, v28
    v_add_u32 v28, v99, v28
    v_mul_u32_u24 v96, 160, v24
    v_sub_u32 v29, v7, v96
    v_bfe_u32 v96, v24, 2, 2
    v_lshrrev_b32 v97, 4, v24
    v_and_b32 v98, 3, v24
    v_lshl_add_u32 v99, v96, 2, v97
    v_mad_u32_u24 v99, v99, 20, v98
    v_add_u32 v99, 16, v99
    v_lshl_add_u32 v98, v97, 2, v98
    v_lshl_add_u32 v98, v96, 2, v98
    v_and_b32 v96, 1, v96
    v_lshl_add_u32 v98, v96, 4, v98
    v_mul_u32_u24 v98, 1280, v98
    v_mul_u32_u24 v99, 1280, v99
    v_add_u32 v24, v98, v29
    v_add_u32 v29, v99, v29
    buffer_load_dwordx4 v21, s[24:27], s56 offen offset:3072 lds
    s_add_u32 m0, s55, 8192
    s_nop 0
    buffer_load_dwordx4 v22, s[24:27], s56 offen lds
    s_mov_b32 s40, s8
    s_mov_b32 s41, s9
    s_movk_i32 s42, 25600
    s_mov_b32 s43, 0x20000
    s_lshl_b32 s56, s51, 10
    s_add_u32 m0, s56, 153600
    s_lshl2_add_u32 s56, s50, s51
    s_mulk_i32 s56, 800
    s_cmp_eq_u32 s48, 0
    s_cselect_b32 s56, s56, 0x40000000
    buffer_load_dwordx4 v7, s[40:43], s56 offen lds
    s_barrier
    s_add_u32 m0, s55, 40960
    s_bfe_u32 s56, s70, 0x40008
    s_mul_i32 s56, s56, 245760
    s_add_u32 s56, s56, s53
    buffer_load_dwordx4 v18, s[24:27], s56 offen offset:0 lds
    buffer_load_dwordx4 v19, s[24:27], s56 offen offset:1024 lds
    buffer_load_dwordx4 v20, s[24:27], s56 offen offset:2048 lds
    buffer_load_dwordx4 v21, s[24:27], s56 offen offset:3072 lds
    s_add_u32 m0, s55, 45056
    s_nop 0
    buffer_load_dwordx4 v22, s[24:27], s56 offen lds
    v_mul_u32_u24 v96, 160, v25
    v_sub_u32 v30, v7, v96
    v_bfe_u32 v96, v25, 2, 2
    v_lshrrev_b32 v97, 4, v25
    v_and_b32 v98, 3, v25
    v_lshl_add_u32 v99, v96, 2, v97
    v_mad_u32_u24 v99, v99, 20, v98
    v_add_u32 v99, 16, v99
    v_lshl_add_u32 v98, v97, 2, v98
    v_lshl_add_u32 v98, v96, 2, v98
    v_and_b32 v96, 1, v96
    v_lshl_add_u32 v98, v96, 4, v98
    v_mul_u32_u24 v98, 1280, v98
    v_mul_u32_u24 v99, 1280, v99
    v_add_u32 v25, v98, v30
    v_add_u32 v30, v99, v30
    v_mul_u32_u24 v96, 160, v26
    v_sub_u32 v31, v7, v96
    v_bfe_u32 v96, v26, 2, 2
    v_lshrrev_b32 v97, 4, v26
    v_and_b32 v98, 3, v26
    v_lshl_add_u32 v99, v96, 2, v97
    v_mad_u32_u24 v99, v99, 20, v98
    v_add_u32 v99, 16, v99
    v_lshl_add_u32 v98, v97, 2, v98
    v_lshl_add_u32 v98, v96, 2, v98
    v_and_b32 v96, 1, v96
    v_lshl_add_u32 v98, v96, 4, v98
    v_mul_u32_u24 v98, 1280, v98
    v_mul_u32_u24 v99, 1280, v99
    v_add_u32 v26, v98, v31
    v_add_u32 v31, v99, v31
    v_mul_u32_u24 v96, 160, v27
    v_sub_u32 v32, v7, v96
    v_add_u32 v32, 4096, v32
    v_bfe_u32 v96, v27, 2, 2
    v_lshrrev_b32 v97, 4, v27
    v_and_b32 v98, 3, v27
    v_lshl_add_u32 v99, v96, 2, v97
    v_mad_u32_u24 v99, v99, 20, v98
    v_add_u32 v99, 16, v99
    v_lshl_add_u32 v98, v97, 2, v98
    v_lshl_add_u32 v98, v96, 2, v98
    v_and_b32 v96, 1, v96
    v_lshl_add_u32 v98, v96, 4, v98
    v_mul_u32_u24 v98, 1280, v98
    v_mul_u32_u24 v99, 1280, v99
    v_add_u32 v27, v98, v32
    v_add_u32 v32, v99, v32
    s_mul_i32 s57, s48, 0x358637bd
    v_mov_b32 v46, s57
    v_mov_b32 v47, s57
    v_mov_b32 v48, s57
    v_mov_b32 v49, s57
    s_mul_i32 s55, s51, 5120
    s_lshr_b32 s57, s51, 1
    s_lshl_b32 s57, s57, 3
    s_lshr_b32 s70, s70, s57
    s_lshr_b32 s71, s71, s57
    s_lshr_b32 s72, s72, s57
    s_waitcnt vmcnt(6)
    s_barrier
    ds_read_b128 a[0:3], v14 offset:0
    ds_read_b128 a[4:7], v14 offset:2048
    ds_read_b64_tr_b16 a[32:33], v4 offset:4096
    ds_read_b64_tr_b16 a[34:35], v4 offset:6656
    ds_read_b128 a[8:11], v16 offset:0
    ds_read_b128 a[12:15], v16 offset:2048
    ds_read_b64_tr_b16 a[36:37], v4 offset:4160
    ds_read_b64_tr_b16 a[38:39], v4 offset:6720
    ds_read_b64_tr_b16 a[40:41], v3 offset:4224
    ds_read_b64_tr_b16 a[42:43], v3 offset:6784
    ds_read_b64_tr_b16 a[44:45], v4 offset:22528
    ds_read_b64_tr_b16 a[46:47], v4 offset:25088
    ds_read_b64_tr_b16 a[48:49], v4 offset:22592
    ds_read_b64_tr_b16 a[50:51], v4 offset:25152
    s_waitcnt lgkmcnt(10)
    v_mfma_f32_16x16x32_bf16 v[56:59], a[32:35], a[0:3], v[46:49]
    v_mfma_f32_16x16x32_bf16 v[60:63], a[32:35], a[4:7], v[46:49]
    ds_read_b64_tr_b16 a[52:53], v3 offset:22656
    s_waitcnt lgkmcnt(10)
    v_mfma_f32_16x16x32_bf16 v[64:67], a[32:35], a[8:11], v[46:49]
    ds_read_b64_tr_b16 a[54:55], v3 offset:25216
    s_waitcnt lgkmcnt(10)
    v_mfma_f32_16x16x32_bf16 v[68:71], a[32:35], a[12:15], v[46:49]
    ds_read_b128 a[16:19], v15 offset:0
    s_waitcnt lgkmcnt(9)
    v_mfma_f32_16x16x32_bf16 v[72:75], a[36:39], a[0:3], v[46:49]
    ds_read_b128 a[20:23], v15 offset:2048
    v_mfma_f32_16x16x32_bf16 v[76:79], a[36:39], a[4:7], v[46:49]
    ds_read_b64_tr_b16 a[56:57], v4 offset:13312
    v_mfma_f32_16x16x32_bf16 v[80:83], a[36:39], a[8:11], v[46:49]
    ds_read_b64_tr_b16 a[58:59], v4 offset:15872
    v_mfma_f32_16x16x32_bf16 v[84:87], a[36:39], a[12:15], v[46:49]
    ds_read_b128 a[24:27], v17 offset:0
    s_waitcnt lgkmcnt(11)
    v_mfma_f32_16x16x32_bf16 v[88:91], a[40:43], a[0:3], v[46:49]
    ds_read_b128 a[28:31], v17 offset:2048
    v_mfma_f32_16x16x32_bf16 v[92:95], a[40:43], a[4:7], v[46:49]
    ds_read_b64_tr_b16 a[60:61], v4 offset:13376
    s_waitcnt lgkmcnt(11)
    v_mfma_f32_16x16x32_bf16 v[96:99], a[44:47], a[0:3], 0
    ds_read_b64_tr_b16 a[62:63], v4 offset:15936
    v_mfma_f32_16x16x32_bf16 v[100:103], a[44:47], a[4:7], 0
    ds_read_b64_tr_b16 a[32:33], v3 offset:13440
    v_mfma_f32_16x16x32_bf16 v[104:107], a[44:47], a[8:11], 0
    ds_read_b64_tr_b16 a[34:35], v3 offset:16000
    v_mfma_f32_16x16x32_bf16 v[108:111], a[44:47], a[12:15], 0
    ds_read_b64_tr_b16 a[36:37], v4 offset:31744
    s_waitcnt lgkmcnt(13)
    v_mfma_f32_16x16x32_bf16 v[112:115], a[48:51], a[0:3], 0
    ds_read_b64_tr_b16 a[38:39], v4 offset:34304
    v_mfma_f32_16x16x32_bf16 v[116:119], a[48:51], a[4:7], 0
    v_mfma_f32_16x16x32_bf16 v[120:123], a[48:51], a[8:11], 0
    v_mfma_f32_16x16x32_bf16 v[124:127], a[48:51], a[12:15], 0
    ds_read_b64_tr_b16 a[40:41], v4 offset:31808
    s_waitcnt lgkmcnt(13)
    v_mfma_f32_16x16x32_bf16 v[42:45], a[52:55], a[0:3], 0
    ds_read_b64_tr_b16 a[42:43], v4 offset:34368
    v_mfma_f32_16x16x32_bf16 v[46:49], a[52:55], a[4:7], 0
    s_waitcnt lgkmcnt(10)
    v_mfma_f32_16x16x32_bf16 v[56:59], a[56:59], a[16:19], v[56:59]
    v_mfma_f32_16x16x32_bf16 v[60:63], a[56:59], a[20:23], v[60:63]
    ds_read_b64_tr_b16 a[44:45], v3 offset:31872
    s_waitcnt lgkmcnt(10)
    v_mfma_f32_16x16x32_bf16 v[64:67], a[56:59], a[24:27], v[64:67]
    ds_read_b64_tr_b16 a[46:47], v3 offset:34432
    s_waitcnt lgkmcnt(10)
    v_mfma_f32_16x16x32_bf16 v[68:71], a[56:59], a[28:31], v[68:71]
    s_waitcnt vmcnt(0)
    s_barrier
    v_add_u32 v3, 36864, v3
    v_add_u32 v4, 36864, v4
    ds_read_b128 a[0:3], v14 offset:36864
    s_waitcnt lgkmcnt(9)
    v_mfma_f32_16x16x32_bf16 v[72:75], a[60:63], a[16:19], v[72:75]
    ds_read_b128 a[4:7], v14 offset:38912
    v_mfma_f32_16x16x32_bf16 v[76:79], a[60:63], a[20:23], v[76:79]
    ds_read_b64_tr_b16 a[48:49], v4 offset:4096
    v_mfma_f32_16x16x32_bf16 v[80:83], a[60:63], a[24:27], v[80:83]
    ds_read_b64_tr_b16 a[50:51], v4 offset:6656
    v_mfma_f32_16x16x32_bf16 v[84:87], a[60:63], a[28:31], v[84:87]
    ds_read_b128 a[8:11], v16 offset:36864
    s_waitcnt lgkmcnt(11)
    v_mfma_f32_16x16x32_bf16 v[88:91], a[32:35], a[16:19], v[88:91]
    ds_read_b128 a[12:15], v16 offset:38912
    v_mfma_f32_16x16x32_bf16 v[92:95], a[32:35], a[20:23], v[92:95]
    ds_read_b64_tr_b16 a[52:53], v4 offset:4160
    s_waitcnt lgkmcnt(11)
    v_mfma_f32_16x16x32_bf16 v[96:99], a[36:39], a[16:19], v[96:99]
    ds_read_b64_tr_b16 a[54:55], v4 offset:6720
    v_mfma_f32_16x16x32_bf16 v[100:103], a[36:39], a[20:23], v[100:103]
    ds_read_b64_tr_b16 a[56:57], v3 offset:4224
    v_mfma_f32_16x16x32_bf16 v[104:107], a[36:39], a[24:27], v[104:107]
    ds_read_b64_tr_b16 a[58:59], v3 offset:6784
    v_mfma_f32_16x16x32_bf16 v[108:111], a[36:39], a[28:31], v[108:111]
    ds_read_b64_tr_b16 a[60:61], v4 offset:22528
    s_waitcnt lgkmcnt(13)
    v_mfma_f32_16x16x32_bf16 v[112:115], a[40:43], a[16:19], v[112:115]
    ds_read_b64_tr_b16 a[62:63], v4 offset:25088
    v_mfma_f32_16x16x32_bf16 v[116:119], a[40:43], a[20:23], v[116:119]
    v_mfma_f32_16x16x32_bf16 v[120:123], a[40:43], a[24:27], v[120:123]
    v_mfma_f32_16x16x32_bf16 v[124:127], a[40:43], a[28:31], v[124:127]
    ds_read_b64_tr_b16 a[32:33], v4 offset:22592
    s_waitcnt lgkmcnt(13)
    v_mfma_f32_16x16x32_bf16 v[42:45], a[44:47], a[16:19], v[42:45]
    ds_read_b64_tr_b16 a[34:35], v4 offset:25152
    v_mfma_f32_16x16x32_bf16 v[46:49], a[44:47], a[20:23], v[46:49]
    s_waitcnt lgkmcnt(10)
    v_mfma_f32_16x16x32_bf16 v[56:59], a[48:51], a[0:3], v[56:59]
    v_mfma_f32_16x16x32_bf16 v[60:63], a[48:51], a[4:7], v[60:63]
    ds_read_b64_tr_b16 a[36:37], v3 offset:22656
    s_waitcnt lgkmcnt(10)
    v_mfma_f32_16x16x32_bf16 v[64:67], a[48:51], a[8:11], v[64:67]
    ds_read_b64_tr_b16 a[38:39], v3 offset:25216
    s_waitcnt lgkmcnt(10)
    v_mfma_f32_16x16x32_bf16 v[68:71], a[48:51], a[12:15], v[68:71]
    ds_read_b128 a[16:19], v15 offset:36864
    s_waitcnt lgkmcnt(9)
    v_mfma_f32_16x16x32_bf16 v[72:75], a[52:55], a[0:3], v[72:75]
    ds_read_b128 a[20:23], v15 offset:38912
    v_mfma_f32_16x16x32_bf16 v[76:79], a[52:55], a[4:7], v[76:79]
    ds_read_b64_tr_b16 a[40:41], v4 offset:13312
    v_mfma_f32_16x16x32_bf16 v[80:83], a[52:55], a[8:11], v[80:83]
    ds_read_b64_tr_b16 a[42:43], v4 offset:15872
    v_mfma_f32_16x16x32_bf16 v[84:87], a[52:55], a[12:15], v[84:87]
    ds_read_b128 a[24:27], v17 offset:36864
    s_waitcnt lgkmcnt(11)
    v_mfma_f32_16x16x32_bf16 v[88:91], a[56:59], a[0:3], v[88:91]
    ds_read_b128 a[28:31], v17 offset:38912
    v_mfma_f32_16x16x32_bf16 v[92:95], a[56:59], a[4:7], v[92:95]
    ds_read_b64_tr_b16 a[44:45], v4 offset:13376
    s_waitcnt lgkmcnt(11)
    v_mfma_f32_16x16x32_bf16 v[96:99], a[60:63], a[0:3], v[96:99]
    ds_read_b64_tr_b16 a[46:47], v4 offset:15936
    v_mfma_f32_16x16x32_bf16 v[100:103], a[60:63], a[4:7], v[100:103]
    ds_read_b64_tr_b16 a[48:49], v3 offset:13440
    v_mfma_f32_16x16x32_bf16 v[104:107], a[60:63], a[8:11], v[104:107]
    ds_read_b64_tr_b16 a[50:51], v3 offset:16000
    v_mfma_f32_16x16x32_bf16 v[108:111], a[60:63], a[12:15], v[108:111]
    ds_read_b64_tr_b16 a[52:53], v4 offset:31744
    s_waitcnt lgkmcnt(13)
    v_mfma_f32_16x16x32_bf16 v[112:115], a[32:35], a[0:3], v[112:115]
    ds_read_b64_tr_b16 a[54:55], v4 offset:34304
    v_mfma_f32_16x16x32_bf16 v[116:119], a[32:35], a[4:7], v[116:119]
    v_mfma_f32_16x16x32_bf16 v[120:123], a[32:35], a[8:11], v[120:123]
    v_mfma_f32_16x16x32_bf16 v[124:127], a[32:35], a[12:15], v[124:127]
    ds_read_b64_tr_b16 a[56:57], v4 offset:31808
    s_waitcnt lgkmcnt(13)
    v_mfma_f32_16x16x32_bf16 v[42:45], a[36:39], a[0:3], v[42:45]
    ds_read_b64_tr_b16 a[58:59], v4 offset:34368
    v_mfma_f32_16x16x32_bf16 v[46:49], a[36:39], a[4:7], v[46:49]
    s_waitcnt lgkmcnt(10)
    v_mfma_f32_16x16x32_bf16 v[56:59], a[40:43], a[16:19], v[56:59]
    v_mfma_f32_16x16x32_bf16 v[60:63], a[40:43], a[20:23], v[60:63]
    ds_read_b64_tr_b16 a[60:61], v3 offset:31872
    s_waitcnt lgkmcnt(10)
    v_mfma_f32_16x16x32_bf16 v[64:67], a[40:43], a[24:27], v[64:67]
    ds_read_b64_tr_b16 a[62:63], v3 offset:34432
    s_waitcnt lgkmcnt(10)
    v_mfma_f32_16x16x32_bf16 v[68:71], a[40:43], a[28:31], v[68:71]
    s_barrier
    v_add_u32 v3, 36864, v3
    v_add_u32 v4, 36864, v4
    v_add_u32 v14, 73728, v14
    v_add_u32 v15, 73728, v15
    v_add_u32 v16, 73728, v16
    v_add_u32 v17, 73728, v17
    ds_read_b128 a[0:3], v14 offset:0
    s_waitcnt lgkmcnt(9)
    v_mfma_f32_16x16x32_bf16 v[72:75], a[44:47], a[16:19], v[72:75]
    ds_read_b128 a[4:7], v14 offset:2048
    v_mfma_f32_16x16x32_bf16 v[76:79], a[44:47], a[20:23], v[76:79]
    ds_read_b64_tr_b16 a[32:33], v4 offset:4096
    v_mfma_f32_16x16x32_bf16 v[80:83], a[44:47], a[24:27], v[80:83]
    ds_read_b64_tr_b16 a[34:35], v4 offset:6656
    v_mfma_f32_16x16x32_bf16 v[84:87], a[44:47], a[28:31], v[84:87]
    ds_read_b128 a[8:11], v16 offset:0
    s_waitcnt lgkmcnt(11)
    v_mfma_f32_16x16x32_bf16 v[88:91], a[48:51], a[16:19], v[88:91]
    ds_read_b128 a[12:15], v16 offset:2048
    v_mfma_f32_16x16x32_bf16 v[92:95], a[48:51], a[20:23], v[92:95]
    ds_read_b64_tr_b16 a[36:37], v4 offset:4160
    s_waitcnt lgkmcnt(11)
    v_mfma_f32_16x16x32_bf16 v[96:99], a[52:55], a[16:19], v[96:99]
    ds_read_b64_tr_b16 a[38:39], v4 offset:6720
    v_mfma_f32_16x16x32_bf16 v[100:103], a[52:55], a[20:23], v[100:103]
    ds_read_b64_tr_b16 a[40:41], v3 offset:4224
    v_mfma_f32_16x16x32_bf16 v[104:107], a[52:55], a[24:27], v[104:107]
    ds_read_b64_tr_b16 a[42:43], v3 offset:6784
    v_mfma_f32_16x16x32_bf16 v[108:111], a[52:55], a[28:31], v[108:111]
    ds_read_b64_tr_b16 a[44:45], v4 offset:22528
    s_waitcnt lgkmcnt(13)
    v_mfma_f32_16x16x32_bf16 v[112:115], a[56:59], a[16:19], v[112:115]
    ds_read_b64_tr_b16 a[46:47], v4 offset:25088
    v_mfma_f32_16x16x32_bf16 v[116:119], a[56:59], a[20:23], v[116:119]
    v_mfma_f32_16x16x32_bf16 v[120:123], a[56:59], a[24:27], v[120:123]
    v_mfma_f32_16x16x32_bf16 v[124:127], a[56:59], a[28:31], v[124:127]
    ds_read_b64_tr_b16 a[48:49], v4 offset:22592
    s_waitcnt lgkmcnt(13)
    v_mfma_f32_16x16x32_bf16 v[42:45], a[60:63], a[16:19], v[42:45]
    ds_read_b64_tr_b16 a[50:51], v4 offset:25152
    v_mfma_f32_16x16x32_bf16 v[46:49], a[60:63], a[20:23], v[46:49]
    s_waitcnt lgkmcnt(10)
    v_mfma_f32_16x16x32_bf16 v[56:59], a[32:35], a[0:3], v[56:59]
    v_mfma_f32_16x16x32_bf16 v[60:63], a[32:35], a[4:7], v[60:63]
    ds_read_b64_tr_b16 a[52:53], v3 offset:22656
    s_waitcnt lgkmcnt(10)
    v_mfma_f32_16x16x32_bf16 v[64:67], a[32:35], a[8:11], v[64:67]
    ds_read_b64_tr_b16 a[54:55], v3 offset:25216
    s_waitcnt lgkmcnt(10)
    v_mfma_f32_16x16x32_bf16 v[68:71], a[32:35], a[12:15], v[68:71]
    ds_read_b128 a[16:19], v15 offset:0
    s_waitcnt lgkmcnt(9)
    v_mfma_f32_16x16x32_bf16 v[72:75], a[36:39], a[0:3], v[72:75]
    ds_read_b128 a[20:23], v15 offset:2048
    v_mfma_f32_16x16x32_bf16 v[76:79], a[36:39], a[4:7], v[76:79]
    ds_read_b64_tr_b16 a[56:57], v4 offset:13312
    v_mfma_f32_16x16x32_bf16 v[80:83], a[36:39], a[8:11], v[80:83]
    ds_read_b64_tr_b16 a[58:59], v4 offset:15872
    v_mfma_f32_16x16x32_bf16 v[84:87], a[36:39], a[12:15], v[84:87]
    ds_read_b128 a[24:27], v17 offset:0
    s_waitcnt lgkmcnt(11)
    v_mfma_f32_16x16x32_bf16 v[88:91], a[40:43], a[0:3], v[88:91]
    ds_read_b128 a[28:31], v17 offset:2048
    v_mfma_f32_16x16x32_bf16 v[92:95], a[40:43], a[4:7], v[92:95]
    ds_read_b64_tr_b16 a[60:61], v4 offset:13376
    s_waitcnt lgkmcnt(11)
    v_mfma_f32_16x16x32_bf16 v[96:99], a[44:47], a[0:3], v[96:99]
    ds_read_b64_tr_b16 a[62:63], v4 offset:15936
    v_mfma_f32_16x16x32_bf16 v[100:103], a[44:47], a[4:7], v[100:103]
    ds_read_b64_tr_b16 a[32:33], v3 offset:13440
    v_mfma_f32_16x16x32_bf16 v[104:107], a[44:47], a[8:11], v[104:107]
    ds_read_b64_tr_b16 a[34:35], v3 offset:16000
    v_mfma_f32_16x16x32_bf16 v[108:111], a[44:47], a[12:15], v[108:111]
    ds_read_b64_tr_b16 a[36:37], v4 offset:31744
    s_waitcnt lgkmcnt(13)
    v_mfma_f32_16x16x32_bf16 v[112:115], a[48:51], a[0:3], v[112:115]
    ds_read_b64_tr_b16 a[38:39], v4 offset:34304
    v_mfma_f32_16x16x32_bf16 v[116:119], a[48:51], a[4:7], v[116:119]
    v_mfma_f32_16x16x32_bf16 v[120:123], a[48:51], a[8:11], v[120:123]
    v_mfma_f32_16x16x32_bf16 v[124:127], a[48:51], a[12:15], v[124:127]
    ds_read_b64_tr_b16 a[40:41], v4 offset:31808
    s_waitcnt lgkmcnt(13)
    v_mfma_f32_16x16x32_bf16 v[42:45], a[52:55], a[0:3], v[42:45]
    ds_read_b64_tr_b16 a[42:43], v4 offset:34368
    v_mfma_f32_16x16x32_bf16 v[46:49], a[52:55], a[4:7], v[46:49]
    s_waitcnt lgkmcnt(10)
    v_mfma_f32_16x16x32_bf16 v[56:59], a[56:59], a[16:19], v[56:59]
    v_mfma_f32_16x16x32_bf16 v[60:63], a[56:59], a[20:23], v[60:63]
    ds_read_b64_tr_b16 a[44:45], v3 offset:31872
    s_waitcnt lgkmcnt(10)
    v_mfma_f32_16x16x32_bf16 v[64:67], a[56:59], a[24:27], v[64:67]
    ds_read_b64_tr_b16 a[46:47], v3 offset:34432
    s_waitcnt lgkmcnt(10)
    v_mfma_f32_16x16x32_bf16 v[68:71], a[56:59], a[28:31], v[68:71]
    s_barrier
    v_add_u32 v3, 36864, v3
    v_add_u32 v4, 36864, v4
    ds_read_b128 a[0:3], v14 offset:36864
    s_waitcnt lgkmcnt(9)
    v_mfma_f32_16x16x32_bf16 v[72:75], a[60:63], a[16:19], v[72:75]
    ds_read_b128 a[4:7], v14 offset:38912
    v_mfma_f32_16x16x32_bf16 v[76:79], a[60:63], a[20:23], v[76:79]
    ds_read_b64_tr_b16 a[48:49], v4 offset:4096
    v_mfma_f32_16x16x32_bf16 v[80:83], a[60:63], a[24:27], v[80:83]
    ds_read_b64_tr_b16 a[50:51], v4 offset:6656
    v_mfma_f32_16x16x32_bf16 v[84:87], a[60:63], a[28:31], v[84:87]
    ds_read_b128 a[8:11], v16 offset:36864
    s_waitcnt lgkmcnt(11)
    v_mfma_f32_16x16x32_bf16 v[88:91], a[32:35], a[16:19], v[88:91]
    ds_read_b128 a[12:15], v16 offset:38912
    v_mfma_f32_16x16x32_bf16 v[92:95], a[32:35], a[20:23], v[92:95]
    ds_read_b64_tr_b16 a[52:53], v4 offset:4160
    s_waitcnt lgkmcnt(11)
    v_mfma_f32_16x16x32_bf16 v[96:99], a[36:39], a[16:19], v[96:99]
    ds_read_b64_tr_b16 a[54:55], v4 offset:6720
    v_mfma_f32_16x16x32_bf16 v[100:103], a[36:39], a[20:23], v[100:103]
    ds_read_b64_tr_b16 a[56:57], v3 offset:4224
    v_mfma_f32_16x16x32_bf16 v[104:107], a[36:39], a[24:27], v[104:107]
    ds_read_b64_tr_b16 a[58:59], v3 offset:6784
    v_mfma_f32_16x16x32_bf16 v[108:111], a[36:39], a[28:31], v[108:111]
    ds_read_b64_tr_b16 a[60:61], v4 offset:22528
    s_waitcnt lgkmcnt(13)
    v_mfma_f32_16x16x32_bf16 v[112:115], a[40:43], a[16:19], v[112:115]
    ds_read_b64_tr_b16 a[62:63], v4 offset:25088
    v_mfma_f32_16x16x32_bf16 v[116:119], a[40:43], a[20:23], v[116:119]
    v_mfma_f32_16x16x32_bf16 v[120:123], a[40:43], a[24:27], v[120:123]
    v_mfma_f32_16x16x32_bf16 v[124:127], a[40:43], a[28:31], v[124:127]
    ds_read_b64_tr_b16 a[32:33], v4 offset:22592
    s_waitcnt lgkmcnt(13)
    v_mfma_f32_16x16x32_bf16 v[42:45], a[44:47], a[16:19], v[42:45]
    ds_read_b64_tr_b16 a[34:35], v4 offset:25152
    v_mfma_f32_16x16x32_bf16 v[46:49], a[44:47], a[20:23], v[46:49]
    s_waitcnt lgkmcnt(10)
    v_mfma_f32_16x16x32_bf16 v[56:59], a[48:51], a[0:3], v[56:59]
    v_mfma_f32_16x16x32_bf16 v[60:63], a[48:51], a[4:7], v[60:63]
    ds_read_b64_tr_b16 a[36:37], v3 offset:22656
    s_waitcnt lgkmcnt(10)
    v_mfma_f32_16x16x32_bf16 v[64:67], a[48:51], a[8:11], v[64:67]
    ds_read_b64_tr_b16 a[38:39], v3 offset:25216
    s_waitcnt lgkmcnt(10)
    v_mfma_f32_16x16x32_bf16 v[68:71], a[48:51], a[12:15], v[68:71]
    ds_read_b128 a[16:19], v15 offset:36864
    s_waitcnt lgkmcnt(9)
    v_mfma_f32_16x16x32_bf16 v[72:75], a[52:55], a[0:3], v[72:75]
    ds_read_b128 a[20:23], v15 offset:38912
    v_mfma_f32_16x16x32_bf16 v[76:79], a[52:55], a[4:7], v[76:79]
    ds_read_b64_tr_b16 a[40:41], v4 offset:13312
    v_mfma_f32_16x16x32_bf16 v[80:83], a[52:55], a[8:11], v[80:83]
    ds_read_b64_tr_b16 a[42:43], v4 offset:15872
    v_mfma_f32_16x16x32_bf16 v[84:87], a[52:55], a[12:15], v[84:87]
    ds_read_b128 a[24:27], v17 offset:36864
    s_waitcnt lgkmcnt(11)
    v_mfma_f32_16x16x32_bf16 v[88:91], a[56:59], a[0:3], v[88:91]
    ds_read_b128 a[28:31], v17 offset:38912
    v_mfma_f32_16x16x32_bf16 v[92:95], a[56:59], a[4:7], v[92:95]
    ds_read_b64_tr_b16 a[44:45], v4 offset:13376
    s_waitcnt lgkmcnt(11)
    v_mfma_f32_16x16x32_bf16 v[96:99], a[60:63], a[0:3], v[96:99]
    ds_read_b64_tr_b16 a[46:47], v4 offset:15936
    v_mfma_f32_16x16x32_bf16 v[100:103], a[60:63], a[4:7], v[100:103]
    ds_read_b64_tr_b16 a[48:49], v3 offset:13440
    v_mfma_f32_16x16x32_bf16 v[104:107], a[60:63], a[8:11], v[104:107]
    ds_read_b64_tr_b16 a[50:51], v3 offset:16000
    v_mfma_f32_16x16x32_bf16 v[108:111], a[60:63], a[12:15], v[108:111]
    ds_read_b64_tr_b16 a[52:53], v4 offset:31744
    s_waitcnt lgkmcnt(13)
    v_mfma_f32_16x16x32_bf16 v[112:115], a[32:35], a[0:3], v[112:115]
    ds_read_b64_tr_b16 a[54:55], v4 offset:34304
    v_mfma_f32_16x16x32_bf16 v[116:119], a[32:35], a[4:7], v[116:119]
    v_mfma_f32_16x16x32_bf16 v[120:123], a[32:35], a[8:11], v[120:123]
    v_mfma_f32_16x16x32_bf16 v[124:127], a[32:35], a[12:15], v[124:127]
    ds_read_b64_tr_b16 a[56:57], v4 offset:31808
    s_waitcnt lgkmcnt(13)
    v_mfma_f32_16x16x32_bf16 v[42:45], a[36:39], a[0:3], v[42:45]
    ds_read_b64_tr_b16 a[58:59], v4 offset:34368
    v_mfma_f32_16x16x32_bf16 v[46:49], a[36:39], a[4:7], v[46:49]
    s_waitcnt lgkmcnt(10)
    v_mfma_f32_16x16x32_bf16 v[56:59], a[40:43], a[16:19], v[56:59]
    v_mfma_f32_16x16x32_bf16 v[60:63], a[40:43], a[20:23], v[60:63]
    ds_read_b64_tr_b16 a[60:61], v3 offset:31872
    s_waitcnt lgkmcnt(10)
    v_mfma_f32_16x16x32_bf16 v[64:67], a[40:43], a[24:27], v[64:67]
    ds_read_b64_tr_b16 a[62:63], v3 offset:34432
    s_waitcnt lgkmcnt(10)
    v_mfma_f32_16x16x32_bf16 v[68:71], a[40:43], a[28:31], v[68:71]
    s_barrier
    v_add_u32 v3, -110592, v3
    v_add_u32 v4, -110592, v4
    v_add_u32 v14, -73728, v14
    v_add_u32 v15, -73728, v15
    v_add_u32 v16, -73728, v16
    v_add_u32 v17, -73728, v17
    ds_read_b128 a[0:3], v14 offset:0
    s_waitcnt lgkmcnt(9)
    v_mfma_f32_16x16x32_bf16 v[72:75], a[44:47], a[16:19], v[72:75]
    ds_read_b128 a[4:7], v14 offset:2048
    v_mfma_f32_16x16x32_bf16 v[76:79], a[44:47], a[20:23], v[76:79]
    ds_read_b64_tr_b16 a[32:33], v4 offset:4096
    v_mfma_f32_16x16x32_bf16 v[80:83], a[44:47], a[24:27], v[80:83]
    ds_read_b64_tr_b16 a[34:35], v4 offset:6656
    v_mfma_f32_16x16x32_bf16 v[84:87], a[44:47], a[28:31], v[84:87]
    ds_read_b128 a[8:11], v16 offset:0
    s_waitcnt lgkmcnt(11)
    v_mfma_f32_16x16x32_bf16 v[88:91], a[48:51], a[16:19], v[88:91]
    ds_read_b128 a[12:15], v16 offset:2048
    v_mfma_f32_16x16x32_bf16 v[92:95], a[48:51], a[20:23], v[92:95]
    ds_read_b64_tr_b16 a[36:37], v4 offset:4160
    s_waitcnt lgkmcnt(11)
    v_mfma_f32_16x16x32_bf16 v[96:99], a[52:55], a[16:19], v[96:99]
    ds_read_b64_tr_b16 a[38:39], v4 offset:6720
    v_mfma_f32_16x16x32_bf16 v[100:103], a[52:55], a[20:23], v[100:103]
    ds_read_b64_tr_b16 a[40:41], v3 offset:4224
    v_mfma_f32_16x16x32_bf16 v[104:107], a[52:55], a[24:27], v[104:107]
    ds_read_b64_tr_b16 a[42:43], v3 offset:6784
    v_mfma_f32_16x16x32_bf16 v[108:111], a[52:55], a[28:31], v[108:111]
    ds_read_b64_tr_b16 a[44:45], v4 offset:22528
    s_waitcnt lgkmcnt(13)
    v_mfma_f32_16x16x32_bf16 v[112:115], a[56:59], a[16:19], v[112:115]
    ds_read_b64_tr_b16 a[46:47], v4 offset:25088
    v_mfma_f32_16x16x32_bf16 v[116:119], a[56:59], a[20:23], v[116:119]
    v_mfma_f32_16x16x32_bf16 v[120:123], a[56:59], a[24:27], v[120:123]
    v_mfma_f32_16x16x32_bf16 v[124:127], a[56:59], a[28:31], v[124:127]
    ds_read_b64_tr_b16 a[48:49], v4 offset:22592
    s_waitcnt lgkmcnt(13)
    v_mfma_f32_16x16x32_bf16 v[42:45], a[60:63], a[16:19], v[42:45]
    ds_read_b64_tr_b16 a[50:51], v4 offset:25152
    v_mfma_f32_16x16x32_bf16 v[46:49], a[60:63], a[20:23], v[46:49]
    s_waitcnt lgkmcnt(10)
    v_mfma_f32_16x16x32_bf16 v[56:59], a[32:35], a[0:3], v[56:59]
    v_mfma_f32_16x16x32_bf16 v[60:63], a[32:35], a[4:7], v[60:63]
    ds_read_b64_tr_b16 a[52:53], v3 offset:22656
    s_waitcnt lgkmcnt(10)
    v_mfma_f32_16x16x32_bf16 v[64:67], a[32:35], a[8:11], v[64:67]
    ds_read_b64_tr_b16 a[54:55], v3 offset:25216
    s_waitcnt lgkmcnt(10)
    v_mfma_f32_16x16x32_bf16 v[68:71], a[32:35], a[12:15], v[68:71]
    ds_read_b128 a[16:19], v15 offset:0
    s_waitcnt lgkmcnt(9)
    v_mfma_f32_16x16x32_bf16 v[72:75], a[36:39], a[0:3], v[72:75]
    ds_read_b128 a[20:23], v15 offset:2048
    v_mfma_f32_16x16x32_bf16 v[76:79], a[36:39], a[4:7], v[76:79]
    ds_read_b64_tr_b16 a[56:57], v4 offset:13312
    v_mfma_f32_16x16x32_bf16 v[80:83], a[36:39], a[8:11], v[80:83]
    ds_read_b64_tr_b16 a[58:59], v4 offset:15872
    v_mfma_f32_16x16x32_bf16 v[84:87], a[36:39], a[12:15], v[84:87]
    ds_read_b128 a[24:27], v17 offset:0
    s_waitcnt lgkmcnt(11)
    v_mfma_f32_16x16x32_bf16 v[88:91], a[40:43], a[0:3], v[88:91]
    ds_read_b128 a[28:31], v17 offset:2048
    v_mfma_f32_16x16x32_bf16 v[92:95], a[40:43], a[4:7], v[92:95]
    ds_read_b64_tr_b16 a[60:61], v4 offset:13376
    s_waitcnt lgkmcnt(11)
    v_mfma_f32_16x16x32_bf16 v[96:99], a[44:47], a[0:3], v[96:99]
    ds_read_b64_tr_b16 a[62:63], v4 offset:15936
    v_mfma_f32_16x16x32_bf16 v[100:103], a[44:47], a[4:7], v[100:103]
    ds_read_b64_tr_b16 a[32:33], v3 offset:13440
    v_mfma_f32_16x16x32_bf16 v[104:107], a[44:47], a[8:11], v[104:107]
    ds_read_b64_tr_b16 a[34:35], v3 offset:16000
    v_mfma_f32_16x16x32_bf16 v[108:111], a[44:47], a[12:15], v[108:111]
    ds_read_b64_tr_b16 a[36:37], v4 offset:31744
    s_waitcnt lgkmcnt(13)
    v_mfma_f32_16x16x32_bf16 v[112:115], a[48:51], a[0:3], v[112:115]
    ds_read_b64_tr_b16 a[38:39], v4 offset:34304
    v_mfma_f32_16x16x32_bf16 v[116:119], a[48:51], a[4:7], v[116:119]
    v_mfma_f32_16x16x32_bf16 v[120:123], a[48:51], a[8:11], v[120:123]
    v_mfma_f32_16x16x32_bf16 v[124:127], a[48:51], a[12:15], v[124:127]
    ds_read_b64_tr_b16 a[40:41], v4 offset:31808
    s_waitcnt lgkmcnt(13)
    v_mfma_f32_16x16x32_bf16 v[42:45], a[52:55], a[0:3], v[42:45]
    ds_read_b64_tr_b16 a[42:43], v4 offset:34368
    v_mfma_f32_16x16x32_bf16 v[46:49], a[52:55], a[4:7], v[46:49]
    s_waitcnt lgkmcnt(10)
    v_mfma_f32_16x16x32_bf16 v[56:59], a[56:59], a[16:19], v[56:59]
    v_mfma_f32_16x16x32_bf16 v[60:63], a[56:59], a[20:23], v[60:63]
    ds_read_b64_tr_b16 a[44:45], v3 offset:31872
    s_waitcnt lgkmcnt(10)
    v_mfma_f32_16x16x32_bf16 v[64:67], a[56:59], a[24:27], v[64:67]
    ds_read_b64_tr_b16 a[46:47], v3 offset:34432
    s_waitcnt lgkmcnt(10)
    v_mfma_f32_16x16x32_bf16 v[68:71], a[56:59], a[28:31], v[68:71]
    s_barrier
    v_add_u32 v3, 36864, v3
    v_add_u32 v4, 36864, v4
    ds_read_b128 a[0:3], v14 offset:36864
    s_waitcnt lgkmcnt(9)
    v_mfma_f32_16x16x32_bf16 v[72:75], a[60:63], a[16:19], v[72:75]
    ds_read_b128 a[4:7], v14 offset:38912
    v_mfma_f32_16x16x32_bf16 v[76:79], a[60:63], a[20:23], v[76:79]
    ds_read_b64_tr_b16 a[48:49], v4 offset:4096
    v_mfma_f32_16x16x32_bf16 v[80:83], a[60:63], a[24:27], v[80:83]
    ds_read_b64_tr_b16 a[50:51], v4 offset:6656
    v_mfma_f32_16x16x32_bf16 v[84:87], a[60:63], a[28:31], v[84:87]
    ds_read_b128 a[8:11], v16 offset:36864
    s_waitcnt lgkmcnt(11)
    v_mfma_f32_16x16x32_bf16 v[88:91], a[32:35], a[16:19], v[88:91]
    ds_read_b128 a[12:15], v16 offset:38912
    v_mfma_f32_16x16x32_bf16 v[92:95], a[32:35], a[20:23], v[92:95]
    ds_read_b64_tr_b16 a[52:53], v4 offset:4160
    s_waitcnt lgkmcnt(11)
    v_mfma_f32_16x16x32_bf16 v[96:99], a[36:39], a[16:19], v[96:99]
    ds_read_b64_tr_b16 a[54:55], v4 offset:6720
    v_mfma_f32_16x16x32_bf16 v[100:103], a[36:39], a[20:23], v[100:103]
    ds_read_b64_tr_b16 a[56:57], v3 offset:4224
    v_mfma_f32_16x16x32_bf16 v[104:107], a[36:39], a[24:27], v[104:107]
    ds_read_b64_tr_b16 a[58:59], v3 offset:6784
    v_mfma_f32_16x16x32_bf16 v[108:111], a[36:39], a[28:31], v[108:111]
    ds_read_b64_tr_b16 a[60:61], v4 offset:22528
    s_waitcnt lgkmcnt(13)
    v_mfma_f32_16x16x32_bf16 v[112:115], a[40:43], a[16:19], v[112:115]
    ds_read_b64_tr_b16 a[62:63], v4 offset:25088
    v_mfma_f32_16x16x32_bf16 v[116:119], a[40:43], a[20:23], v[116:119]
    v_mfma_f32_16x16x32_bf16 v[120:123], a[40:43], a[24:27], v[120:123]
    v_mfma_f32_16x16x32_bf16 v[124:127], a[40:43], a[28:31], v[124:127]
    ds_read_b64_tr_b16 a[32:33], v4 offset:22592
    s_waitcnt lgkmcnt(13)
    v_mfma_f32_16x16x32_bf16 v[42:45], a[44:47], a[16:19], v[42:45]
    ds_read_b64_tr_b16 a[34:35], v4 offset:25152
    v_mfma_f32_16x16x32_bf16 v[46:49], a[44:47], a[20:23], v[46:49]
    s_waitcnt lgkmcnt(10)
    v_mfma_f32_16x16x32_bf16 v[56:59], a[48:51], a[0:3], v[56:59]
    v_mfma_f32_16x16x32_bf16 v[60:63], a[48:51], a[4:7], v[60:63]
    ds_read_b64_tr_b16 a[36:37], v3 offset:22656
    s_waitcnt lgkmcnt(10)
    v_mfma_f32_16x16x32_bf16 v[64:67], a[48:51], a[8:11], v[64:67]
    ds_read_b64_tr_b16 a[38:39], v3 offset:25216
    s_waitcnt lgkmcnt(10)
    v_mfma_f32_16x16x32_bf16 v[68:71], a[48:51], a[12:15], v[68:71]
    ds_read_b128 a[16:19], v15 offset:36864
    s_waitcnt lgkmcnt(9)
    v_mfma_f32_16x16x32_bf16 v[72:75], a[52:55], a[0:3], v[72:75]
    ds_read_b128 a[20:23], v15 offset:38912
    v_mfma_f32_16x16x32_bf16 v[76:79], a[52:55], a[4:7], v[76:79]
    ds_read_b64_tr_b16 a[40:41], v4 offset:13312
    v_mfma_f32_16x16x32_bf16 v[80:83], a[52:55], a[8:11], v[80:83]
    ds_read_b64_tr_b16 a[42:43], v4 offset:15872
    v_mfma_f32_16x16x32_bf16 v[84:87], a[52:55], a[12:15], v[84:87]
    ds_read_b128 a[24:27], v17 offset:36864
    s_waitcnt lgkmcnt(11)
    v_mfma_f32_16x16x32_bf16 v[88:91], a[56:59], a[0:3], v[88:91]
    ds_read_b128 a[28:31], v17 offset:38912
    v_mfma_f32_16x16x32_bf16 v[92:95], a[56:59], a[4:7], v[92:95]
    ds_read_b64_tr_b16 a[44:45], v4 offset:13376
    s_waitcnt lgkmcnt(11)
    v_mfma_f32_16x16x32_bf16 v[96:99], a[60:63], a[0:3], v[96:99]
    ds_read_b64_tr_b16 a[46:47], v4 offset:15936
    v_mfma_f32_16x16x32_bf16 v[100:103], a[60:63], a[4:7], v[100:103]
    ds_read_b64_tr_b16 a[48:49], v3 offset:13440
    v_mfma_f32_16x16x32_bf16 v[104:107], a[60:63], a[8:11], v[104:107]
    ds_read_b64_tr_b16 a[50:51], v3 offset:16000
    v_mfma_f32_16x16x32_bf16 v[108:111], a[60:63], a[12:15], v[108:111]
    ds_read_b64_tr_b16 a[52:53], v4 offset:31744
    s_waitcnt lgkmcnt(13)
    v_mfma_f32_16x16x32_bf16 v[112:115], a[32:35], a[0:3], v[112:115]
    ds_read_b64_tr_b16 a[54:55], v4 offset:34304
    v_mfma_f32_16x16x32_bf16 v[116:119], a[32:35], a[4:7], v[116:119]
    v_mfma_f32_16x16x32_bf16 v[120:123], a[32:35], a[8:11], v[120:123]
    v_mfma_f32_16x16x32_bf16 v[124:127], a[32:35], a[12:15], v[124:127]
    ds_read_b64_tr_b16 a[56:57], v4 offset:31808
    s_waitcnt lgkmcnt(13)
    v_mfma_f32_16x16x32_bf16 v[42:45], a[36:39], a[0:3], v[42:45]
    ds_read_b64_tr_b16 a[58:59], v4 offset:34368
    v_mfma_f32_16x16x32_bf16 v[46:49], a[36:39], a[4:7], v[46:49]
    s_waitcnt lgkmcnt(10)
    v_mfma_f32_16x16x32_bf16 v[56:59], a[40:43], a[16:19], v[56:59]
    v_mfma_f32_16x16x32_bf16 v[60:63], a[40:43], a[20:23], v[60:63]
    ds_read_b64_tr_b16 a[60:61], v3 offset:31872
    s_waitcnt lgkmcnt(10)
    v_mfma_f32_16x16x32_bf16 v[64:67], a[40:43], a[24:27], v[64:67]
    ds_read_b64_tr_b16 a[62:63], v3 offset:34432
    s_waitcnt lgkmcnt(10)
    v_mfma_f32_16x16x32_bf16 v[68:71], a[40:43], a[28:31], v[68:71]
    s_barrier
    v_add_u32 v3, 36864, v3
    v_add_u32 v4, 36864, v4
    v_add_u32 v14, 73728, v14
    v_add_u32 v15, 73728, v15
    v_add_u32 v16, 73728, v16
    v_add_u32 v17, 73728, v17
    ds_read_b128 a[0:3], v14 offset:0
    s_waitcnt lgkmcnt(9)
    v_mfma_f32_16x16x32_bf16 v[72:75], a[44:47], a[16:19], v[72:75]
    ds_read_b128 a[4:7], v14 offset:2048
    v_mfma_f32_16x16x32_bf16 v[76:79], a[44:47], a[20:23], v[76:79]
    ds_read_b64_tr_b16 a[32:33], v4 offset:4096
    v_mfma_f32_16x16x32_bf16 v[80:83], a[44:47], a[24:27], v[80:83]
    ds_read_b64_tr_b16 a[34:35], v4 offset:6656
    v_mfma_f32_16x16x32_bf16 v[84:87], a[44:47], a[28:31], v[84:87]
    ds_read_b128 a[8:11], v16 offset:0
    s_waitcnt lgkmcnt(11)
    v_mfma_f32_16x16x32_bf16 v[88:91], a[48:51], a[16:19], v[88:91]
    ds_read_b128 a[12:15], v16 offset:2048
    v_mfma_f32_16x16x32_bf16 v[92:95], a[48:51], a[20:23], v[92:95]
    ds_read_b64_tr_b16 a[36:37], v4 offset:4160
    s_waitcnt lgkmcnt(11)
    v_mfma_f32_16x16x32_bf16 v[96:99], a[52:55], a[16:19], v[96:99]
    ds_read_b64_tr_b16 a[38:39], v4 offset:6720
    v_mfma_f32_16x16x32_bf16 v[100:103], a[52:55], a[20:23], v[100:103]
    ds_read_b64_tr_b16 a[40:41], v3 offset:4224
    v_mfma_f32_16x16x32_bf16 v[104:107], a[52:55], a[24:27], v[104:107]
    ds_read_b64_tr_b16 a[42:43], v3 offset:6784
    v_mfma_f32_16x16x32_bf16 v[108:111], a[52:55], a[28:31], v[108:111]
    ds_read_b64_tr_b16 a[44:45], v4 offset:22528
    s_waitcnt lgkmcnt(13)
    v_mfma_f32_16x16x32_bf16 v[112:115], a[56:59], a[16:19], v[112:115]
    ds_read_b64_tr_b16 a[46:47], v4 offset:25088
    v_mfma_f32_16x16x32_bf16 v[116:119], a[56:59], a[20:23], v[116:119]
    v_mfma_f32_16x16x32_bf16 v[120:123], a[56:59], a[24:27], v[120:123]
    v_mfma_f32_16x16x32_bf16 v[124:127], a[56:59], a[28:31], v[124:127]
    ds_read_b64_tr_b16 a[48:49], v4 offset:22592
    s_waitcnt lgkmcnt(13)
    v_mfma_f32_16x16x32_bf16 v[42:45], a[60:63], a[16:19], v[42:45]
    ds_read_b64_tr_b16 a[50:51], v4 offset:25152
    v_mfma_f32_16x16x32_bf16 v[46:49], a[60:63], a[20:23], v[46:49]
    s_waitcnt lgkmcnt(10)
    v_mfma_f32_16x16x32_bf16 v[56:59], a[32:35], a[0:3], v[56:59]
    v_mfma_f32_16x16x32_bf16 v[60:63], a[32:35], a[4:7], v[60:63]
    ds_read_b64_tr_b16 a[52:53], v3 offset:22656
    s_waitcnt lgkmcnt(10)
    v_mfma_f32_16x16x32_bf16 v[64:67], a[32:35], a[8:11], v[64:67]
    ds_read_b64_tr_b16 a[54:55], v3 offset:25216
    s_waitcnt lgkmcnt(10)
    v_mfma_f32_16x16x32_bf16 v[68:71], a[32:35], a[12:15], v[68:71]
    ds_read_b128 a[16:19], v15 offset:0
    s_waitcnt lgkmcnt(9)
    v_mfma_f32_16x16x32_bf16 v[72:75], a[36:39], a[0:3], v[72:75]
    ds_read_b128 a[20:23], v15 offset:2048
    v_mfma_f32_16x16x32_bf16 v[76:79], a[36:39], a[4:7], v[76:79]
    ds_read_b64_tr_b16 a[56:57], v4 offset:13312
    v_mfma_f32_16x16x32_bf16 v[80:83], a[36:39], a[8:11], v[80:83]
    ds_read_b64_tr_b16 a[58:59], v4 offset:15872
    v_mfma_f32_16x16x32_bf16 v[84:87], a[36:39], a[12:15], v[84:87]
    ds_read_b128 a[24:27], v17 offset:0
    s_waitcnt lgkmcnt(11)
    v_mfma_f32_16x16x32_bf16 v[88:91], a[40:43], a[0:3], v[88:91]
    ds_read_b128 a[28:31], v17 offset:2048
    v_mfma_f32_16x16x32_bf16 v[92:95], a[40:43], a[4:7], v[92:95]
    ds_read_b64_tr_b16 a[60:61], v4 offset:13376
    s_waitcnt lgkmcnt(11)
    v_mfma_f32_16x16x32_bf16 v[96:99], a[44:47], a[0:3], v[96:99]
    ds_read_b64_tr_b16 a[62:63], v4 offset:15936
    v_mfma_f32_16x16x32_bf16 v[100:103], a[44:47], a[4:7], v[100:103]
    ds_read_b64_tr_b16 a[32:33], v3 offset:13440
    v_mfma_f32_16x16x32_bf16 v[104:107], a[44:47], a[8:11], v[104:107]
    ds_read_b64_tr_b16 a[34:35], v3 offset:16000
    v_mfma_f32_16x16x32_bf16 v[108:111], a[44:47], a[12:15], v[108:111]
    ds_read_b64_tr_b16 a[36:37], v4 offset:31744
    s_waitcnt lgkmcnt(13)
    v_mfma_f32_16x16x32_bf16 v[112:115], a[48:51], a[0:3], v[112:115]
    ds_read_b64_tr_b16 a[38:39], v4 offset:34304
    v_mfma_f32_16x16x32_bf16 v[116:119], a[48:51], a[4:7], v[116:119]
    v_mfma_f32_16x16x32_bf16 v[120:123], a[48:51], a[8:11], v[120:123]
    v_mfma_f32_16x16x32_bf16 v[124:127], a[48:51], a[12:15], v[124:127]
    ds_read_b64_tr_b16 a[40:41], v4 offset:31808
    s_waitcnt lgkmcnt(13)
    v_mfma_f32_16x16x32_bf16 v[42:45], a[52:55], a[0:3], v[42:45]
    ds_read_b64_tr_b16 a[42:43], v4 offset:34368
    v_mfma_f32_16x16x32_bf16 v[46:49], a[52:55], a[4:7], v[46:49]
    s_waitcnt lgkmcnt(10)
    v_mfma_f32_16x16x32_bf16 v[56:59], a[56:59], a[16:19], v[56:59]
    v_mfma_f32_16x16x32_bf16 v[60:63], a[56:59], a[20:23], v[60:63]
    ds_read_b64_tr_b16 a[44:45], v3 offset:31872
    s_waitcnt lgkmcnt(10)
    v_mfma_f32_16x16x32_bf16 v[64:67], a[56:59], a[24:27], v[64:67]
    ds_read_b64_tr_b16 a[46:47], v3 offset:34432
    s_waitcnt lgkmcnt(10)
    v_mfma_f32_16x16x32_bf16 v[68:71], a[56:59], a[28:31], v[68:71]
    s_barrier
    v_add_u32 v3, 36864, v3
    v_add_u32 v4, 36864, v4
    ds_read_b128 a[0:3], v14 offset:36864
    s_waitcnt lgkmcnt(9)
    v_mfma_f32_16x16x32_bf16 v[72:75], a[60:63], a[16:19], v[72:75]
    ds_read_b128 a[4:7], v14 offset:38912
    v_mfma_f32_16x16x32_bf16 v[76:79], a[60:63], a[20:23], v[76:79]
    ds_read_b64_tr_b16 a[48:49], v4 offset:4096
    v_mfma_f32_16x16x32_bf16 v[80:83], a[60:63], a[24:27], v[80:83]
    ds_read_b64_tr_b16 a[50:51], v4 offset:6656
    v_mfma_f32_16x16x32_bf16 v[84:87], a[60:63], a[28:31], v[84:87]
    ds_read_b128 a[8:11], v16 offset:36864
    s_waitcnt lgkmcnt(11)
    v_mfma_f32_16x16x32_bf16 v[88:91], a[32:35], a[16:19], v[88:91]
    ds_read_b128 a[12:15], v16 offset:38912
    v_mfma_f32_16x16x32_bf16 v[92:95], a[32:35], a[20:23], v[92:95]
    ds_read_b64_tr_b16 a[52:53], v4 offset:4160
    s_waitcnt lgkmcnt(11)
    v_mfma_f32_16x16x32_bf16 v[96:99], a[36:39], a[16:19], v[96:99]
    ds_read_b64_tr_b16 a[54:55], v4 offset:6720
    v_mfma_f32_16x16x32_bf16 v[100:103], a[36:39], a[20:23], v[100:103]
    ds_read_b64_tr_b16 a[56:57], v3 offset:4224
    v_mfma_f32_16x16x32_bf16 v[104:107], a[36:39], a[24:27], v[104:107]
    ds_read_b64_tr_b16 a[58:59], v3 offset:6784
    v_mfma_f32_16x16x32_bf16 v[108:111], a[36:39], a[28:31], v[108:111]
    ds_read_b64_tr_b16 a[60:61], v4 offset:22528
    s_waitcnt lgkmcnt(13)
    v_mfma_f32_16x16x32_bf16 v[112:115], a[40:43], a[16:19], v[112:115]
    ds_read_b64_tr_b16 a[62:63], v4 offset:25088
    v_mfma_f32_16x16x32_bf16 v[116:119], a[40:43], a[20:23], v[116:119]
    v_mfma_f32_16x16x32_bf16 v[120:123], a[40:43], a[24:27], v[120:123]
    v_mfma_f32_16x16x32_bf16 v[124:127], a[40:43], a[28:31], v[124:127]
    ds_read_b64_tr_b16 a[32:33], v4 offset:22592
    s_waitcnt lgkmcnt(13)
    v_mfma_f32_16x16x32_bf16 v[42:45], a[44:47], a[16:19], v[42:45]
    ds_read_b64_tr_b16 a[34:35], v4 offset:25152
    v_mfma_f32_16x16x32_bf16 v[46:49], a[44:47], a[20:23], v[46:49]
    s_waitcnt lgkmcnt(10)
    v_mfma_f32_16x16x32_bf16 v[56:59], a[48:51], a[0:3], v[56:59]
    v_mfma_f32_16x16x32_bf16 v[60:63], a[48:51], a[4:7], v[60:63]
    ds_read_b64_tr_b16 a[36:37], v3 offset:22656
    s_waitcnt lgkmcnt(10)
    v_mfma_f32_16x16x32_bf16 v[64:67], a[48:51], a[8:11], v[64:67]
    ds_read_b64_tr_b16 a[38:39], v3 offset:25216
    s_waitcnt lgkmcnt(10)
    v_mfma_f32_16x16x32_bf16 v[68:71], a[48:51], a[12:15], v[68:71]
    ds_read_b128 a[16:19], v15 offset:36864
    s_waitcnt lgkmcnt(9)
    v_mfma_f32_16x16x32_bf16 v[72:75], a[52:55], a[0:3], v[72:75]
    ds_read_b128 a[20:23], v15 offset:38912
    v_mfma_f32_16x16x32_bf16 v[76:79], a[52:55], a[4:7], v[76:79]
    ds_read_b64_tr_b16 a[40:41], v4 offset:13312
    v_mfma_f32_16x16x32_bf16 v[80:83], a[52:55], a[8:11], v[80:83]
    ds_read_b64_tr_b16 a[42:43], v4 offset:15872
    v_mfma_f32_16x16x32_bf16 v[84:87], a[52:55], a[12:15], v[84:87]
    ds_read_b128 a[24:27], v17 offset:36864
    s_waitcnt lgkmcnt(11)
    v_mfma_f32_16x16x32_bf16 v[88:91], a[56:59], a[0:3], v[88:91]
    ds_read_b128 a[28:31], v17 offset:38912
    v_mfma_f32_16x16x32_bf16 v[92:95], a[56:59], a[4:7], v[92:95]
    ds_read_b64_tr_b16 a[44:45], v4 offset:13376
    s_waitcnt lgkmcnt(11)
    v_mfma_f32_16x16x32_bf16 v[96:99], a[60:63], a[0:3], v[96:99]
    ds_read_b64_tr_b16 a[46:47], v4 offset:15936
    v_mfma_f32_16x16x32_bf16 v[100:103], a[60:63], a[4:7], v[100:103]
    ds_read_b64_tr_b16 a[48:49], v3 offset:13440
    v_mfma_f32_16x16x32_bf16 v[104:107], a[60:63], a[8:11], v[104:107]
    ds_read_b64_tr_b16 a[50:51], v3 offset:16000
    v_mfma_f32_16x16x32_bf16 v[108:111], a[60:63], a[12:15], v[108:111]
    ds_read_b64_tr_b16 a[52:53], v4 offset:31744
    s_waitcnt lgkmcnt(13)
    v_mfma_f32_16x16x32_bf16 v[112:115], a[32:35], a[0:3], v[112:115]
    ds_read_b64_tr_b16 a[54:55], v4 offset:34304
    v_mfma_f32_16x16x32_bf16 v[116:119], a[32:35], a[4:7], v[116:119]
    v_mfma_f32_16x16x32_bf16 v[120:123], a[32:35], a[8:11], v[120:123]
    v_mfma_f32_16x16x32_bf16 v[124:127], a[32:35], a[12:15], v[124:127]
    ds_read_b64_tr_b16 a[56:57], v4 offset:31808
    s_waitcnt lgkmcnt(13)
    v_mfma_f32_16x16x32_bf16 v[42:45], a[36:39], a[0:3], v[42:45]
    ds_read_b64_tr_b16 a[58:59], v4 offset:34368
    v_mfma_f32_16x16x32_bf16 v[46:49], a[36:39], a[4:7], v[46:49]
    s_waitcnt lgkmcnt(10)
    v_mfma_f32_16x16x32_bf16 v[56:59], a[40:43], a[16:19], v[56:59]
    v_mfma_f32_16x16x32_bf16 v[60:63], a[40:43], a[20:23], v[60:63]
    ds_read_b64_tr_b16 a[60:61], v3 offset:31872
    s_waitcnt lgkmcnt(10)
    v_mfma_f32_16x16x32_bf16 v[64:67], a[40:43], a[24:27], v[64:67]
    ds_read_b64_tr_b16 a[62:63], v3 offset:34432
    s_waitcnt lgkmcnt(10)
    v_mfma_f32_16x16x32_bf16 v[68:71], a[40:43], a[28:31], v[68:71]
    s_barrier
    v_add_u32 v3, -110592, v3
    v_add_u32 v4, -110592, v4
    v_add_u32 v14, -73728, v14
    v_add_u32 v15, -73728, v15
    v_add_u32 v16, -73728, v16
    v_add_u32 v17, -73728, v17
    ds_read_b128 a[0:3], v14 offset:0
    s_waitcnt lgkmcnt(9)
    v_mfma_f32_16x16x32_bf16 v[72:75], a[44:47], a[16:19], v[72:75]
    ds_read_b128 a[4:7], v14 offset:2048
    v_mfma_f32_16x16x32_bf16 v[76:79], a[44:47], a[20:23], v[76:79]
    ds_read_b64_tr_b16 a[32:33], v4 offset:4096
    v_mfma_f32_16x16x32_bf16 v[80:83], a[44:47], a[24:27], v[80:83]
    ds_read_b64_tr_b16 a[34:35], v4 offset:6656
    v_mfma_f32_16x16x32_bf16 v[84:87], a[44:47], a[28:31], v[84:87]
    ds_read_b128 a[8:11], v16 offset:0
    s_waitcnt lgkmcnt(11)
    v_mfma_f32_16x16x32_bf16 v[88:91], a[48:51], a[16:19], v[88:91]
    ds_read_b128 a[12:15], v16 offset:2048
    v_mfma_f32_16x16x32_bf16 v[92:95], a[48:51], a[20:23], v[92:95]
    ds_read_b64_tr_b16 a[36:37], v4 offset:4160
    s_waitcnt lgkmcnt(11)
    v_mfma_f32_16x16x32_bf16 v[96:99], a[52:55], a[16:19], v[96:99]
    ds_read_b64_tr_b16 a[38:39], v4 offset:6720
    v_mfma_f32_16x16x32_bf16 v[100:103], a[52:55], a[20:23], v[100:103]
    ds_read_b64_tr_b16 a[40:41], v3 offset:4224
    v_mfma_f32_16x16x32_bf16 v[104:107], a[52:55], a[24:27], v[104:107]
    ds_read_b64_tr_b16 a[42:43], v3 offset:6784
    v_mfma_f32_16x16x32_bf16 v[108:111], a[52:55], a[28:31], v[108:111]
    ds_read_b64_tr_b16 a[44:45], v4 offset:22528
    s_waitcnt lgkmcnt(13)
    v_mfma_f32_16x16x32_bf16 v[112:115], a[56:59], a[16:19], v[112:115]
    ds_read_b64_tr_b16 a[46:47], v4 offset:25088
    v_mfma_f32_16x16x32_bf16 v[116:119], a[56:59], a[20:23], v[116:119]
    v_mfma_f32_16x16x32_bf16 v[120:123], a[56:59], a[24:27], v[120:123]
    v_mfma_f32_16x16x32_bf16 v[124:127], a[56:59], a[28:31], v[124:127]
    ds_read_b64_tr_b16 a[48:49], v4 offset:22592
    s_waitcnt lgkmcnt(13)
    v_mfma_f32_16x16x32_bf16 v[42:45], a[60:63], a[16:19], v[42:45]
    ds_read_b64_tr_b16 a[50:51], v4 offset:25152
    v_mfma_f32_16x16x32_bf16 v[46:49], a[60:63], a[20:23], v[46:49]
    s_waitcnt lgkmcnt(10)
    v_mfma_f32_16x16x32_bf16 v[56:59], a[32:35], a[0:3], v[56:59]
    v_mfma_f32_16x16x32_bf16 v[60:63], a[32:35], a[4:7], v[60:63]
    ds_read_b64_tr_b16 a[52:53], v3 offset:22656
    s_waitcnt lgkmcnt(10)
    v_mfma_f32_16x16x32_bf16 v[64:67], a[32:35], a[8:11], v[64:67]
    ds_read_b64_tr_b16 a[54:55], v3 offset:25216
    s_waitcnt lgkmcnt(10)
    v_mfma_f32_16x16x32_bf16 v[68:71], a[32:35], a[12:15], v[68:71]
    ds_read_b128 a[16:19], v15 offset:0
    s_waitcnt lgkmcnt(9)
    v_mfma_f32_16x16x32_bf16 v[72:75], a[36:39], a[0:3], v[72:75]
    ds_read_b128 a[20:23], v15 offset:2048
    v_mfma_f32_16x16x32_bf16 v[76:79], a[36:39], a[4:7], v[76:79]
    ds_read_b64_tr_b16 a[56:57], v4 offset:13312
    v_mfma_f32_16x16x32_bf16 v[80:83], a[36:39], a[8:11], v[80:83]
    ds_read_b64_tr_b16 a[58:59], v4 offset:15872
    v_mfma_f32_16x16x32_bf16 v[84:87], a[36:39], a[12:15], v[84:87]
    ds_read_b128 a[24:27], v17 offset:0
    s_waitcnt lgkmcnt(11)
    v_mfma_f32_16x16x32_bf16 v[88:91], a[40:43], a[0:3], v[88:91]
    ds_read_b128 a[28:31], v17 offset:2048
    v_mfma_f32_16x16x32_bf16 v[92:95], a[40:43], a[4:7], v[92:95]
    ds_read_b64_tr_b16 a[60:61], v4 offset:13376
    s_waitcnt lgkmcnt(11)
    v_mfma_f32_16x16x32_bf16 v[96:99], a[44:47], a[0:3], v[96:99]
    ds_read_b64_tr_b16 a[62:63], v4 offset:15936
    v_mfma_f32_16x16x32_bf16 v[100:103], a[44:47], a[4:7], v[100:103]
    ds_read_b64_tr_b16 a[32:33], v3 offset:13440
    v_mfma_f32_16x16x32_bf16 v[104:107], a[44:47], a[8:11], v[104:107]
    ds_read_b64_tr_b16 a[34:35], v3 offset:16000
    v_mfma_f32_16x16x32_bf16 v[108:111], a[44:47], a[12:15], v[108:111]
    ds_read_b64_tr_b16 a[36:37], v4 offset:31744
    s_waitcnt lgkmcnt(13)
    v_mfma_f32_16x16x32_bf16 v[112:115], a[48:51], a[0:3], v[112:115]
    ds_read_b64_tr_b16 a[38:39], v4 offset:34304
    v_mfma_f32_16x16x32_bf16 v[116:119], a[48:51], a[4:7], v[116:119]
    v_mfma_f32_16x16x32_bf16 v[120:123], a[48:51], a[8:11], v[120:123]
    v_mfma_f32_16x16x32_bf16 v[124:127], a[48:51], a[12:15], v[124:127]
    ds_read_b64_tr_b16 a[40:41], v4 offset:31808
    s_waitcnt lgkmcnt(13)
    v_mfma_f32_16x16x32_bf16 v[42:45], a[52:55], a[0:3], v[42:45]
    ds_read_b64_tr_b16 a[42:43], v4 offset:34368
    v_mfma_f32_16x16x32_bf16 v[46:49], a[52:55], a[4:7], v[46:49]
    s_waitcnt lgkmcnt(10)
    v_mfma_f32_16x16x32_bf16 v[56:59], a[56:59], a[16:19], v[56:59]
    v_mfma_f32_16x16x32_bf16 v[60:63], a[56:59], a[20:23], v[60:63]
    ds_read_b64_tr_b16 a[44:45], v3 offset:31872
    s_waitcnt lgkmcnt(10)
    v_mfma_f32_16x16x32_bf16 v[64:67], a[56:59], a[24:27], v[64:67]
    ds_read_b64_tr_b16 a[46:47], v3 offset:34432
    s_waitcnt lgkmcnt(10)
    v_mfma_f32_16x16x32_bf16 v[68:71], a[56:59], a[28:31], v[68:71]
    s_waitcnt lgkmcnt(0)
    s_barrier
    v_add_u32 v3, 36864, v3
    v_add_u32 v4, 36864, v4
    ds_read_b128 a[0:3], v14 offset:36864
    v_mfma_f32_16x16x32_bf16 v[72:75], a[60:63], a[16:19], v[72:75]
    ds_read_b128 a[4:7], v14 offset:38912
    v_mfma_f32_16x16x32_bf16 v[76:79], a[60:63], a[20:23], v[76:79]
    ds_read_b64_tr_b16 a[48:49], v4 offset:4096
    v_mfma_f32_16x16x32_bf16 v[80:83], a[60:63], a[24:27], v[80:83]
    ds_read_b64_tr_b16 a[50:51], v4 offset:6656
    v_mfma_f32_16x16x32_bf16 v[84:87], a[60:63], a[28:31], v[84:87]
    ds_read_b128 a[8:11], v16 offset:36864
    v_mfma_f32_16x16x32_bf16 v[88:91], a[32:35], a[16:19], v[88:91]
    ds_read_b128 a[12:15], v16 offset:38912
    v_mfma_f32_16x16x32_bf16 v[92:95], a[32:35], a[20:23], v[92:95]
    ds_read_b64_tr_b16 a[52:53], v4 offset:4160
    v_mfma_f32_16x16x32_bf16 v[96:99], a[36:39], a[16:19], v[96:99]
    ds_read_b64_tr_b16 a[54:55], v4 offset:6720
    v_mfma_f32_16x16x32_bf16 v[100:103], a[36:39], a[20:23], v[100:103]
    ds_read_b64_tr_b16 a[56:57], v3 offset:4224
    v_mfma_f32_16x16x32_bf16 v[104:107], a[36:39], a[24:27], v[104:107]
    ds_read_b64_tr_b16 a[58:59], v3 offset:6784
    v_mfma_f32_16x16x32_bf16 v[108:111], a[36:39], a[28:31], v[108:111]
    ds_read_b64_tr_b16 a[60:61], v4 offset:22528
    v_mfma_f32_16x16x32_bf16 v[112:115], a[40:43], a[16:19], v[112:115]
    ds_read_b64_tr_b16 a[62:63], v4 offset:25088
    v_mfma_f32_16x16x32_bf16 v[116:119], a[40:43], a[20:23], v[116:119]
    v_mfma_f32_16x16x32_bf16 v[120:123], a[40:43], a[24:27], v[120:123]
    v_mfma_f32_16x16x32_bf16 v[124:127], a[40:43], a[28:31], v[124:127]
    ds_read_b64_tr_b16 a[32:33], v4 offset:22592
    v_mfma_f32_16x16x32_bf16 v[42:45], a[44:47], a[16:19], v[42:45]
    ds_read_b64_tr_b16 a[34:35], v4 offset:25152
    v_mfma_f32_16x16x32_bf16 v[46:49], a[44:47], a[20:23], v[46:49]
    s_waitcnt lgkmcnt(10)
    v_mfma_f32_16x16x32_bf16 v[56:59], a[48:51], a[0:3], v[56:59]
    v_mfma_f32_16x16x32_bf16 v[60:63], a[48:51], a[4:7], v[60:63]
    ds_read_b64_tr_b16 a[36:37], v3 offset:22656
    s_waitcnt lgkmcnt(10)
    v_mfma_f32_16x16x32_bf16 v[64:67], a[48:51], a[8:11], v[64:67]
    ds_read_b64_tr_b16 a[38:39], v3 offset:25216
    s_waitcnt lgkmcnt(10)
    v_mfma_f32_16x16x32_bf16 v[68:71], a[48:51], a[12:15], v[68:71]
    ds_read_b128 a[16:19], v15 offset:36864
    s_waitcnt lgkmcnt(9)
    v_mfma_f32_16x16x32_bf16 v[72:75], a[52:55], a[0:3], v[72:75]
    ds_read_b128 a[20:23], v15 offset:38912
    v_mfma_f32_16x16x32_bf16 v[76:79], a[52:55], a[4:7], v[76:79]
    ds_read_b64_tr_b16 a[40:41], v4 offset:13312
    v_mfma_f32_16x16x32_bf16 v[80:83], a[52:55], a[8:11], v[80:83]
    ds_read_b64_tr_b16 a[42:43], v4 offset:15872
    v_mfma_f32_16x16x32_bf16 v[84:87], a[52:55], a[12:15], v[84:87]
    ds_read_b128 a[24:27], v17 offset:36864
    s_waitcnt lgkmcnt(11)
    v_mfma_f32_16x16x32_bf16 v[88:91], a[56:59], a[0:3], v[88:91]
    ds_read_b128 a[28:31], v17 offset:38912
    v_mfma_f32_16x16x32_bf16 v[92:95], a[56:59], a[4:7], v[92:95]
    ds_read_b64_tr_b16 a[44:45], v4 offset:13376
    s_waitcnt lgkmcnt(11)
    v_mfma_f32_16x16x32_bf16 v[96:99], a[60:63], a[0:3], v[96:99]
    ds_read_b64_tr_b16 a[46:47], v4 offset:15936
    v_mfma_f32_16x16x32_bf16 v[100:103], a[60:63], a[4:7], v[100:103]
    ds_read_b64_tr_b16 a[48:49], v3 offset:13440
    v_mfma_f32_16x16x32_bf16 v[104:107], a[60:63], a[8:11], v[104:107]
    ds_read_b64_tr_b16 a[50:51], v3 offset:16000
    v_mfma_f32_16x16x32_bf16 v[108:111], a[60:63], a[12:15], v[108:111]
    ds_read_b64_tr_b16 a[52:53], v4 offset:31744
    s_waitcnt lgkmcnt(13)
    v_mfma_f32_16x16x32_bf16 v[112:115], a[32:35], a[0:3], v[112:115]
    ds_read_b64_tr_b16 a[54:55], v4 offset:34304
    v_mfma_f32_16x16x32_bf16 v[116:119], a[32:35], a[4:7], v[116:119]
    v_mfma_f32_16x16x32_bf16 v[120:123], a[32:35], a[8:11], v[120:123]
    v_mfma_f32_16x16x32_bf16 v[124:127], a[32:35], a[12:15], v[124:127]
    ds_read_b64_tr_b16 a[56:57], v4 offset:31808
    s_waitcnt lgkmcnt(13)
    v_mfma_f32_16x16x32_bf16 v[42:45], a[36:39], a[0:3], v[42:45]
    ds_read_b64_tr_b16 a[58:59], v4 offset:34368
    v_mfma_f32_16x16x32_bf16 v[46:49], a[36:39], a[4:7], v[46:49]
    s_waitcnt lgkmcnt(10)
    v_mfma_f32_16x16x32_bf16 v[56:59], a[40:43], a[16:19], v[56:59]
    v_mfma_f32_16x16x32_bf16 v[60:63], a[40:43], a[20:23], v[60:63]
    ds_read_b64_tr_b16 a[60:61], v3 offset:31872
    s_waitcnt lgkmcnt(10)
    v_mfma_f32_16x16x32_bf16 v[64:67], a[40:43], a[24:27], v[64:67]
    ds_read_b64_tr_b16 a[62:63], v3 offset:34432
    s_waitcnt lgkmcnt(10)
    v_mfma_f32_16x16x32_bf16 v[68:71], a[40:43], a[28:31], v[68:71]
    s_waitcnt lgkmcnt(8)
    v_mfma_f32_16x16x32_bf16 v[72:75], a[44:47], a[16:19], v[72:75]
    v_mfma_f32_16x16x32_bf16 v[76:79], a[44:47], a[20:23], v[76:79]
    v_mfma_f32_16x16x32_bf16 v[80:83], a[44:47], a[24:27], v[80:83]
    v_mfma_f32_16x16x32_bf16 v[84:87], a[44:47], a[28:31], v[84:87]
    s_waitcnt lgkmcnt(6)
    v_mfma_f32_16x16x32_bf16 v[88:91], a[48:51], a[16:19], v[88:91]
    v_mfma_f32_16x16x32_bf16 v[92:95], a[48:51], a[20:23], v[92:95]
    s_cmp_eq_u32 s48, 0
    s_cbranch_scc0 L_Ba
    s_waitcnt lgkmcnt(4)
    v_mfma_f32_16x16x32_bf16 v[96:99], a[52:55], a[16:19], v[96:99]
    v_cvt_pk_bf16_f32 v56, v56, v57
    v_cvt_pk_bf16_f32 v57, v58, v59
    ds_write_b64 v34, v[56:57] offset:0
    v_mfma_f32_16x16x32_bf16 v[100:103], a[52:55], a[20:23], v[100:103]
    v_cvt_pk_bf16_f32 v60, v60, v61
    v_cvt_pk_bf16_f32 v61, v62, v63
    ds_write_b64 v34, v[60:61] offset:640
    v_mfma_f32_16x16x32_bf16 v[104:107], a[52:55], a[24:27], v[104:107]
    v_cvt_pk_bf16_f32 v64, v64, v65
    v_cvt_pk_bf16_f32 v65, v66, v67
    ds_write_b64 v35, v[64:65] offset:0
    v_mfma_f32_16x16x32_bf16 v[108:111], a[52:55], a[28:31], v[108:111]
    v_cvt_pk_bf16_f32 v68, v68, v69
    v_cvt_pk_bf16_f32 v69, v70, v71
    ds_write_b64 v35, v[68:69] offset:640
    s_waitcnt lgkmcnt(6)
    v_mfma_f32_16x16x32_bf16 v[112:115], a[56:59], a[16:19], v[112:115]
    v_cvt_pk_bf16_f32 v72, v72, v73
    v_cvt_pk_bf16_f32 v73, v74, v75
    ds_write_b64 v36, v[72:73] offset:0
    v_mfma_f32_16x16x32_bf16 v[116:119], a[56:59], a[20:23], v[116:119]
    v_cvt_pk_bf16_f32 v76, v76, v77
    v_cvt_pk_bf16_f32 v77, v78, v79
    ds_write_b64 v36, v[76:77] offset:640
    v_mfma_f32_16x16x32_bf16 v[120:123], a[56:59], a[24:27], v[120:123]
    v_cvt_pk_bf16_f32 v80, v80, v81
    v_cvt_pk_bf16_f32 v81, v82, v83
    ds_write_b64 v37, v[80:81] offset:0
    v_mfma_f32_16x16x32_bf16 v[124:127], a[56:59], a[28:31], v[124:127]
    v_cvt_pk_bf16_f32 v84, v84, v85
    v_cvt_pk_bf16_f32 v85, v86, v87
    ds_write_b64 v37, v[84:85] offset:640
    s_waitcnt lgkmcnt(8)
    v_mfma_f32_16x16x32_bf16 v[42:45], a[60:63], a[16:19], v[42:45]
    v_cvt_pk_bf16_f32 v88, v88, v89
    v_cvt_pk_bf16_f32 v89, v90, v91
    ds_write_b64 v38, v[88:89] offset:0
    v_mfma_f32_16x16x32_bf16 v[46:49], a[60:63], a[20:23], v[46:49]
    v_cvt_pk_bf16_f32 v92, v92, v93
    v_cvt_pk_bf16_f32 v93, v94, v95
    ds_write_b64 v38, v[92:93] offset:640
    s_waitcnt lgkmcnt(0)
    s_barrier
    v_cvt_pk_bf16_f32 v96, v96, v97
    v_cvt_pk_bf16_f32 v97, v98, v99
    ds_write_b64 v34, v[96:97] offset:20480
    v_cvt_pk_bf16_f32 v100, v100, v101
    v_cvt_pk_bf16_f32 v101, v102, v103
    ds_write_b64 v34, v[100:101] offset:21120
    v_cvt_pk_bf16_f32 v104, v104, v105
    v_cvt_pk_bf16_f32 v105, v106, v107
    ds_write_b64 v35, v[104:105] offset:20480
    v_cvt_pk_bf16_f32 v108, v108, v109
    v_cvt_pk_bf16_f32 v109, v110, v111
    ds_write_b64 v35, v[108:109] offset:21120
    v_cvt_pk_bf16_f32 v112, v112, v113
    v_cvt_pk_bf16_f32 v113, v114, v115
    ds_write_b64 v36, v[112:113] offset:20480
    v_cvt_pk_bf16_f32 v116, v116, v117
    v_cvt_pk_bf16_f32 v117, v118, v119
    ds_write_b64 v36, v[116:117] offset:21120
    v_cvt_pk_bf16_f32 v120, v120, v121
    v_cvt_pk_bf16_f32 v121, v122, v123
    ds_write_b64 v37, v[120:121] offset:20480
    v_cvt_pk_bf16_f32 v124, v124, v125
    v_cvt_pk_bf16_f32 v125, v126, v127
    ds_write_b64 v37, v[124:125] offset:21120
    v_cvt_pk_bf16_f32 v42, v42, v43
    v_cvt_pk_bf16_f32 v43, v44, v45
    ds_write_b64 v38, v[42:43] offset:20480
    v_cvt_pk_bf16_f32 v46, v46, v47
    v_cvt_pk_bf16_f32 v47, v48, v49
    ds_write_b64 v38, v[46:47] offset:21120
    v_mov_b32 v120, -1
    v_mov_b32 v121, -1
    v_mov_b32 v122, -1
    v_mov_b32 v123, -1
    buffer_store_dwordx4 v[120:123], v54, s[32:35], s60 offen sc1
    ds_read_b64 v[96:97], v8 offset:0
    ds_read_b64 v[98:99], v8 offset:512
    ds_read_b64 v[100:101], v8 offset:1024
    ds_read_b64 v[102:103], v5 offset:0
    ds_read_b64 v[104:105], v5 offset:8
    ds_read_b64 v[106:107], v6 offset:0
    ds_read_b64 v[108:109], v8 offset:1536
    ds_read_b64 v[110:111], v8 offset:2048
    ds_read_b64 v[112:113], v8 offset:2560
    ds_read_b64 v[114:115], v5 offset:5120
    ds_read_b64 v[116:117], v5 offset:5128
    ds_read_b64 v[118:119], v6 offset:5120
    s_waitcnt lgkmcnt(7)
    v_mfma_f32_32x32x16_bf16 v[56:71], v[96:99], v[102:105], 0
    s_waitcnt lgkmcnt(6)
    v_mfma_f32_32x32x8_bf16 v[56:71], v[100:101], v[106:107], v[56:71]
    s_waitcnt lgkmcnt(1)
    v_mfma_f32_32x32x16_bf16 v[72:87], v[108:111], v[114:117], 0
    s_waitcnt lgkmcnt(0)
    v_mfma_f32_32x32x8_bf16 v[72:87], v[112:113], v[118:119], v[72:87]
    s_nop 7
    v_exp_f32 v96, v56
    v_and_b32 v126, 31, v1
    v_lshlrev_b32 v126, 2, v126
    buffer_load_dword v124, v126, s[32:35], s68 offen offset:512 sc1
    v_and_b32 v126, 12, v126
    s_lshl_b32 s58, s48, 4
    buffer_load_dword v125, v126, s[44:47], s58 offen sc1
    v_exp_f32_e64 v56, -v56
    v_exp_f32 v97, v57
    v_exp_f32_e64 v57, -v57
    v_exp_f32 v98, v58
    v_exp_f32_e64 v58, -v58
    v_exp_f32 v99, v59
    v_exp_f32_e64 v59, -v59
    s_add_u32 m0, s55, 20480
    s_bfe_u32 s56, s71, 0x40000
    s_mul_i32 s56, s56, 245760
    s_add_u32 s56, s56, s54
    v_exp_f32 v100, v60
    v_exp_f32_e64 v60, -v60
    v_exp_f32 v101, v61
    v_exp_f32_e64 v61, -v61
    v_exp_f32 v102, v62
    v_exp_f32_e64 v62, -v62
    v_exp_f32 v103, v63
    v_exp_f32_e64 v63, -v63
    buffer_load_dwordx4 v18, s[24:27], s56 offen offset:0 lds
    v_exp_f32 v104, v64
    v_exp_f32_e64 v64, -v64
    v_exp_f32 v105, v65
    v_exp_f32_e64 v65, -v65
    v_pk_add_f32 v[66:67], v[96:97], v[98:99]
    v_pk_add_f32 v[68:69], v[56:57], v[58:59]
    v_pk_add_f32 v[66:67], v[66:67], v[100:101]
    buffer_load_dwordx4 v19, s[24:27], s56 offen offset:1024 lds
    v_pk_add_f32 v[68:69], v[68:69], v[60:61]
    v_pk_add_f32 v[66:67], v[66:67], v[102:103]
    v_pk_add_f32 v[68:69], v[68:69], v[62:63]
    v_pk_add_f32 v[66:67], v[66:67], v[104:105]
    v_pk_add_f32 v[68:69], v[68:69], v[64:65]
    v_add_f32 v66, v66, v67
    v_add_f32 v68, v68, v69
    s_nop 1
    v_permlane32_swap_b32 v66, v68
    buffer_load_dwordx4 v20, s[24:27], s56 offen offset:2048 lds
    v_add_f32 v66, v66, v68
    v_cmp_ngt_f32 vcc, 0x56800000, v66
    v_rcp_f32 v66, v66
    s_cbranch_vccnz L_k0Aa_max
L_k0Aa_sum:
    v_mov_b32 v68, v66
    s_nop 1
    v_permlane32_swap_b32 v66, v68
    v_pk_mul_f32 v[96:97], v[96:97], v[66:67] op_sel_hi:[1,0]
    v_pk_mul_f32 v[56:57], v[56:57], v[68:69] op_sel_hi:[1,0]
    v_pk_mul_f32 v[98:99], v[98:99], v[66:67] op_sel_hi:[1,0]
    buffer_load_dwordx4 v21, s[24:27], s56 offen offset:3072 lds
    v_pk_mul_f32 v[58:59], v[58:59], v[68:69] op_sel_hi:[1,0]
    v_pk_mul_f32 v[100:101], v[100:101], v[66:67] op_sel_hi:[1,0]
    v_pk_mul_f32 v[60:61], v[60:61], v[68:69] op_sel_hi:[1,0]
    v_pk_mul_f32 v[102:103], v[102:103], v[66:67] op_sel_hi:[1,0]
    v_pk_mul_f32 v[62:63], v[62:63], v[68:69] op_sel_hi:[1,0]
    v_pk_mul_f32 v[104:105], v[104:105], v[66:67] op_sel_hi:[1,0]
    v_pk_mul_f32 v[64:65], v[64:65], v[68:69] op_sel_hi:[1,0]
    v_cvt_pk_bf16_f32 v96, v96, v97
    s_add_u32 m0, s55, 24576
    v_cvt_pk_bf16_f32 v97, v98, v99
    v_cvt_pk_bf16_f32 v98, v100, v101
    v_cvt_pk_bf16_f32 v99, v102, v103
    v_cvt_pk_bf16_f32 v100, v104, v105
    v_cvt_pk_bf16_f32 v101, v56, v57
    v_cvt_pk_bf16_f32 v102, v58, v59
    v_cvt_pk_bf16_f32 v103, v60, v61
    buffer_load_dwordx4 v22, s[24:27], s56 offen lds
    v_cvt_pk_bf16_f32 v104, v62, v63
    v_cvt_pk_bf16_f32 v105, v64, v65
    ds_write_b64 v39, v[96:97] offset:0
    ds_write_b64 v39, v[98:99] offset:8
    ds_write_b64 v39, v[100:101] offset:16
    ds_write_b64 v39, v[102:103] offset:24
    ds_write_b64 v39, v[104:105] offset:32
    v_exp_f32 v108, v72
    s_add_u32 m0, s55, 40960
    s_bfe_u32 s56, s71, 0x40010
    s_mul_i32 s56, s56, 245760
    s_add_u32 s56, s56, s54
    v_exp_f32_e64 v72, -v72
    v_exp_f32 v109, v73
    v_exp_f32_e64 v73, -v73
    v_exp_f32 v110, v74
    v_exp_f32_e64 v74, -v74
    v_exp_f32 v111, v75
    v_exp_f32_e64 v75, -v75
    v_exp_f32 v112, v76
    buffer_load_dwordx4 v18, s[24:27], s56 offen offset:0 lds
    v_exp_f32_e64 v76, -v76
    v_exp_f32 v113, v77
    v_exp_f32_e64 v77, -v77
    v_exp_f32 v114, v78
    v_exp_f32_e64 v78, -v78
    v_exp_f32 v115, v79
    v_exp_f32_e64 v79, -v79
    v_exp_f32 v116, v80
    v_exp_f32_e64 v80, -v80
    buffer_load_dwordx4 v19, s[24:27], s56 offen offset:1024 lds
    v_exp_f32 v117, v81
    v_exp_f32_e64 v81, -v81
    v_pk_add_f32 v[82:83], v[108:109], v[110:111]
    v_pk_add_f32 v[84:85], v[72:73], v[74:75]
    v_pk_add_f32 v[82:83], v[82:83], v[112:113]
    v_pk_add_f32 v[84:85], v[84:85], v[76:77]
    v_pk_add_f32 v[82:83], v[82:83], v[114:115]
    v_pk_add_f32 v[84:85], v[84:85], v[78:79]
    buffer_load_dwordx4 v20, s[24:27], s56 offen offset:2048 lds
    v_pk_add_f32 v[82:83], v[82:83], v[116:117]
    v_pk_add_f32 v[84:85], v[84:85], v[80:81]
    v_add_f32 v82, v82, v83
    v_add_f32 v84, v84, v85
    s_nop 1
    v_permlane32_swap_b32 v82, v84
    v_add_f32 v82, v82, v84
    v_cmp_ngt_f32 vcc, 0x56800000, v82
    v_rcp_f32 v82, v82
    s_cbranch_vccnz L_k1Aa_max
L_k1Aa_sum:
    v_mov_b32 v84, v82
    s_nop 1
    v_permlane32_swap_b32 v82, v84
    buffer_load_dwordx4 v21, s[24:27], s56 offen offset:3072 lds
    v_pk_mul_f32 v[108:109], v[108:109], v[82:83] op_sel_hi:[1,0]
    v_pk_mul_f32 v[72:73], v[72:73], v[84:85] op_sel_hi:[1,0]
    v_pk_mul_f32 v[110:111], v[110:111], v[82:83] op_sel_hi:[1,0]
    v_pk_mul_f32 v[74:75], v[74:75], v[84:85] op_sel_hi:[1,0]
    v_pk_mul_f32 v[112:113], v[112:113], v[82:83] op_sel_hi:[1,0]
    v_pk_mul_f32 v[76:77], v[76:77], v[84:85] op_sel_hi:[1,0]
    v_pk_mul_f32 v[114:115], v[114:115], v[82:83] op_sel_hi:[1,0]
    v_pk_mul_f32 v[78:79], v[78:79], v[84:85] op_sel_hi:[1,0]
    s_add_u32 m0, s55, 45056
    v_pk_mul_f32 v[116:117], v[116:117], v[82:83] op_sel_hi:[1,0]
    v_pk_mul_f32 v[80:81], v[80:81], v[84:85] op_sel_hi:[1,0]
    v_cvt_pk_bf16_f32 v108, v108, v109
    v_cvt_pk_bf16_f32 v109, v110, v111
    v_cvt_pk_bf16_f32 v110, v112, v113
    v_cvt_pk_bf16_f32 v111, v114, v115
    v_cvt_pk_bf16_f32 v112, v116, v117
    v_cvt_pk_bf16_f32 v113, v72, v73
    v_cvt_pk_bf16_f32 v114, v74, v75
    buffer_load_dwordx4 v22, s[24:27], s56 offen lds
    v_cvt_pk_bf16_f32 v115, v76, v77
    v_cvt_pk_bf16_f32 v116, v78, v79
    v_cvt_pk_bf16_f32 v117, v80, v81
    ds_write_b64 v39, v[108:109] offset:5120
    ds_write_b64 v39, v[110:111] offset:5128
    ds_write_b64 v39, v[112:113] offset:5136
    ds_write_b64 v39, v[114:115] offset:5144
    ds_write_b64 v39, v[116:117] offset:5152
    v_accvgpr_read_b32 v42, a100
    v_accvgpr_read_b32 v43, a101
    v_accvgpr_read_b32 v44, a102
    v_accvgpr_read_b32 v45, a103
    v_accvgpr_read_b32 v46, a104
    v_accvgpr_read_b32 v47, a105
    v_accvgpr_read_b32 v48, a106
    v_accvgpr_read_b32 v49, a107
    s_getreg_b32 s57, hwreg(HW_REG_XCC_ID)
    s_and_b32 s57, s57, 15
    s_add_u32 s57, s57, 1
    s_mov_b32 s61, 0
    s_waitcnt vmcnt(11)
    v_cmp_ne_u32 vcc, s57, v124
    s_cbranch_vccnz L_hsAa_slow
L_hsAa_ok:
    s_waitcnt vmcnt(10)
    v_cmp_eq_u32 vcc, 0, v125
    s_cbranch_vccnz L_alAa_slow
L_alAa_ok:
    s_lshr_b32 s57, s50, 1
    s_lshl2_add_u32 s57, s48, s57
    s_lshl_b32 s57, s57, 12
    s_and_b32 s58, s50, 1
    s_lshl2_add_u32 s58, s58, s51
    s_lshl_b32 s58, s58, 7
    s_add_u32 s53, s57, s58
    s_add_u32 s53, s53, 0x280c00
    s_lshl2_add_u32 s58, s50, s51
    s_lshl_b32 s58, s58, 4
    s_add_u32 s69, s58, s68
    s_lshl2_add_u32 s58, s52, s69
    v_and_b32 v34, 3, v1
    v_lshlrev_b32 v34, 2, v34
    v_and_b32 v35, 15, v1
    v_cmp_gt_u32 vcc, 9, v35
    v_mov_b32 v35, 0x40000000
    s_nop 0
    v_cndmask_b32 v35, v35, v33, vcc
    s_waitcnt lgkmcnt(0)
    s_barrier
    s_setprio 1
    ds_read_b64_tr_b16 a[0:1], v40 offset:61440
    ds_read_b64_tr_b16 a[2:3], v40 offset:61480
    ds_read_b64_tr_b16 a[4:5], v42
    ds_read_b64_tr_b16 a[6:7], v43
    ds_read_b64_tr_b16 a[32:33], v40 offset:40960
    ds_read_b64_tr_b16 a[34:35], v40 offset:41000
    ds_read_b64_tr_b16 a[36:37], v40 offset:0
    ds_read_b64_tr_b16 a[38:39], v40 offset:40
    ds_read_b64_tr_b16 a[40:41], v41 offset:0
    ds_read_b64_tr_b16 a[42:43], v41 offset:40
    ds_read_b64_tr_b16 a[8:9], v40 offset:62720
    ds_read_b64_tr_b16 a[10:11], v40 offset:62760
    ds_read_b64_tr_b16 a[12:13], v44
    ds_read_b64_tr_b16 a[14:15], v45
    s_waitcnt lgkmcnt(8)
    v_mfma_f32_16x16x32_bf16 v[56:59], a[32:35], a[0:3], 0
    ds_read_b64_tr_b16 a[44:45], v40 offset:42240
    ds_read_b64_tr_b16 a[46:47], v40 offset:42280
    v_mfma_f32_16x16x32_bf16 v[60:63], a[32:35], a[4:7], 0
    ds_read_b64_tr_b16 a[48:49], v40 offset:1280
    ds_read_b64_tr_b16 a[50:51], v40 offset:1320
    s_waitcnt lgkmcnt(10)
    v_mfma_f32_16x16x32_bf16 v[64:67], a[36:39], a[0:3], 0
    ds_read_b64_tr_b16 a[52:53], v41 offset:1280
    ds_read_b64_tr_b16 a[54:55], v41 offset:1320
    v_mfma_f32_16x16x32_bf16 v[68:71], a[36:39], a[4:7], 0
    ds_read_b64_tr_b16 a[16:17], v40 offset:64000
    ds_read_b64_tr_b16 a[18:19], v40 offset:64040
    s_waitcnt lgkmcnt(12)
    v_mfma_f32_16x16x32_bf16 v[72:75], a[40:43], a[0:3], 0
    ds_read_b64_tr_b16 a[20:21], v46
    ds_read_b64_tr_b16 a[22:23], v47
    v_mfma_f32_16x16x32_bf16 v[76:79], a[40:43], a[4:7], 0
    ds_read_b64_tr_b16 a[56:57], v40 offset:43520
    ds_read_b64_tr_b16 a[58:59], v40 offset:43560
    s_waitcnt lgkmcnt(10)
    v_mfma_f32_16x16x32_bf16 v[56:59], a[44:47], a[8:11], v[56:59]
    ds_read_b64_tr_b16 a[60:61], v40 offset:2560
    ds_read_b64_tr_b16 a[62:63], v40 offset:2600
    v_mfma_f32_16x16x32_bf16 v[60:63], a[44:47], a[12:15], v[60:63]
    ds_read_b64_tr_b16 a[64:65], v41 offset:2560
    ds_read_b64_tr_b16 a[66:67], v41 offset:2600
    s_waitcnt lgkmcnt(12)
    v_mfma_f32_16x16x32_bf16 v[64:67], a[48:51], a[8:11], v[64:67]
    ds_read_b64_tr_b16 a[24:25], v40 offset:65280
    ds_read_b64_tr_b16 a[26:27], v40 offset:65320
    v_mfma_f32_16x16x32_bf16 v[68:71], a[48:51], a[12:15], v[68:71]
    ds_read_b64_tr_b16 a[28:29], v48
    ds_read_b64_tr_b16 a[30:31], v49
    s_waitcnt lgkmcnt(14)
    v_mfma_f32_16x16x32_bf16 v[72:75], a[52:55], a[8:11], v[72:75]
    ds_read_b64_tr_b16 a[68:69], v40 offset:44800
    ds_read_b64_tr_b16 a[70:71], v40 offset:44840
    v_mfma_f32_16x16x32_bf16 v[76:79], a[52:55], a[12:15], v[76:79]
    ds_read_b64_tr_b16 a[72:73], v40 offset:3840
    ds_read_b64_tr_b16 a[74:75], v40 offset:3880
    s_waitcnt lgkmcnt(12)
    v_mfma_f32_16x16x32_bf16 v[56:59], a[56:59], a[16:19], v[56:59]
    ds_read_b64_tr_b16 a[76:77], v41 offset:3840
    ds_read_b64_tr_b16 a[78:79], v41 offset:3880
    v_mfma_f32_16x16x32_bf16 v[60:63], a[56:59], a[20:23], v[60:63]
    s_waitcnt lgkmcnt(12)
    v_mfma_f32_16x16x32_bf16 v[64:67], a[60:63], a[16:19], v[64:67]
    v_mfma_f32_16x16x32_bf16 v[68:71], a[60:63], a[20:23], v[68:71]
    s_waitcnt lgkmcnt(10)
    v_mfma_f32_16x16x32_bf16 v[72:75], a[64:67], a[16:19], v[72:75]
    v_mfma_f32_16x16x32_bf16 v[76:79], a[64:67], a[20:23], v[76:79]
    s_waitcnt lgkmcnt(4)
    v_mfma_f32_16x16x32_bf16 v[56:59], a[68:71], a[24:27], v[56:59]
    v_mfma_f32_16x16x32_bf16 v[60:63], a[68:71], a[28:31], v[60:63]
    s_waitcnt lgkmcnt(2)
    v_mfma_f32_16x16x32_bf16 v[64:67], a[72:75], a[24:27], v[64:67]
    v_mfma_f32_16x16x32_bf16 v[68:71], a[72:75], a[28:31], v[68:71]
    s_waitcnt lgkmcnt(0)
    v_mfma_f32_16x16x32_bf16 v[72:75], a[76:79], a[24:27], v[72:75]
    v_mfma_f32_16x16x32_bf16 v[76:79], a[76:79], a[28:31], v[76:79]
    s_nop 0
    v_cvt_pk_bf16_f32 v80, v56, v57
    v_cvt_pk_bf16_f32 v81, v58, v59
    s_nop 0
    v_cvt_pk_bf16_f32 v82, v64, v65
    v_cvt_pk_bf16_f32 v83, v66, v67
    v_cvt_pk_bf16_f32 v84, v60, v61
    v_cvt_pk_bf16_f32 v85, v62, v63
    v_cvt_pk_bf16_f32 v86, v68, v69
    v_cvt_pk_bf16_f32 v87, v70, v71
    v_cvt_pk_bf16_f32 v88, v72, v73
    v_cvt_pk_bf16_f32 v89, v74, v75
    v_cvt_pk_bf16_f32 v90, v76, v77
    v_cvt_pk_bf16_f32 v91, v78, v79
    v_permlane16_swap_b32 v80, v82
    v_permlane16_swap_b32 v81, v83
    v_permlane16_swap_b32 v84, v86
    v_permlane16_swap_b32 v85, v87
    v_permlane16_swap_b32 v88, v90
    v_permlane16_swap_b32 v89, v91
    s_cmp_eq_u32 s61, 0
    s_cbranch_scc0 L_pubAa_far
    buffer_store_dwordx4 v[80:83], v50, s[36:39], s62 offen
    buffer_store_dwordx4 v[84:87], v51, s[36:39], s62 offen
    buffer_store_dwordx4 v[88:91], v52, s[36:39], s62 offen
L_pubAa_st:
    s_add_u32 m0, s55, 122880
    s_bfe_u32 s56, s72, 0x40000
    s_mul_i32 s56, s56, 245760
    s_add_u32 s56, s56, s54
    buffer_load_dwordx4 v18, s[24:27], s56 offen offset:0 lds
    buffer_load_dwordx4 v19, s[24:27], s56 offen offset:1024 lds
    buffer_load_dwordx4 v20, s[24:27], s56 offen offset:2048 lds
    buffer_load_dwordx4 v21, s[24:27], s56 offen offset:3072 lds
    s_add_u32 m0, s55, 126976
    s_nop 0
    buffer_load_dwordx4 v22, s[24:27], s56 offen lds
    s_waitcnt vmcnt(5)
    v_mov_b32 v55, 1
    s_cmp_eq_u32 s61, 0
    s_cbranch_scc0 L_s1Aa_far
    s_mov_b64 exec, 1
    buffer_store_dword v55, off, s[32:35], s58 offset:0
    s_mov_b64 exec, -1
L_s1Aa_st:
    s_barrier
    s_mov_b32 s67, 0
L_f1Aa:
    buffer_load_dword v55, v34, s[32:35], s69 offen offset:0 sc1
    s_add_u32 s67, s67, 1
    s_waitcnt vmcnt(0)
    v_cmp_eq_u32 vcc, 0, v55
    s_cmpk_ge_u32 s67, 20000
    s_cbranch_scc1 L_f1Aa_ok
    s_cbranch_vccnz L_f1Aa
L_f1Aa_ok:
    buffer_load_dwordx4 v[56:59], v53, s[36:39], s59 offen sc1
    s_cmp_eq_u32 s52, 3
    s_cselect_b32 s57, 0x40000000, s59
    buffer_load_dwordx4 v[60:63], v53, s[36:39], s57 offen offset:256 sc1
    v_mov_b32 v55, 1
    s_mov_b64 exec, 1
    buffer_atomic_add v55, off, s[32:35], s53 sc1
    s_mov_b64 exec, -1
    s_add_u32 m0, s55, 61440
    s_add_u32 s56, s51, s50
    s_and_b32 s56, s56, 7
    s_mul_i32 s56, s56, 102400
    s_add_u32 s56, s56, s64
    s_add_u32 s56, s56, 51200
    buffer_load_dwordx4 v23, s[28:31], s56 offen offset:0 lds
    buffer_load_dwordx4 v24, s[28:31], s56 offen offset:1024 lds
    buffer_load_dwordx4 v25, s[28:31], s56 offen offset:2048 lds
    buffer_load_dwordx4 v26, s[28:31], s56 offen offset:3072 lds
    s_add_u32 m0, s55, 65536
    s_nop 0
    buffer_load_dwordx4 v27, s[28:31], s56 offen lds
    s_waitcnt vmcnt(7)
    v_mfma_f32_16x16x32_bf16 v[64:67], a[120:123], v[56:59], 0
    s_waitcnt vmcnt(6)
    v_mfma_f32_16x16x32_bf16 v[68:71], a[120:123], v[60:63], 0
    s_nop 5
    v_cvt_pk_bf16_f32 v56, v64, v65
    v_cvt_pk_bf16_f32 v57, v66, v67
    v_cvt_pk_bf16_f32 v58, v68, v69
    v_cvt_pk_bf16_f32 v59, v70, v71
    s_nop 0
    v_permlane16_swap_b32 v56, v58
    v_permlane16_swap_b32 v57, v59
    buffer_store_dwordx4 v[56:59], v54, s[32:35], s60 offen sc1
    s_setprio 0
    s_add_u32 m0, s55, 81920
    s_add_u32 s56, s51, s50
    s_add_u32 s56, s56, 4
    s_and_b32 s56, s56, 7
    s_mul_i32 s56, s56, 102400
    s_add_u32 s56, s56, s64
    s_add_u32 s56, s56, 51200
    buffer_load_dwordx4 v23, s[28:31], s56 offen offset:0 lds
    buffer_load_dwordx4 v24, s[28:31], s56 offen offset:1024 lds
    buffer_load_dwordx4 v25, s[28:31], s56 offen offset:2048 lds
    buffer_load_dwordx4 v26, s[28:31], s56 offen offset:3072 lds
    s_add_u32 m0, s55, 86016
    s_nop 0
    buffer_load_dwordx4 v27, s[28:31], s56 offen lds
    s_barrier
    v_mov_b32 v55, 16
    s_mov_b64 exec, 1
    v_mov_b32 v55, 0
    buffer_atomic_add v55, off, s[32:35], s53 sc0 sc1
    s_mov_b64 exec, -1
    s_add_u32 m0, s55, 0
    s_and_b32 s56, s51, 1
    s_mul_i32 s56, s56, 409600
    s_add_u32 s56, s56, s64
    s_cmp_lt_u32 s51, 2
    s_cselect_b32 s65, 51200, 0
    s_add_u32 s56, s56, s65
    buffer_load_dwordx4 v28, s[28:31], s56 offen offset:0 lds
    buffer_load_dwordx4 v29, s[28:31], s56 offen offset:1024 lds
    buffer_load_dwordx4 v30, s[28:31], s56 offen offset:2048 lds
    buffer_load_dwordx4 v31, s[28:31], s56 offen offset:3072 lds
    s_add_u32 m0, s55, 4096
    s_nop 0
    buffer_load_dwordx4 v32, s[28:31], s56 offen lds
    v_lshrrev_b32 v20, 4, v1
    v_and_b32 v21, 15, v1
    v_add_u32 v15, 40960, v7
    v_mul_u32_u24 v16, 5120, v20
    v_lshl_add_u32 v16, v21, 4, v16
    v_add_u32 v17, 40960, v16
    s_mul_i32 s57, s51, 10240
    s_add_u32 s57, s57, 102400
    v_add_u32 v18, s57, v7
    v_add_u32 v3, 0x10000, v2
    s_mul_i32 s58, s51, 1792
    s_add_u32 s58, s58, 153600
    v_lshrrev_b32 v22, 5, v1
    v_mul_u32_u24 v22, 240, v22
    v_lshl_add_u32 v22, v20, 3, v22
    v_lshl_add_u32 v22, v21, 4, v22
    v_add_u32 v22, s58, v22
    v_mul_u32_u24 v19, 176, v21
    v_lshl_add_u32 v19, v20, 3, v19
    v_add_u32 v19, s57, v19
    v_mul_u32_u24 v21, 0xccd, v1
    v_lshrrev_b32 v21, 15, v21
    v_lshl_add_u32 v20, v21, 4, v18
    v_mul_u32_u24 v21, 2400, v21
    v_add_u32 v21, v21, v7
    v_mov_b32 v96, 0x40000000
    v_cmp_gt_u32 vcc, 20, v1
    s_nop 1
    v_cndmask_b32 v54, v96, v21, vcc
    v_cmp_gt_u32 vcc, 60, v1
    s_nop 1
    v_cndmask_b32 v21, v96, v21, vcc
    s_add_u32 s44, s63, 0
    s_add_u32 s45, s44, 20480
    s_add_u32 s25, s50, 1
    s_and_b32 s25, s25, 7
    s_mulk_i32 s25, 5120
    s_add_u32 s25, s25, s44
    s_add_u32 s26, s50, 2
    s_and_b32 s26, s26, 7
    s_mulk_i32 s26, 5120
    s_add_u32 s26, s26, s44
    s_add_u32 s27, s50, 3
    s_and_b32 s27, s27, 7
    s_mulk_i32 s27, 5120
    s_add_u32 s27, s27, s44
    s_add_u32 s40, s50, 4
    s_and_b32 s40, s40, 7
    s_mulk_i32 s40, 5120
    s_add_u32 s40, s40, s44
    s_add_u32 s41, s50, 5
    s_and_b32 s41, s41, 7
    s_mulk_i32 s41, 5120
    s_add_u32 s41, s41, s44
    s_add_u32 s42, s50, 6
    s_and_b32 s42, s42, 7
    s_mulk_i32 s42, 5120
    s_add_u32 s42, s42, s44
    s_add_u32 s43, s50, 7
    s_and_b32 s43, s43, 7
    s_mulk_i32 s43, 5120
    s_add_u32 s43, s43, s44
    s_lshl2_add_u32 s58, s52, s51
    s_lshl_b32 s58, s58, 6
    s_add_u32 s69, s58, s68
    s_lshl3_add_u32 s58, s50, s69
    s_waitcnt vmcnt(5)
    v_cmp_ne_u32 vcc, 16, v55
    s_cbranch_vccz L_gcAa_ok
    s_mov_b32 s67, 0
L_gcAa:
    v_mov_b32 v55, 16
    s_mov_b64 exec, 1
    v_mov_b32 v55, 0
    buffer_atomic_add v55, off, s[32:35], s53 sc0 sc1
    s_mov_b64 exec, -1
    s_add_u32 s67, s67, 1
    s_waitcnt vmcnt(0)
    v_cmp_ne_u32 vcc, 16, v55
    s_cmpk_ge_u32 s67, 20000
    s_cbranch_scc1 L_gcAa_ok
    s_cbranch_vccnz L_gcAa
L_gcAa_ok:
    buffer_load_dwordx4 a[0:3], v33, s[32:35], s60 offen offset:0 sc1
    buffer_load_dwordx4 a[4:7], v33, s[32:35], s60 offen offset:256 sc1
    buffer_load_dwordx4 a[8:11], v33, s[32:35], s60 offen offset:512 sc1
    buffer_load_dwordx4 a[12:15], v33, s[32:35], s60 offen offset:768 sc1
    buffer_load_dwordx4 a[16:19], v33, s[32:35], s60 offen offset:1024 sc1
    buffer_load_dwordx4 a[20:23], v33, s[32:35], s60 offen offset:1280 sc1
    buffer_load_dwordx4 a[24:27], v35, s[32:35], s60 offen offset:1536 sc1
    v_and_b32 v121, 15, v1
    v_lshlrev_b32 v121, 2, v121
    v_and_b32 v123, 56, v121
    s_barrier
    ds_read_b64 v[96:97], v8 offset:0
    s_add_u32 m0, s55, 20480
    s_add_u32 s56, s51, s50
    s_and_b32 s56, s56, 7
    s_mul_i32 s56, s56, 102400
    s_add_u32 s56, s56, s64
    ds_read_b64 v[98:99], v8 offset:512
    ds_read_b64 v[100:101], v8 offset:1024
    buffer_load_dwordx4 v23, s[28:31], s56 offen offset:0 lds
    ds_read_b64 v[102:103], v5 offset:0
    ds_read_b64 v[104:105], v5 offset:8
    buffer_load_dwordx4 v24, s[28:31], s56 offen offset:1024 lds
    ds_read_b64 v[106:107], v6 offset:0
    ds_read_b64 v[108:109], v8 offset:1536
    buffer_load_dwordx4 v25, s[28:31], s56 offen offset:2048 lds
    ds_read_b64 v[110:111], v8 offset:2048
    ds_read_b64 v[112:113], v8 offset:2560
    ds_read_b64 v[114:115], v5 offset:5120
    buffer_load_dwordx4 v26, s[28:31], s56 offen offset:3072 lds
    ds_read_b64 v[116:117], v5 offset:5128
    ds_read_b64 v[118:119], v6 offset:5120
    s_add_u32 m0, s55, 24576
    s_waitcnt lgkmcnt(7)
    v_mfma_f32_32x32x16_bf16 v[56:71], v[96:99], v[102:105], 0
    s_waitcnt lgkmcnt(6)
    v_mfma_f32_32x32x8_bf16 v[56:71], v[100:101], v[106:107], v[56:71]
    buffer_load_dwordx4 v27, s[28:31], s56 offen lds
    s_waitcnt lgkmcnt(1)
    v_mfma_f32_32x32x16_bf16 v[72:87], v[108:111], v[114:117], 0
    s_waitcnt lgkmcnt(0)
    v_mfma_f32_32x32x8_bf16 v[72:87], v[112:113], v[118:119], v[72:87]
    s_nop 6
    v_exp_f32 v96, v56
    v_exp_f32_e64 v56, -v56
    v_exp_f32 v97, v57
    v_exp_f32_e64 v57, -v57
    v_exp_f32 v98, v58
    v_exp_f32_e64 v58, -v58
    v_exp_f32 v99, v59
    v_exp_f32_e64 v59, -v59
    v_exp_f32 v100, v60
    v_exp_f32_e64 v60, -v60
    v_exp_f32 v101, v61
    v_exp_f32_e64 v61, -v61
    v_exp_f32 v102, v62
    v_exp_f32_e64 v62, -v62
    v_exp_f32 v103, v63
    v_exp_f32_e64 v63, -v63
    v_exp_f32 v104, v64
    v_exp_f32_e64 v64, -v64
    v_exp_f32 v105, v65
    v_exp_f32_e64 v65, -v65
    v_pk_add_f32 v[66:67], v[96:97], v[98:99]
    v_pk_add_f32 v[68:69], v[56:57], v[58:59]
    v_pk_add_f32 v[66:67], v[66:67], v[100:101]
    v_pk_add_f32 v[68:69], v[68:69], v[60:61]
    v_pk_add_f32 v[66:67], v[66:67], v[102:103]
    v_pk_add_f32 v[68:69], v[68:69], v[62:63]
    v_pk_add_f32 v[66:67], v[66:67], v[104:105]
    v_pk_add_f32 v[68:69], v[68:69], v[64:65]
    v_add_f32 v66, v66, v67
    v_add_f32 v68, v68, v69
    s_nop 1
    v_permlane32_swap_b32 v66, v68
    v_add_f32 v66, v66, v68
    v_cmp_ngt_f32 vcc, 0x56800000, v66
    v_rcp_f32 v66, v66
    s_cbranch_vccnz L_q0Aa_max
L_q0Aa_sum:
    v_mov_b32 v68, v66
    s_nop 1
    v_permlane32_swap_b32 v66, v68
    v_pk_mul_f32 v[96:97], v[96:97], v[66:67] op_sel_hi:[1,0]
    v_pk_mul_f32 v[56:57], v[56:57], v[68:69] op_sel_hi:[1,0]
    v_pk_mul_f32 v[98:99], v[98:99], v[66:67] op_sel_hi:[1,0]
    v_pk_mul_f32 v[58:59], v[58:59], v[68:69] op_sel_hi:[1,0]
    v_pk_mul_f32 v[100:101], v[100:101], v[66:67] op_sel_hi:[1,0]
    v_pk_mul_f32 v[60:61], v[60:61], v[68:69] op_sel_hi:[1,0]
    v_pk_mul_f32 v[102:103], v[102:103], v[66:67] op_sel_hi:[1,0]
    v_pk_mul_f32 v[62:63], v[62:63], v[68:69] op_sel_hi:[1,0]
    v_pk_mul_f32 v[104:105], v[104:105], v[66:67] op_sel_hi:[1,0]
    v_pk_mul_f32 v[64:65], v[64:65], v[68:69] op_sel_hi:[1,0]
    v_cvt_pk_bf16_f32 v96, v96, v97
    v_cvt_pk_bf16_f32 v97, v98, v99
    v_cvt_pk_bf16_f32 v98, v100, v101
    v_cvt_pk_bf16_f32 v99, v102, v103
    v_cvt_pk_bf16_f32 v100, v104, v105
    v_cvt_pk_bf16_f32 v101, v56, v57
    v_cvt_pk_bf16_f32 v102, v58, v59
    v_cvt_pk_bf16_f32 v103, v60, v61
    v_cvt_pk_bf16_f32 v104, v62, v63
    v_cvt_pk_bf16_f32 v105, v64, v65
    s_waitcnt vmcnt(5)
    v_mfma_f32_16x16x32_bf16 v[56:59], a[120:123], a[0:3], 0
    v_mfma_f32_16x16x32_bf16 v[60:63], a[120:123], a[8:11], 0
    v_mfma_f32_16x16x32_bf16 v[64:67], a[120:123], a[16:19], 0
    v_mfma_f32_16x16x32_bf16 v[68:71], a[120:123], a[24:27], 0
    v_mfma_f32_16x16x32_bf16 v[56:59], a[124:127], a[4:7], v[56:59]
    v_mfma_f32_16x16x32_bf16 v[60:63], a[124:127], a[12:15], v[60:63]
    v_mfma_f32_16x16x32_bf16 v[64:67], a[124:127], a[20:23], v[64:67]
    s_nop 5
    v_add_f32 v120, v68, v56
    v_add_f32 v120, v120, v60
    v_cmp_u_f32 vcc, v120, v64
    s_cbranch_vccz L_xlAa_ok
    s_mov_b32 s67, 0
L_xlAa:
    buffer_load_dwordx4 a[0:3], v33, s[32:35], s60 offen offset:0 sc1
    buffer_load_dwordx4 a[4:7], v33, s[32:35], s60 offen offset:256 sc1
    buffer_load_dwordx4 a[8:11], v33, s[32:35], s60 offen offset:512 sc1
    buffer_load_dwordx4 a[12:15], v33, s[32:35], s60 offen offset:768 sc1
    buffer_load_dwordx4 a[16:19], v33, s[32:35], s60 offen offset:1024 sc1
    buffer_load_dwordx4 a[20:23], v33, s[32:35], s60 offen offset:1280 sc1
    buffer_load_dwordx4 a[24:27], v35, s[32:35], s60 offen offset:1536 sc1
    s_add_u32 s67, s67, 1
    s_waitcnt vmcnt(0)
    v_mfma_f32_16x16x32_bf16 v[56:59], a[120:123], a[0:3], 0
    v_mfma_f32_16x16x32_bf16 v[60:63], a[120:123], a[8:11], 0
    v_mfma_f32_16x16x32_bf16 v[64:67], a[120:123], a[16:19], 0
    v_mfma_f32_16x16x32_bf16 v[68:71], a[120:123], a[24:27], 0
    v_mfma_f32_16x16x32_bf16 v[56:59], a[124:127], a[4:7], v[56:59]
    v_mfma_f32_16x16x32_bf16 v[60:63], a[124:127], a[12:15], v[60:63]
    v_mfma_f32_16x16x32_bf16 v[64:67], a[124:127], a[20:23], v[64:67]
    s_nop 5
    v_add_f32 v120, v68, v56
    v_add_f32 v120, v120, v60
    v_cmp_u_f32 vcc, v120, v64
    s_cmpk_ge_u32 s67, 4000
    s_cbranch_scc1 L_xlAa_ok
    s_cbranch_vccnz L_xlAa
L_xlAa_ok:
    v_cvt_pk_bf16_f32 v56, v56, v57
    v_cvt_pk_bf16_f32 v57, v58, v59
    ds_write_b64 v22, v[56:57] offset:0
    v_cvt_pk_bf16_f32 v60, v60, v61
    v_cvt_pk_bf16_f32 v61, v62, v63
    ds_write_b64 v22, v[60:61] offset:512
    v_cvt_pk_bf16_f32 v64, v64, v65
    v_cvt_pk_bf16_f32 v65, v66, v67
    ds_write_b64 v22, v[64:65] offset:1024
    v_cvt_pk_bf16_f32 v68, v68, v69
    v_cvt_pk_bf16_f32 v69, v70, v71
    s_mov_b32 exec_hi, 0
    ds_write_b64 v22, v[68:69] offset:1536
    s_mov_b32 exec_hi, -1
    s_add_u32 m0, s55, 40960
    s_add_u32 s56, s51, s50
    s_add_u32 s56, s56, 4
    s_and_b32 s56, s56, 7
    s_mul_i32 s56, s56, 102400
    s_add_u32 s56, s56, s64
    buffer_load_dwordx4 v23, s[28:31], s56 offen offset:0 lds
    buffer_load_dwordx4 v24, s[28:31], s56 offen offset:1024 lds
    buffer_load_dwordx4 v25, s[28:31], s56 offen offset:2048 lds
    buffer_load_dwordx4 v26, s[28:31], s56 offen offset:3072 lds
    s_add_u32 m0, s55, 45056
    s_nop 0
    buffer_load_dwordx4 v27, s[28:31], s56 offen lds
    s_waitcnt lgkmcnt(0)
    s_barrier
    ds_read_b128 v[34:37], v9 offset:0
    ds_read_b128 v[38:41], v10 offset:0
    ds_read_b64 v[42:43], v11 offset:0
    ds_read_b128 v[44:47], v9 offset:1792
    ds_read_b128 v[48:51], v10 offset:1792
    ds_read_b64 v[52:53], v11 offset:1792
    v_exp_f32 v108, v72
    v_exp_f32_e64 v72, -v72
    v_exp_f32 v109, v73
    v_exp_f32_e64 v73, -v73
    v_exp_f32 v110, v74
    v_exp_f32_e64 v74, -v74
    v_exp_f32 v111, v75
    v_exp_f32_e64 v75, -v75
    v_exp_f32 v112, v76
    v_exp_f32_e64 v76, -v76
    v_exp_f32 v113, v77
    v_exp_f32_e64 v77, -v77
    v_exp_f32 v114, v78
    v_exp_f32_e64 v78, -v78
    v_exp_f32 v115, v79
    v_exp_f32_e64 v79, -v79
    v_exp_f32 v116, v80
    v_exp_f32_e64 v80, -v80
    v_exp_f32 v117, v81
    v_exp_f32_e64 v81, -v81
    s_waitcnt lgkmcnt(5)
    v_mfma_f32_32x32x16_bf16 v[56:71], v[34:37], v[96:99], 0
    s_waitcnt lgkmcnt(4)
    v_mfma_f32_32x32x16_bf16 v[56:71], v[38:41], v[100:103], v[56:71]
    s_waitcnt lgkmcnt(3)
    v_mfma_f32_32x32x8_bf16 v[56:71], v[42:43], v[104:105], v[56:71]
    s_nop 11
    v_add_f32 v68, 0x358637bd, v68
    v_rcp_f32 v68, v68
    s_nop 0
    v_pk_mul_f32 v[56:57], v[56:57], v[68:69] op_sel_hi:[1,0]
    v_pk_mul_f32 v[58:59], v[58:59], v[68:69] op_sel_hi:[1,0]
    v_pk_mul_f32 v[60:61], v[60:61], v[68:69] op_sel_hi:[1,0]
    v_pk_mul_f32 v[62:63], v[62:63], v[68:69] op_sel_hi:[1,0]
    v_pk_mul_f32 v[64:65], v[64:65], v[68:69] op_sel_hi:[1,0]
    v_pk_mul_f32 v[66:67], v[66:67], v[68:69] op_sel_hi:[1,0]
    v_cvt_pk_bf16_f32 v88, v56, v57
    v_cvt_pk_bf16_f32 v89, v58, v59
    v_cvt_pk_bf16_f32 v90, v60, v61
    v_cvt_pk_bf16_f32 v91, v62, v63
    v_cvt_pk_bf16_f32 v124, v64, v65
    v_cvt_pk_bf16_f32 v125, v66, v67
    v_pk_add_f32 v[82:83], v[108:109], v[110:111]
    v_pk_add_f32 v[84:85], v[72:73], v[74:75]
    v_pk_add_f32 v[82:83], v[82:83], v[112:113]
    v_pk_add_f32 v[84:85], v[84:85], v[76:77]
    v_pk_add_f32 v[82:83], v[82:83], v[114:115]
    v_pk_add_f32 v[84:85], v[84:85], v[78:79]
    v_pk_add_f32 v[82:83], v[82:83], v[116:117]
    v_pk_add_f32 v[84:85], v[84:85], v[80:81]
    v_add_f32 v82, v82, v83
    v_add_f32 v84, v84, v85
    s_nop 1
    v_permlane32_swap_b32 v82, v84
    v_add_f32 v82, v82, v84
    v_cmp_ngt_f32 vcc, 0x56800000, v82
    v_rcp_f32 v82, v82
    s_cbranch_vccnz L_q1Aa_max
L_q1Aa_sum:
    v_mov_b32 v84, v82
    s_nop 1
    v_permlane32_swap_b32 v82, v84
    v_pk_mul_f32 v[108:109], v[108:109], v[82:83] op_sel_hi:[1,0]
    v_pk_mul_f32 v[72:73], v[72:73], v[84:85] op_sel_hi:[1,0]
    v_pk_mul_f32 v[110:111], v[110:111], v[82:83] op_sel_hi:[1,0]
    v_pk_mul_f32 v[74:75], v[74:75], v[84:85] op_sel_hi:[1,0]
    v_pk_mul_f32 v[112:113], v[112:113], v[82:83] op_sel_hi:[1,0]
    v_pk_mul_f32 v[76:77], v[76:77], v[84:85] op_sel_hi:[1,0]
    v_pk_mul_f32 v[114:115], v[114:115], v[82:83] op_sel_hi:[1,0]
    v_pk_mul_f32 v[78:79], v[78:79], v[84:85] op_sel_hi:[1,0]
    v_pk_mul_f32 v[116:117], v[116:117], v[82:83] op_sel_hi:[1,0]
    v_pk_mul_f32 v[80:81], v[80:81], v[84:85] op_sel_hi:[1,0]
    v_cvt_pk_bf16_f32 v108, v108, v109
    v_cvt_pk_bf16_f32 v109, v110, v111
    v_cvt_pk_bf16_f32 v110, v112, v113
    v_cvt_pk_bf16_f32 v111, v114, v115
    v_cvt_pk_bf16_f32 v112, v116, v117
    v_cvt_pk_bf16_f32 v113, v72, v73
    v_cvt_pk_bf16_f32 v114, v74, v75
    v_cvt_pk_bf16_f32 v115, v76, v77
    v_cvt_pk_bf16_f32 v116, v78, v79
    v_cvt_pk_bf16_f32 v117, v80, v81
    s_waitcnt lgkmcnt(2)
    v_mfma_f32_32x32x16_bf16 v[72:87], v[44:47], v[108:111], 0
    s_waitcnt lgkmcnt(1)
    v_mfma_f32_32x32x16_bf16 v[72:87], v[48:51], v[112:115], v[72:87]
    s_waitcnt lgkmcnt(0)
    v_mfma_f32_32x32x8_bf16 v[72:87], v[52:53], v[116:117], v[72:87]
    s_nop 11
    v_add_f32 v84, 0x358637bd, v84
    v_rcp_f32 v84, v84
    s_nop 0
    v_pk_mul_f32 v[72:73], v[72:73], v[84:85] op_sel_hi:[1,0]
    v_pk_mul_f32 v[74:75], v[74:75], v[84:85] op_sel_hi:[1,0]
    v_pk_mul_f32 v[76:77], v[76:77], v[84:85] op_sel_hi:[1,0]
    v_pk_mul_f32 v[78:79], v[78:79], v[84:85] op_sel_hi:[1,0]
    v_pk_mul_f32 v[80:81], v[80:81], v[84:85] op_sel_hi:[1,0]
    v_pk_mul_f32 v[82:83], v[82:83], v[84:85] op_sel_hi:[1,0]
    v_cvt_pk_bf16_f32 v92, v72, v73
    v_cvt_pk_bf16_f32 v93, v74, v75
    v_cvt_pk_bf16_f32 v94, v76, v77
    v_cvt_pk_bf16_f32 v95, v78, v79
    v_permlane16_swap_b32 v88, v92
    v_permlane16_swap_b32 v89, v93
    v_permlane16_swap_b32 v90, v94
    v_permlane16_swap_b32 v91, v95
    v_cvt_pk_bf16_f32 v126, v80, v81
    v_cvt_pk_bf16_f32 v127, v82, v83
    s_cmp_eq_u32 s61, 0
    s_cbranch_scc0 L_o1Aa_far
    buffer_store_dwordx4 v[88:91], v7, s[36:39], s62 offen
    buffer_store_dwordx4 v[92:95], v15, s[36:39], s62 offen
    buffer_store_dwordx4 v[124:127], v13, s[36:39], s62 offen offset:1024
L_o1Aa_st:
    v_accvgpr_write_b32 a0, v88
    v_accvgpr_write_b32 a1, v89
    v_accvgpr_write_b32 a2, v90
    v_accvgpr_write_b32 a3, v91
    v_accvgpr_write_b32 a4, v92
    v_accvgpr_write_b32 a5, v93
    v_accvgpr_write_b32 a6, v94
    v_accvgpr_write_b32 a7, v95
    s_waitcnt vmcnt(8)
    s_waitcnt vmcnt(3)
    s_barrier
    s_setprio 2
    ds_read_b64_tr_b16 a[80:81], v2 offset:20480
    ds_read_b64_tr_b16 a[82:83], v2 offset:23040
    ds_read_b64_tr_b16 a[84:85], v2 offset:20512
    ds_read_b64_tr_b16 a[86:87], v2 offset:23072
    ds_read_b64_tr_b16 a[88:89], v2 offset:20544
    ds_read_b64_tr_b16 a[90:91], v2 offset:23104
    ds_read_b64_tr_b16 a[92:93], v2 offset:20576
    ds_read_b64_tr_b16 a[94:95], v2 offset:23136
    ds_read_b64_tr_b16 a[96:97], v2 offset:20608
    ds_read_b64_tr_b16 a[98:99], v2 offset:23168
    ds_read_b64_tr_b16 a[100:101], v2 offset:25600
    ds_read_b64_tr_b16 a[102:103], v2 offset:28160
    s_waitcnt vmcnt(0)
    v_mov_b32 v120, 1
    s_cmp_eq_u32 s61, 0
    s_cbranch_scc0 L_s2Aa_far
    s_mov_b64 exec, 1
    buffer_store_dword v120, off, s[32:35], s58 offset:1024
    s_mov_b64 exec, -1
L_s2Aa_st:
    ds_read_b64_tr_b16 a[104:105], v2 offset:25632
    ds_read_b64_tr_b16 a[106:107], v2 offset:28192
    ds_read_b64_tr_b16 a[108:109], v2 offset:25664
    ds_read_b64_tr_b16 a[110:111], v2 offset:28224
    ds_read_b64_tr_b16 a[112:113], v2 offset:25696
    ds_read_b64_tr_b16 a[114:115], v2 offset:28256
    ds_read_b64_tr_b16 a[116:117], v2 offset:25728
    ds_read_b64_tr_b16 a[118:119], v2 offset:28288
    ds_read_b64_tr_b16 a[120:121], v2 offset:30720
    ds_read_b64_tr_b16 a[122:123], v2 offset:33280
    ds_read_b64_tr_b16 a[124:125], v2 offset:30752
    ds_read_b64_tr_b16 a[126:127], v2 offset:33312
    ds_read_b64_tr_b16 v[34:35], v2 offset:30784
    ds_read_b64_tr_b16 v[36:37], v2 offset:33344
    ds_read_b64_tr_b16 v[38:39], v2 offset:30816
    ds_read_b64_tr_b16 v[40:41], v2 offset:33376
    buffer_load_dword v122, v123, s[32:35], s69 offen offset:1024 sc1
    ds_read_b64_tr_b16 v[42:43], v2 offset:30848
    ds_read_b64_tr_b16 v[44:45], v2 offset:33408
    ds_read_b64_tr_b16 v[46:47], v2 offset:35840
    ds_read_b64_tr_b16 v[48:49], v2 offset:38400
    ds_read_b64_tr_b16 v[50:51], v2 offset:35872
    ds_read_b64_tr_b16 v[52:53], v2 offset:38432
    ds_read_b64_tr_b16 v[96:97], v2 offset:35904
    ds_read_b64_tr_b16 v[98:99], v2 offset:38464
    ds_read_b64_tr_b16 v[100:101], v2 offset:35936
    ds_read_b64_tr_b16 v[102:103], v2 offset:38496
    ds_read_b64_tr_b16 v[104:105], v2 offset:35968
    ds_read_b64_tr_b16 v[106:107], v2 offset:38528
    ds_read_b64_tr_b16 v[108:109], v2 offset:40960
    ds_read_b64_tr_b16 v[110:111], v2 offset:43520
    ds_read_b64_tr_b16 v[112:113], v2 offset:40992
    ds_read_b64_tr_b16 v[114:115], v2 offset:43552
    s_waitcnt vmcnt(0)
    v_cmp_eq_u32 vcc, 0, v122
    s_cbranch_vccz L_f2Aa_ok
    s_mov_b32 s67, 0
L_f2Aa:
    buffer_load_dword v122, v123, s[32:35], s69 offen offset:1024 sc1
    s_add_u32 s67, s67, 1
    s_waitcnt vmcnt(0)
    v_cmp_eq_u32 vcc, 0, v122
    s_cmpk_ge_u32 s67, 20000
    s_cbranch_scc1 L_f2Aa_ok
    s_cbranch_vccnz L_f2Aa
L_f2Aa_ok:
    buffer_load_dwordx4 a[8:11], v7, s[36:39], s25 offen sc1
    buffer_load_dwordx4 a[12:15], v15, s[36:39], s25 offen sc1
    buffer_load_dwordx4 a[16:19], v7, s[36:39], s26 offen sc1
    buffer_load_dwordx4 a[20:23], v15, s[36:39], s26 offen sc1
    s_waitcnt lgkmcnt(0)
    s_setprio 0
    v_mfma_f32_16x16x32_bf16 v[56:59], a[80:83], a[0:3], 0
    v_mfma_f32_16x16x32_bf16 v[60:63], a[80:83], a[4:7], 0
    buffer_load_dwordx4 a[24:27], v7, s[36:39], s27 offen sc1
    v_mfma_f32_16x16x32_bf16 v[64:67], a[84:87], a[0:3], 0
    v_mfma_f32_16x16x32_bf16 v[68:71], a[84:87], a[4:7], 0
    v_mfma_f32_16x16x32_bf16 v[72:75], a[88:91], a[0:3], 0
    v_mfma_f32_16x16x32_bf16 v[76:79], a[88:91], a[4:7], 0
    buffer_load_dwordx4 a[28:31], v15, s[36:39], s27 offen sc1
    v_mfma_f32_16x16x32_bf16 v[80:83], a[92:95], a[0:3], 0
    v_mfma_f32_16x16x32_bf16 v[84:87], a[92:95], a[4:7], 0
    buffer_load_dwordx4 a[32:35], v7, s[36:39], s40 offen sc1
    v_mfma_f32_16x16x32_bf16 v[88:91], a[96:99], a[0:3], 0
    v_mfma_f32_16x16x32_bf16 v[92:95], a[96:99], a[4:7], 0
    s_waitcnt vmcnt(6)
    v_mfma_f32_16x16x32_bf16 v[56:59], a[100:103], a[8:11], v[56:59]
    s_waitcnt vmcnt(5)
    v_mfma_f32_16x16x32_bf16 v[60:63], a[100:103], a[12:15], v[60:63]
    buffer_load_dwordx4 a[36:39], v15, s[36:39], s40 offen sc1
    v_mfma_f32_16x16x32_bf16 v[64:67], a[104:107], a[8:11], v[64:67]
    v_mfma_f32_16x16x32_bf16 v[68:71], a[104:107], a[12:15], v[68:71]
    v_mfma_f32_16x16x32_bf16 v[72:75], a[108:111], a[8:11], v[72:75]
    v_mfma_f32_16x16x32_bf16 v[76:79], a[108:111], a[12:15], v[76:79]
    buffer_load_dwordx4 a[40:43], v7, s[36:39], s41 offen sc1
    v_mfma_f32_16x16x32_bf16 v[80:83], a[112:115], a[8:11], v[80:83]
    v_mfma_f32_16x16x32_bf16 v[84:87], a[112:115], a[12:15], v[84:87]
    buffer_load_dwordx4 a[44:47], v15, s[36:39], s41 offen sc1
    v_mfma_f32_16x16x32_bf16 v[88:91], a[116:119], a[8:11], v[88:91]
    v_mfma_f32_16x16x32_bf16 v[92:95], a[116:119], a[12:15], v[92:95]
    s_waitcnt vmcnt(7)
    v_mfma_f32_16x16x32_bf16 v[56:59], a[120:123], a[16:19], v[56:59]
    s_waitcnt vmcnt(6)
    v_mfma_f32_16x16x32_bf16 v[60:63], a[120:123], a[20:23], v[60:63]
    buffer_load_dwordx4 a[48:51], v7, s[36:39], s42 offen sc1
    v_mfma_f32_16x16x32_bf16 v[64:67], a[124:127], a[16:19], v[64:67]
    v_mfma_f32_16x16x32_bf16 v[68:71], a[124:127], a[20:23], v[68:71]
    v_mfma_f32_16x16x32_bf16 v[72:75], v[34:37], a[16:19], v[72:75]
    v_mfma_f32_16x16x32_bf16 v[76:79], v[34:37], a[20:23], v[76:79]
    buffer_load_dwordx4 a[52:55], v15, s[36:39], s42 offen sc1
    v_mfma_f32_16x16x32_bf16 v[80:83], v[38:41], a[16:19], v[80:83]
    v_mfma_f32_16x16x32_bf16 v[84:87], v[38:41], a[20:23], v[84:87]
    buffer_load_dwordx4 a[56:59], v7, s[36:39], s43 offen sc1
    v_mfma_f32_16x16x32_bf16 v[88:91], v[42:45], a[16:19], v[88:91]
    v_mfma_f32_16x16x32_bf16 v[92:95], v[42:45], a[20:23], v[92:95]
    s_waitcnt vmcnt(8)
    v_mfma_f32_16x16x32_bf16 v[56:59], v[46:49], a[24:27], v[56:59]
    s_waitcnt vmcnt(7)
    v_mfma_f32_16x16x32_bf16 v[60:63], v[46:49], a[28:31], v[60:63]
    buffer_load_dwordx4 a[60:63], v15, s[36:39], s43 offen sc1
    v_mfma_f32_16x16x32_bf16 v[64:67], v[50:53], a[24:27], v[64:67]
    v_mfma_f32_16x16x32_bf16 v[68:71], v[50:53], a[28:31], v[68:71]
    v_mfma_f32_16x16x32_bf16 v[72:75], v[96:99], a[24:27], v[72:75]
    ds_read_b64_tr_b16 v[116:117], v2 offset:41024
    buffer_load_dwordx4 a[64:67], v16, s[36:39], s44 offen offset:1024 sc1
    v_mfma_f32_16x16x32_bf16 v[76:79], v[96:99], a[28:31], v[76:79]
    ds_read_b64_tr_b16 v[118:119], v2 offset:43584
    v_mfma_f32_16x16x32_bf16 v[80:83], v[100:103], a[24:27], v[80:83]
    ds_read_b64_tr_b16 v[96:97], v2 offset:41056
    buffer_load_dwordx4 a[68:71], v17, s[36:39], s44 offen offset:1024 sc1
    v_mfma_f32_16x16x32_bf16 v[84:87], v[100:103], a[28:31], v[84:87]
    ds_read_b64_tr_b16 v[98:99], v2 offset:43616
    v_mfma_f32_16x16x32_bf16 v[88:91], v[104:107], a[24:27], v[88:91]
    ds_read_b64_tr_b16 v[100:101], v2 offset:41088
    v_mfma_f32_16x16x32_bf16 v[92:95], v[104:107], a[28:31], v[92:95]
    ds_read_b64_tr_b16 v[102:103], v2 offset:43648
    s_waitcnt vmcnt(9)
    v_mfma_f32_16x16x32_bf16 v[56:59], v[108:111], a[32:35], v[56:59]
    ds_read_b64_tr_b16 v[104:105], v2 offset:46080
    buffer_load_dwordx4 a[72:75], v16, s[36:39], s45 offen offset:1024 sc1
    s_waitcnt vmcnt(9)
    v_mfma_f32_16x16x32_bf16 v[60:63], v[108:111], a[36:39], v[60:63]
    ds_read_b64_tr_b16 v[106:107], v2 offset:48640
    v_mfma_f32_16x16x32_bf16 v[64:67], v[112:115], a[32:35], v[64:67]
    ds_read_b64_tr_b16 v[108:109], v2 offset:46112
    v_mfma_f32_16x16x32_bf16 v[68:71], v[112:115], a[36:39], v[68:71]
    ds_read_b64_tr_b16 v[110:111], v2 offset:48672
    s_waitcnt lgkmcnt(8)
    v_mfma_f32_16x16x32_bf16 v[72:75], v[116:119], a[32:35], v[72:75]
    ds_read_b64_tr_b16 v[112:113], v2 offset:46144
    buffer_load_dwordx4 a[76:79], v17, s[36:39], s45 offen offset:1024 sc1
    v_mfma_f32_16x16x32_bf16 v[76:79], v[116:119], a[36:39], v[76:79]
    ds_read_b64_tr_b16 v[114:115], v2 offset:48704
    s_waitcnt lgkmcnt(8)
    v_mfma_f32_16x16x32_bf16 v[80:83], v[96:99], a[32:35], v[80:83]
    ds_read_b64_tr_b16 v[116:117], v2 offset:46176
    v_mfma_f32_16x16x32_bf16 v[84:87], v[96:99], a[36:39], v[84:87]
    ds_read_b64_tr_b16 v[118:119], v2 offset:48736
    s_waitcnt lgkmcnt(8)
    v_mfma_f32_16x16x32_bf16 v[88:91], v[100:103], a[32:35], v[88:91]
    ds_read_b64_tr_b16 v[96:97], v2 offset:46208
    v_mfma_f32_16x16x32_bf16 v[92:95], v[100:103], a[36:39], v[92:95]
    ds_read_b64_tr_b16 v[98:99], v2 offset:48768
    s_waitcnt vmcnt(9) lgkmcnt(8)
    v_mfma_f32_16x16x32_bf16 v[56:59], v[104:107], a[40:43], v[56:59]
    ds_read_b64_tr_b16 v[100:101], v2 offset:51200
    s_waitcnt vmcnt(8)
    v_mfma_f32_16x16x32_bf16 v[60:63], v[104:107], a[44:47], v[60:63]
    ds_read_b64_tr_b16 v[102:103], v2 offset:53760
    s_waitcnt lgkmcnt(8)
    v_mfma_f32_16x16x32_bf16 v[64:67], v[108:111], a[40:43], v[64:67]
    ds_read_b64_tr_b16 v[104:105], v2 offset:51232
    v_mfma_f32_16x16x32_bf16 v[68:71], v[108:111], a[44:47], v[68:71]
    ds_read_b64_tr_b16 v[106:107], v2 offset:53792
    s_waitcnt lgkmcnt(8)
    v_mfma_f32_16x16x32_bf16 v[72:75], v[112:115], a[40:43], v[72:75]
    ds_read_b64_tr_b16 v[108:109], v2 offset:51264
    v_mfma_f32_16x16x32_bf16 v[76:79], v[112:115], a[44:47], v[76:79]
    ds_read_b64_tr_b16 v[110:111], v2 offset:53824
    s_waitcnt lgkmcnt(8)
    v_mfma_f32_16x16x32_bf16 v[80:83], v[116:119], a[40:43], v[80:83]
    ds_read_b64_tr_b16 v[112:113], v2 offset:51296
    v_mfma_f32_16x16x32_bf16 v[84:87], v[116:119], a[44:47], v[84:87]
    ds_read_b64_tr_b16 v[114:115], v2 offset:53856
    s_waitcnt lgkmcnt(8)
    v_mfma_f32_16x16x32_bf16 v[88:91], v[96:99], a[40:43], v[88:91]
    ds_read_b64_tr_b16 v[116:117], v2 offset:51328
    v_mfma_f32_16x16x32_bf16 v[92:95], v[96:99], a[44:47], v[92:95]
    ds_read_b64_tr_b16 v[118:119], v2 offset:53888
    s_waitcnt vmcnt(7) lgkmcnt(8)
    v_mfma_f32_16x16x32_bf16 v[56:59], v[100:103], a[48:51], v[56:59]
    ds_read_b64_tr_b16 v[96:97], v2 offset:56320
    s_waitcnt vmcnt(6)
    v_mfma_f32_16x16x32_bf16 v[60:63], v[100:103], a[52:55], v[60:63]
    ds_read_b64_tr_b16 v[98:99], v2 offset:58880
    s_waitcnt lgkmcnt(8)
    v_mfma_f32_16x16x32_bf16 v[64:67], v[104:107], a[48:51], v[64:67]
    ds_read_b64_tr_b16 v[100:101], v2 offset:56352
    v_mfma_f32_16x16x32_bf16 v[68:71], v[104:107], a[52:55], v[68:71]
    ds_read_b64_tr_b16 v[102:103], v2 offset:58912
    s_waitcnt lgkmcnt(8)
    v_mfma_f32_16x16x32_bf16 v[72:75], v[108:111], a[48:51], v[72:75]
    ds_read_b64_tr_b16 v[104:105], v2 offset:56384
    v_mfma_f32_16x16x32_bf16 v[76:79], v[108:111], a[52:55], v[76:79]
    ds_read_b64_tr_b16 v[106:107], v2 offset:58944
    s_waitcnt lgkmcnt(8)
    v_mfma_f32_16x16x32_bf16 v[80:83], v[112:115], a[48:51], v[80:83]
    ds_read_b64_tr_b16 v[108:109], v2 offset:56416
    v_mfma_f32_16x16x32_bf16 v[84:87], v[112:115], a[52:55], v[84:87]
    ds_read_b64_tr_b16 v[110:111], v2 offset:58976
    s_waitcnt lgkmcnt(8)
    v_mfma_f32_16x16x32_bf16 v[88:91], v[116:119], a[48:51], v[88:91]
    ds_read_b64_tr_b16 v[112:113], v2 offset:56448
    v_mfma_f32_16x16x32_bf16 v[92:95], v[116:119], a[52:55], v[92:95]
    ds_read_b64_tr_b16 v[114:115], v2 offset:59008
    s_waitcnt vmcnt(5) lgkmcnt(8)
    v_mfma_f32_16x16x32_bf16 v[56:59], v[96:99], a[56:59], v[56:59]
    ds_read_b64_tr_b16 v[116:117], v2 offset:10240
    s_waitcnt vmcnt(4)
    v_mfma_f32_16x16x32_bf16 v[60:63], v[96:99], a[60:63], v[60:63]
    ds_read_b64_tr_b16 v[118:119], v2 offset:12800
    s_waitcnt lgkmcnt(8)
    v_mfma_f32_16x16x32_bf16 v[64:67], v[100:103], a[56:59], v[64:67]
    ds_read_b64_tr_b16 v[96:97], v2 offset:10272
    v_mfma_f32_16x16x32_bf16 v[68:71], v[100:103], a[60:63], v[68:71]
    ds_read_b64_tr_b16 v[98:99], v2 offset:12832
    s_waitcnt lgkmcnt(8)
    v_mfma_f32_16x16x32_bf16 v[72:75], v[104:107], a[56:59], v[72:75]
    ds_read_b64_tr_b16 v[100:101], v2 offset:10304
    v_mfma_f32_16x16x32_bf16 v[76:79], v[104:107], a[60:63], v[76:79]
    ds_read_b64_tr_b16 v[102:103], v2 offset:12864
    s_waitcnt vmcnt(0)
    v_mov_b32 v120, 1
    s_cmp_eq_u32 s61, 0
    s_cbranch_scc0 L_s3Aa_far
    s_mov_b64 exec, 1
    buffer_store_dword v120, off, s[32:35], s58 offset:2048
    s_mov_b64 exec, -1
L_s3Aa_st:
    s_waitcnt lgkmcnt(8)
    v_mfma_f32_16x16x32_bf16 v[80:83], v[108:111], a[56:59], v[80:83]
    ds_read_b64_tr_b16 v[104:105], v2 offset:10336
    v_mfma_f32_16x16x32_bf16 v[84:87], v[108:111], a[60:63], v[84:87]
    ds_read_b64_tr_b16 v[106:107], v2 offset:12896
    s_waitcnt lgkmcnt(8)
    v_mfma_f32_16x16x32_bf16 v[88:91], v[112:115], a[56:59], v[88:91]
    ds_read_b64_tr_b16 v[108:109], v2 offset:10368
    v_mfma_f32_16x16x32_bf16 v[92:95], v[112:115], a[60:63], v[92:95]
    ds_read_b64_tr_b16 v[110:111], v2 offset:12928
    s_waitcnt lgkmcnt(8)
    v_mfma_f32_16x16x32_bf16 v[56:59], v[116:119], a[64:67], v[56:59]
    ds_read_b64_tr_b16 v[112:113], v2 offset:15360
    v_mfma_f32_16x16x32_bf16 v[60:63], v[116:119], a[68:71], v[60:63]
    ds_read_b64_tr_b16 v[114:115], v2 offset:17920
    s_waitcnt lgkmcnt(8)
    v_mfma_f32_16x16x32_bf16 v[64:67], v[96:99], a[64:67], v[64:67]
    ds_read_b64_tr_b16 v[116:117], v2 offset:15392
    v_mfma_f32_16x16x32_bf16 v[68:71], v[96:99], a[68:71], v[68:71]
    ds_read_b64_tr_b16 v[118:119], v2 offset:17952
    s_waitcnt lgkmcnt(8)
    v_mfma_f32_16x16x32_bf16 v[72:75], v[100:103], a[64:67], v[72:75]
    ds_read_b64_tr_b16 v[96:97], v2 offset:15424
    v_mfma_f32_16x16x32_bf16 v[76:79], v[100:103], a[68:71], v[76:79]
    ds_read_b64_tr_b16 v[98:99], v2 offset:17984
    s_waitcnt lgkmcnt(8)
    v_mfma_f32_16x16x32_bf16 v[80:83], v[104:107], a[64:67], v[80:83]
    ds_read_b64_tr_b16 v[100:101], v2 offset:15456
    v_mfma_f32_16x16x32_bf16 v[84:87], v[104:107], a[68:71], v[84:87]
    ds_read_b64_tr_b16 v[102:103], v2 offset:18016
    s_waitcnt lgkmcnt(8)
    v_mfma_f32_16x16x32_bf16 v[88:91], v[108:111], a[64:67], v[88:91]
    ds_read_b64_tr_b16 v[104:105], v2 offset:15488
    v_mfma_f32_16x16x32_bf16 v[92:95], v[108:111], a[68:71], v[92:95]
    ds_read_b64_tr_b16 v[106:107], v2 offset:18048
    s_barrier
    s_waitcnt lgkmcnt(8)
    v_mfma_f32_16x16x32_bf16 v[56:59], v[112:115], a[72:75], v[56:59]
    ds_read_b128 v[34:37], v18 offset:0
    v_mfma_f32_16x16x32_bf16 v[60:63], v[112:115], a[76:79], v[60:63]
    buffer_load_dword v122, v121, s[32:35], s69 offen offset:2048 sc1
    s_waitcnt lgkmcnt(7)
    v_mfma_f32_16x16x32_bf16 v[64:67], v[116:119], a[72:75], v[64:67]
    ds_read_b128 v[38:41], v18 offset:1024
    v_mfma_f32_16x16x32_bf16 v[68:71], v[116:119], a[76:79], v[68:71]
    s_waitcnt lgkmcnt(6)
    v_mfma_f32_16x16x32_bf16 v[72:75], v[96:99], a[72:75], v[72:75]
    ds_read_b128 v[42:45], v18 offset:2048
    v_mfma_f32_16x16x32_bf16 v[76:79], v[96:99], a[76:79], v[76:79]
    s_waitcnt lgkmcnt(5)
    v_mfma_f32_16x16x32_bf16 v[80:83], v[100:103], a[72:75], v[80:83]
    ds_read_b128 v[46:49], v18 offset:3072
    v_mfma_f32_16x16x32_bf16 v[84:87], v[100:103], a[76:79], v[84:87]
    s_waitcnt lgkmcnt(4)
    v_mfma_f32_16x16x32_bf16 v[88:91], v[104:107], a[72:75], v[88:91]
    ds_read_b128 v[50:53], v18 offset:4096
    v_mfma_f32_16x16x32_bf16 v[92:95], v[104:107], a[76:79], v[92:95]
    ds_read_b128 v[96:99], v18 offset:5120
    ds_read_b128 v[100:103], v18 offset:6144
    ds_read_b128 v[104:107], v18 offset:7168
    ds_read_b128 v[108:111], v18 offset:8192
    ds_read_b128 v[112:115], v18 offset:9216
    s_add_u32 s25, s66, 15360
    s_add_u32 s26, s66, 30720
    s_add_u32 s27, s66, 46080
    s_add_u32 s40, s66, 61440
    s_add_u32 s41, s66, 76800
    s_waitcnt lgkmcnt(9)
    v_pk_add_f32 v[56:57], v[56:57], v[34:35]
    v_pk_add_f32 v[58:59], v[58:59], v[36:37]
    v_cvt_pk_bf16_f32 v56, v56, v57
    v_cvt_pk_bf16_f32 v57, v58, v59
    ds_write_b64 v19, v[56:57] offset:0
    s_waitcnt lgkmcnt(9)
    v_pk_add_f32 v[64:65], v[64:65], v[38:39]
    v_pk_add_f32 v[66:67], v[66:67], v[40:41]
    v_cvt_pk_bf16_f32 v64, v64, v65
    v_cvt_pk_bf16_f32 v65, v66, v67
    ds_write_b64 v19, v[64:65] offset:32
    s_waitcnt lgkmcnt(9)
    v_pk_add_f32 v[72:73], v[72:73], v[42:43]
    v_pk_add_f32 v[74:75], v[74:75], v[44:45]
    v_cvt_pk_bf16_f32 v72, v72, v73
    v_cvt_pk_bf16_f32 v73, v74, v75
    ds_write_b64 v19, v[72:73] offset:64
    s_waitcnt lgkmcnt(9)
    v_pk_add_f32 v[80:81], v[80:81], v[46:47]
    v_pk_add_f32 v[82:83], v[82:83], v[48:49]
    v_cvt_pk_bf16_f32 v80, v80, v81
    v_cvt_pk_bf16_f32 v81, v82, v83
    ds_write_b64 v19, v[80:81] offset:96
    s_waitcnt lgkmcnt(9)
    v_pk_add_f32 v[88:89], v[88:89], v[50:51]
    v_pk_add_f32 v[90:91], v[90:91], v[52:53]
    v_cvt_pk_bf16_f32 v88, v88, v89
    v_cvt_pk_bf16_f32 v89, v90, v91
    ds_write_b64 v19, v[88:89] offset:128
    ds_read_b128 a[0:3], v20 offset:0
    ds_read_b128 a[4:7], v20 offset:1056
    s_waitcnt lgkmcnt(11)
    v_pk_add_f32 v[60:61], v[60:61], v[96:97]
    v_pk_add_f32 v[62:63], v[62:63], v[98:99]
    v_cvt_pk_bf16_f32 v60, v60, v61
    v_cvt_pk_bf16_f32 v61, v62, v63
    ds_write_b64 v19, v[60:61] offset:2816
    s_waitcnt lgkmcnt(11)
    v_pk_add_f32 v[68:69], v[68:69], v[100:101]
    v_pk_add_f32 v[70:71], v[70:71], v[102:103]
    v_cvt_pk_bf16_f32 v68, v68, v69
    v_cvt_pk_bf16_f32 v69, v70, v71
    ds_write_b64 v19, v[68:69] offset:2848
    s_waitcnt lgkmcnt(11)
    v_pk_add_f32 v[76:77], v[76:77], v[104:105]
    v_pk_add_f32 v[78:79], v[78:79], v[106:107]
    v_cvt_pk_bf16_f32 v76, v76, v77
    v_cvt_pk_bf16_f32 v77, v78, v79
    ds_write_b64 v19, v[76:77] offset:2880
    s_waitcnt vmcnt(0)
    v_cmp_eq_u32 vcc, 0, v122
    s_cbranch_vccz L_f3Aa_ok
    s_mov_b32 s67, 0
L_f3Aa:
    buffer_load_dword v122, v121, s[32:35], s69 offen offset:2048 sc1
    s_add_u32 s67, s67, 1
    s_waitcnt vmcnt(0)
    v_cmp_eq_u32 vcc, 0, v122
    s_cmpk_ge_u32 s67, 20000
    s_cbranch_scc1 L_f3Aa_ok
    s_cbranch_vccnz L_f3Aa
L_f3Aa_ok:
    s_waitcnt lgkmcnt(4)
    buffer_store_dwordx4 a[0:3], v21, s[36:39], s66 offen
    s_waitcnt lgkmcnt(3)
    buffer_store_dwordx4 a[4:7], v21, s[36:39], s25 offen
    v_pk_add_f32 v[84:85], v[84:85], v[108:109]
    v_pk_add_f32 v[86:87], v[86:87], v[110:111]
    v_cvt_pk_bf16_f32 v84, v84, v85
    v_cvt_pk_bf16_f32 v85, v86, v87
    ds_write_b64 v19, v[84:85] offset:2912
    v_pk_add_f32 v[92:93], v[92:93], v[112:113]
    v_pk_add_f32 v[94:95], v[94:95], v[114:115]
    v_cvt_pk_bf16_f32 v92, v92, v93
    v_cvt_pk_bf16_f32 v93, v94, v95
    ds_write_b64 v19, v[92:93] offset:2944
    ds_read_b128 a[8:11], v20 offset:2112
    ds_read_b128 a[12:15], v20 offset:3168
    ds_read_b128 a[16:19], v20 offset:4224
    ds_read_b128 a[20:23], v20 offset:5280
    s_waitcnt lgkmcnt(3)
    buffer_store_dwordx4 a[8:11], v21, s[36:39], s26 offen
    s_waitcnt lgkmcnt(2)
    buffer_store_dwordx4 a[12:15], v21, s[36:39], s27 offen
    s_waitcnt lgkmcnt(1)
    buffer_store_dwordx4 a[16:19], v21, s[36:39], s40 offen
    s_waitcnt lgkmcnt(0)
    buffer_store_dwordx4 a[20:23], v54, s[36:39], s41 offen
    s_endpgm
.p2align 12
.fill 184, 4, 0xbf800000
L_Ba:
    s_waitcnt lgkmcnt(4)
    v_mfma_f32_16x16x32_bf16 v[96:99], a[52:55], a[16:19], v[96:99]
    v_mfma_f32_16x16x32_bf16 v[100:103], a[52:55], a[20:23], v[100:103]
    v_mfma_f32_16x16x32_bf16 v[104:107], a[52:55], a[24:27], v[104:107]
    v_mfma_f32_16x16x32_bf16 v[108:111], a[52:55], a[28:31], v[108:111]
    s_waitcnt lgkmcnt(2)
    v_mfma_f32_16x16x32_bf16 v[112:115], a[56:59], a[16:19], v[112:115]
    v_mfma_f32_16x16x32_bf16 v[116:119], a[56:59], a[20:23], v[116:119]
    v_mfma_f32_16x16x32_bf16 v[120:123], a[56:59], a[24:27], v[120:123]
    v_mfma_f32_16x16x32_bf16 v[124:127], a[56:59], a[28:31], v[124:127]
    s_waitcnt lgkmcnt(0)
    v_mfma_f32_16x16x32_bf16 v[42:45], a[60:63], a[16:19], v[42:45]
    v_mfma_f32_16x16x32_bf16 v[46:49], a[60:63], a[20:23], v[46:49]
    v_cvt_pk_bf16_f32 v96, v96, v97
    v_cvt_pk_bf16_f32 v97, v98, v99
    ds_write_b64 v34, v[96:97] offset:20480
    v_cvt_pk_bf16_f32 v100, v100, v101
    v_cvt_pk_bf16_f32 v101, v102, v103
    ds_write_b64 v34, v[100:101] offset:21120
    v_cvt_pk_bf16_f32 v104, v104, v105
    v_cvt_pk_bf16_f32 v105, v106, v107
    ds_write_b64 v35, v[104:105] offset:20480
    v_cvt_pk_bf16_f32 v108, v108, v109
    v_cvt_pk_bf16_f32 v109, v110, v111
    ds_write_b64 v35, v[108:109] offset:21120
    v_cvt_pk_bf16_f32 v112, v112, v113
    v_cvt_pk_bf16_f32 v113, v114, v115
    ds_write_b64 v36, v[112:113] offset:20480
    v_cvt_pk_bf16_f32 v116, v116, v117
    v_cvt_pk_bf16_f32 v117, v118, v119
    ds_write_b64 v36, v[116:117] offset:21120
    v_cvt_pk_bf16_f32 v120, v120, v121
    v_cvt_pk_bf16_f32 v121, v122, v123
    ds_write_b64 v37, v[120:121] offset:20480
    v_cvt_pk_bf16_f32 v124, v124, v125
    v_cvt_pk_bf16_f32 v125, v126, v127
    ds_write_b64 v37, v[124:125] offset:21120
    v_cvt_pk_bf16_f32 v42, v42, v43
    v_cvt_pk_bf16_f32 v43, v44, v45
    ds_write_b64 v38, v[42:43] offset:20480
    v_cvt_pk_bf16_f32 v46, v46, v47
    v_cvt_pk_bf16_f32 v47, v48, v49
    ds_write_b64 v38, v[46:47] offset:21120
    v_mov_b32 v104, 0xb5c1a2f1
    v_mov_b32 v120, -1
    v_mov_b32 v121, -1
    v_mov_b32 v122, -1
    v_mov_b32 v123, -1
    v_pk_fma_f32 v[96:97], v[56:57], s[74:75], v[104:105] op_sel_hi:[1,1,0]
    v_pk_fma_f32 v[98:99], v[58:59], s[74:75], v[104:105] op_sel_hi:[1,1,0]
    v_pk_fma_f32 v[100:101], v[60:61], s[74:75], v[104:105] op_sel_hi:[1,1,0]
    v_pk_fma_f32 v[102:103], v[62:63], s[74:75], v[104:105] op_sel_hi:[1,1,0]
    v_exp_f32_e64 v96, v96 clamp
    v_max_f32 v56, 0x358637bd, v56
    v_exp_f32_e64 v97, v97 clamp
    v_max_f32 v57, 0x358637bd, v57
    v_exp_f32_e64 v98, v98 clamp
    v_max_f32 v58, 0x358637bd, v58
    v_exp_f32_e64 v99, v99 clamp
    v_max_f32 v59, 0x358637bd, v59
    v_exp_f32_e64 v100, v100 clamp
    v_max_f32 v60, 0x358637bd, v60
    v_exp_f32_e64 v101, v101 clamp
    v_max_f32 v61, 0x358637bd, v61
    v_exp_f32_e64 v102, v102 clamp
    v_max_f32 v62, 0x358637bd, v62
    v_exp_f32_e64 v103, v103 clamp
    v_max_f32 v63, 0x358637bd, v63
    buffer_store_dwordx4 v[120:123], v54, s[32:35], s60 offen sc1
    v_pk_add_f32 v[56:57], v[56:57], v[96:97]
    v_pk_add_f32 v[58:59], v[58:59], v[98:99]
    v_pk_add_f32 v[60:61], v[60:61], v[100:101]
    v_pk_add_f32 v[62:63], v[62:63], v[102:103]
    v_pk_fma_f32 v[96:97], v[64:65], s[74:75], v[104:105] op_sel_hi:[1,1,0]
    v_pk_fma_f32 v[98:99], v[66:67], s[74:75], v[104:105] op_sel_hi:[1,1,0]
    v_pk_fma_f32 v[100:101], v[68:69], s[74:75], v[104:105] op_sel_hi:[1,1,0]
    v_pk_fma_f32 v[102:103], v[70:71], s[74:75], v[104:105] op_sel_hi:[1,1,0]
    v_exp_f32_e64 v96, v96 clamp
    v_max_f32 v64, 0x358637bd, v64
    v_exp_f32_e64 v97, v97 clamp
    v_max_f32 v65, 0x358637bd, v65
    v_exp_f32_e64 v98, v98 clamp
    v_max_f32 v66, 0x358637bd, v66
    v_exp_f32_e64 v99, v99 clamp
    v_max_f32 v67, 0x358637bd, v67
    v_exp_f32_e64 v100, v100 clamp
    v_max_f32 v68, 0x358637bd, v68
    v_exp_f32_e64 v101, v101 clamp
    v_max_f32 v69, 0x358637bd, v69
    v_and_b32 v126, 31, v1
    v_lshlrev_b32 v126, 2, v126
    buffer_load_dword v124, v126, s[32:35], s68 offen offset:512 sc1
    v_and_b32 v126, 12, v126
    s_lshl_b32 s58, s48, 4
    buffer_load_dword v125, v126, s[44:47], s58 offen sc1
    v_exp_f32_e64 v102, v102 clamp
    v_max_f32 v70, 0x358637bd, v70
    v_exp_f32_e64 v103, v103 clamp
    v_max_f32 v71, 0x358637bd, v71
    v_pk_add_f32 v[64:65], v[64:65], v[96:97]
    v_pk_add_f32 v[66:67], v[66:67], v[98:99]
    v_pk_add_f32 v[68:69], v[68:69], v[100:101]
    v_pk_add_f32 v[70:71], v[70:71], v[102:103]
    v_pk_fma_f32 v[96:97], v[72:73], s[74:75], v[104:105] op_sel_hi:[1,1,0]
    v_pk_fma_f32 v[98:99], v[74:75], s[74:75], v[104:105] op_sel_hi:[1,1,0]
    v_pk_fma_f32 v[100:101], v[76:77], s[74:75], v[104:105] op_sel_hi:[1,1,0]
    v_pk_fma_f32 v[102:103], v[78:79], s[74:75], v[104:105] op_sel_hi:[1,1,0]
    v_exp_f32_e64 v96, v96 clamp
    v_max_f32 v72, 0x358637bd, v72
    v_exp_f32_e64 v97, v97 clamp
    v_max_f32 v73, 0x358637bd, v73
    v_exp_f32_e64 v98, v98 clamp
    v_max_f32 v74, 0x358637bd, v74
    v_exp_f32_e64 v99, v99 clamp
    v_max_f32 v75, 0x358637bd, v75
    v_exp_f32_e64 v100, v100 clamp
    v_max_f32 v76, 0x358637bd, v76
    v_exp_f32_e64 v101, v101 clamp
    v_max_f32 v77, 0x358637bd, v77
    v_exp_f32_e64 v102, v102 clamp
    v_max_f32 v78, 0x358637bd, v78
    v_exp_f32_e64 v103, v103 clamp
    v_max_f32 v79, 0x358637bd, v79
    v_pk_add_f32 v[72:73], v[72:73], v[96:97]
    v_pk_add_f32 v[74:75], v[74:75], v[98:99]
    v_pk_add_f32 v[76:77], v[76:77], v[100:101]
    v_pk_add_f32 v[78:79], v[78:79], v[102:103]
    v_pk_fma_f32 v[96:97], v[80:81], s[74:75], v[104:105] op_sel_hi:[1,1,0]
    v_pk_fma_f32 v[98:99], v[82:83], s[74:75], v[104:105] op_sel_hi:[1,1,0]
    v_pk_fma_f32 v[100:101], v[84:85], s[74:75], v[104:105] op_sel_hi:[1,1,0]
    v_pk_fma_f32 v[102:103], v[86:87], s[74:75], v[104:105] op_sel_hi:[1,1,0]
    v_exp_f32_e64 v96, v96 clamp
    v_max_f32 v80, 0x358637bd, v80
    v_exp_f32_e64 v97, v97 clamp
    v_max_f32 v81, 0x358637bd, v81
    v_exp_f32_e64 v98, v98 clamp
    v_max_f32 v82, 0x358637bd, v82
    v_exp_f32_e64 v99, v99 clamp
    v_max_f32 v83, 0x358637bd, v83
    v_exp_f32_e64 v100, v100 clamp
    v_max_f32 v84, 0x358637bd, v84
    v_exp_f32_e64 v101, v101 clamp
    v_max_f32 v85, 0x358637bd, v85
    v_exp_f32_e64 v102, v102 clamp
    v_max_f32 v86, 0x358637bd, v86
    v_exp_f32_e64 v103, v103 clamp
    v_max_f32 v87, 0x358637bd, v87
    v_pk_add_f32 v[80:81], v[80:81], v[96:97]
    v_pk_add_f32 v[82:83], v[82:83], v[98:99]
    v_pk_add_f32 v[84:85], v[84:85], v[100:101]
    v_pk_add_f32 v[86:87], v[86:87], v[102:103]
    v_pk_fma_f32 v[96:97], v[88:89], s[74:75], v[104:105] op_sel_hi:[1,1,0]
    v_pk_fma_f32 v[98:99], v[90:91], s[74:75], v[104:105] op_sel_hi:[1,1,0]
    v_pk_fma_f32 v[100:101], v[92:93], s[74:75], v[104:105] op_sel_hi:[1,1,0]
    v_pk_fma_f32 v[102:103], v[94:95], s[74:75], v[104:105] op_sel_hi:[1,1,0]
    v_exp_f32_e64 v96, v96 clamp
    v_max_f32 v88, 0x358637bd, v88
    v_exp_f32_e64 v97, v97 clamp
    v_max_f32 v89, 0x358637bd, v89
    v_exp_f32_e64 v98, v98 clamp
    v_max_f32 v90, 0x358637bd, v90
    v_exp_f32_e64 v99, v99 clamp
    v_max_f32 v91, 0x358637bd, v91
    v_exp_f32_e64 v100, v100 clamp
    v_max_f32 v92, 0x358637bd, v92
    v_exp_f32_e64 v101, v101 clamp
    v_max_f32 v93, 0x358637bd, v93
    v_exp_f32_e64 v102, v102 clamp
    v_max_f32 v94, 0x358637bd, v94
    v_exp_f32_e64 v103, v103 clamp
    v_max_f32 v95, 0x358637bd, v95
    v_pk_add_f32 v[88:89], v[88:89], v[96:97]
    v_pk_add_f32 v[90:91], v[90:91], v[98:99]
    v_pk_add_f32 v[92:93], v[92:93], v[100:101]
    v_pk_add_f32 v[94:95], v[94:95], v[102:103]
    v_cvt_pk_bf16_f32 v56, v56, v57
    v_cvt_pk_bf16_f32 v57, v58, v59
    ds_write_b64 v34, v[56:57] offset:0
    v_cvt_pk_bf16_f32 v60, v60, v61
    v_cvt_pk_bf16_f32 v61, v62, v63
    ds_write_b64 v34, v[60:61] offset:640
    v_cvt_pk_bf16_f32 v64, v64, v65
    v_cvt_pk_bf16_f32 v65, v66, v67
    ds_write_b64 v35, v[64:65] offset:0
    v_cvt_pk_bf16_f32 v68, v68, v69
    v_cvt_pk_bf16_f32 v69, v70, v71
    ds_write_b64 v35, v[68:69] offset:640
    v_cvt_pk_bf16_f32 v72, v72, v73
    v_cvt_pk_bf16_f32 v73, v74, v75
    ds_write_b64 v36, v[72:73] offset:0
    v_cvt_pk_bf16_f32 v76, v76, v77
    v_cvt_pk_bf16_f32 v77, v78, v79
    ds_write_b64 v36, v[76:77] offset:640
    v_cvt_pk_bf16_f32 v80, v80, v81
    v_cvt_pk_bf16_f32 v81, v82, v83
    ds_write_b64 v37, v[80:81] offset:0
    v_cvt_pk_bf16_f32 v84, v84, v85
    v_cvt_pk_bf16_f32 v85, v86, v87
    ds_write_b64 v37, v[84:85] offset:640
    v_cvt_pk_bf16_f32 v88, v88, v89
    v_cvt_pk_bf16_f32 v89, v90, v91
    ds_write_b64 v38, v[88:89] offset:0
    v_cvt_pk_bf16_f32 v92, v92, v93
    v_cvt_pk_bf16_f32 v93, v94, v95
    ds_write_b64 v38, v[92:93] offset:640
    v_accvgpr_read_b32 v42, a100
    v_accvgpr_read_b32 v43, a101
    v_accvgpr_read_b32 v44, a102
    v_accvgpr_read_b32 v45, a103
    v_accvgpr_read_b32 v46, a104
    v_accvgpr_read_b32 v47, a105
    v_accvgpr_read_b32 v48, a106
    v_accvgpr_read_b32 v49, a107
    s_waitcnt lgkmcnt(0)
    s_barrier
    s_setprio 1
    ds_read_b64_tr_b16 a[0:1], v40 offset:61440
    s_add_u32 m0, s55, 20480
    s_bfe_u32 s56, s71, 0x40000
    s_mul_i32 s56, s56, 245760
    s_add_u32 s56, s56, s54
    ds_read_b64_tr_b16 a[2:3], v40 offset:61480
    ds_read_b64_tr_b16 a[4:5], v42
    ds_read_b64_tr_b16 a[6:7], v43
    ds_read_b64_tr_b16 a[32:33], v40 offset:40960
    ds_read_b64_tr_b16 a[34:35], v40 offset:41000
    ds_read_b64_tr_b16 a[36:37], v41 offset:0
    buffer_load_dwordx4 v18, s[24:27], s56 offen offset:0 lds
    ds_read_b64_tr_b16 a[38:39], v41 offset:40
    ds_read_b64_tr_b16 a[8:9], v40 offset:62720
    ds_read_b64_tr_b16 a[10:11], v40 offset:62760
    ds_read_b64_tr_b16 a[12:13], v44
    ds_read_b64_tr_b16 a[14:15], v45
    s_waitcnt lgkmcnt(6)
    v_mfma_f32_16x16x32_bf16 v[56:59], a[32:35], a[0:3], 0
    ds_read_b64_tr_b16 a[44:45], v40 offset:42240
    buffer_load_dwordx4 v19, s[24:27], s56 offen offset:1024 lds
    ds_read_b64_tr_b16 a[46:47], v40 offset:42280
    v_mfma_f32_16x16x32_bf16 v[60:63], a[32:35], a[4:7], 0
    ds_read_b64_tr_b16 a[48:49], v41 offset:1280
    ds_read_b64_tr_b16 a[50:51], v41 offset:1320
    s_waitcnt lgkmcnt(8)
    v_mfma_f32_16x16x32_bf16 v[64:67], a[36:39], a[0:3], 0
    ds_read_b64_tr_b16 a[16:17], v40 offset:64000
    ds_read_b64_tr_b16 a[18:19], v40 offset:64040
    buffer_load_dwordx4 v20, s[24:27], s56 offen offset:2048 lds
    v_mfma_f32_16x16x32_bf16 v[68:71], a[36:39], a[4:7], 0
    ds_read_b64_tr_b16 a[20:21], v46
    ds_read_b64_tr_b16 a[22:23], v47
    s_waitcnt lgkmcnt(6)
    v_mfma_f32_16x16x32_bf16 v[56:59], a[44:47], a[8:11], v[56:59]
    ds_read_b64_tr_b16 a[56:57], v40 offset:43520
    ds_read_b64_tr_b16 a[58:59], v40 offset:43560
    v_mfma_f32_16x16x32_bf16 v[60:63], a[44:47], a[12:15], v[60:63]
    buffer_load_dwordx4 v21, s[24:27], s56 offen offset:3072 lds
    ds_read_b64_tr_b16 a[60:61], v41 offset:2560
    ds_read_b64_tr_b16 a[62:63], v41 offset:2600
    s_waitcnt lgkmcnt(8)
    v_mfma_f32_16x16x32_bf16 v[64:67], a[48:51], a[8:11], v[64:67]
    ds_read_b64_tr_b16 a[24:25], v40 offset:65280
    ds_read_b64_tr_b16 a[26:27], v40 offset:65320
    v_mfma_f32_16x16x32_bf16 v[68:71], a[48:51], a[12:15], v[68:71]
    ds_read_b64_tr_b16 a[28:29], v48
    s_add_u32 m0, s55, 24576
    ds_read_b64_tr_b16 a[30:31], v49
    s_waitcnt lgkmcnt(6)
    v_mfma_f32_16x16x32_bf16 v[56:59], a[56:59], a[16:19], v[56:59]
    ds_read_b64_tr_b16 a[68:69], v40 offset:44800
    ds_read_b64_tr_b16 a[70:71], v40 offset:44840
    v_mfma_f32_16x16x32_bf16 v[60:63], a[56:59], a[20:23], v[60:63]
    ds_read_b64_tr_b16 a[72:73], v41 offset:3840
    ds_read_b64_tr_b16 a[74:75], v41 offset:3880
    buffer_load_dwordx4 v22, s[24:27], s56 offen lds
    s_waitcnt lgkmcnt(8)
    v_mfma_f32_16x16x32_bf16 v[64:67], a[60:63], a[16:19], v[64:67]
    v_mfma_f32_16x16x32_bf16 v[68:71], a[60:63], a[20:23], v[68:71]
    s_waitcnt lgkmcnt(2)
    v_mfma_f32_16x16x32_bf16 v[56:59], a[68:71], a[24:27], v[56:59]
    v_mfma_f32_16x16x32_bf16 v[60:63], a[68:71], a[28:31], v[60:63]
    s_waitcnt lgkmcnt(0)
    v_mfma_f32_16x16x32_bf16 v[64:67], a[72:75], a[24:27], v[64:67]
    v_mfma_f32_16x16x32_bf16 v[68:71], a[72:75], a[28:31], v[68:71]
    s_getreg_b32 s57, hwreg(HW_REG_XCC_ID)
    s_and_b32 s57, s57, 15
    s_add_u32 s57, s57, 1
    s_mov_b32 s61, 0
    s_waitcnt vmcnt(6)
    v_cmp_ne_u32 vcc, s57, v124
    s_cbranch_vccnz L_hsBa_slow
L_hsBa_ok:
    s_waitcnt vmcnt(5)
    v_cmp_eq_u32 vcc, 0, v125
    s_cbranch_vccnz L_alBa_slow
L_alBa_ok:
    s_lshr_b32 s57, s50, 1
    s_lshl2_add_u32 s57, s48, s57
    s_lshl_b32 s57, s57, 12
    s_and_b32 s58, s50, 1
    s_lshl2_add_u32 s58, s58, s51
    s_lshl_b32 s58, s58, 7
    s_add_u32 s53, s57, s58
    s_add_u32 s53, s53, 0x280c00
    s_lshl2_add_u32 s58, s50, s51
    s_lshl_b32 s58, s58, 4
    s_add_u32 s69, s58, s68
    s_lshl2_add_u32 s58, s52, s69
    v_and_b32 v34, 3, v1
    v_lshlrev_b32 v34, 2, v34
    v_and_b32 v35, 15, v1
    v_cmp_gt_u32 vcc, 15, v35
    v_mov_b32 v35, 0x40000000
    s_nop 0
    v_cndmask_b32 v35, v35, v33, vcc
    v_cvt_pk_bf16_f32 v80, v56, v57
    v_cvt_pk_bf16_f32 v81, v58, v59
    v_cvt_pk_bf16_f32 v82, v60, v61
    v_cvt_pk_bf16_f32 v83, v62, v63
    v_cvt_pk_bf16_f32 v84, v64, v65
    v_cvt_pk_bf16_f32 v85, v66, v67
    v_cvt_pk_bf16_f32 v86, v68, v69
    v_cvt_pk_bf16_f32 v87, v70, v71
    v_permlane16_swap_b32 v80, v82
    v_permlane16_swap_b32 v81, v83
    v_permlane16_swap_b32 v84, v86
    v_permlane16_swap_b32 v85, v87
    s_cmp_eq_u32 s61, 0
    s_cbranch_scc0 L_pubBa_far
    buffer_store_dwordx4 v[80:83], v50, s[36:39], s62 offen
    buffer_store_dwordx4 v[84:87], v52, s[36:39], s62 offen
L_pubBa_st:
    s_add_u32 m0, s55, 40960
    s_bfe_u32 s56, s71, 0x40010
    s_mul_i32 s56, s56, 245760
    s_add_u32 s56, s56, s54
    buffer_load_dwordx4 v18, s[24:27], s56 offen offset:0 lds
    buffer_load_dwordx4 v19, s[24:27], s56 offen offset:1024 lds
    buffer_load_dwordx4 v20, s[24:27], s56 offen offset:2048 lds
    buffer_load_dwordx4 v21, s[24:27], s56 offen offset:3072 lds
    s_add_u32 m0, s55, 45056
    s_nop 0
    buffer_load_dwordx4 v22, s[24:27], s56 offen lds
    s_waitcnt vmcnt(5)
    v_mov_b32 v55, 1
    s_cmp_eq_u32 s61, 0
    s_cbranch_scc0 L_s1Ba_far
    s_mov_b64 exec, 1
    buffer_store_dword v55, off, s[32:35], s58 offset:0
    s_mov_b64 exec, -1
L_s1Ba_st:
    s_barrier
    s_mov_b32 s67, 0
L_f1Ba:
    buffer_load_dword v55, v34, s[32:35], s69 offen offset:0 sc1
    s_add_u32 s67, s67, 1
    s_waitcnt vmcnt(0)
    v_cmp_eq_u32 vcc, 0, v55
    s_cmpk_ge_u32 s67, 20000
    s_cbranch_scc1 L_f1Ba_ok
    s_cbranch_vccnz L_f1Ba
L_f1Ba_ok:
    buffer_load_dwordx4 v[56:59], v53, s[36:39], s59 offen sc1
    v_mov_b32 v55, 1
    s_mov_b64 exec, 1
    buffer_atomic_add v55, off, s[32:35], s53 sc1
    s_mov_b64 exec, -1
    s_add_u32 m0, s55, 122880
    s_bfe_u32 s56, s72, 0x40000
    s_mul_i32 s56, s56, 245760
    s_add_u32 s56, s56, s54
    buffer_load_dwordx4 v18, s[24:27], s56 offen offset:0 lds
    buffer_load_dwordx4 v19, s[24:27], s56 offen offset:1024 lds
    buffer_load_dwordx4 v20, s[24:27], s56 offen offset:2048 lds
    buffer_load_dwordx4 v21, s[24:27], s56 offen offset:3072 lds
    s_add_u32 m0, s55, 126976
    s_nop 0
    buffer_load_dwordx4 v22, s[24:27], s56 offen lds
    s_barrier
    s_waitcnt vmcnt(6)
    v_mfma_f32_16x16x32_bf16 v[64:67], a[120:123], v[56:59], 0
    s_nop 7
    v_cvt_pk_bf16_f32 v56, v64, v65
    v_cvt_pk_bf16_f32 v57, v66, v67
    s_nop 0
    v_permlane16_swap_b32 v56, v58
    v_permlane16_swap_b32 v57, v59
    buffer_store_dwordx4 v[56:59], v54, s[32:35], s60 offen sc1
    s_setprio 0
    v_mov_b32 v55, 16
    s_mov_b64 exec, 1
    v_mov_b32 v55, 0
    buffer_atomic_add v55, off, s[32:35], s53 sc0 sc1
    s_mov_b64 exec, -1
    s_add_u32 m0, s55, 61440
    s_add_u32 s56, s51, s50
    s_and_b32 s56, s56, 7
    s_mul_i32 s56, s56, 102400
    s_add_u32 s56, s56, s64
    s_add_u32 s56, s56, 51200
    buffer_load_dwordx4 v23, s[28:31], s56 offen offset:0 lds
    buffer_load_dwordx4 v24, s[28:31], s56 offen offset:1024 lds
    buffer_load_dwordx4 v25, s[28:31], s56 offen offset:2048 lds
    buffer_load_dwordx4 v26, s[28:31], s56 offen offset:3072 lds
    s_add_u32 m0, s55, 65536
    s_nop 0
    buffer_load_dwordx4 v27, s[28:31], s56 offen lds
    s_waitcnt vmcnt(7)
    s_barrier
    s_add_u32 m0, s55, 81920
    s_add_u32 s56, s51, s50
    s_add_u32 s56, s56, 4
    s_and_b32 s56, s56, 7
    s_mul_i32 s56, s56, 102400
    s_add_u32 s56, s56, s64
    s_add_u32 s56, s56, 51200
    buffer_load_dwordx4 v23, s[28:31], s56 offen offset:0 lds
    buffer_load_dwordx4 v24, s[28:31], s56 offen offset:1024 lds
    buffer_load_dwordx4 v25, s[28:31], s56 offen offset:2048 lds
    buffer_load_dwordx4 v26, s[28:31], s56 offen offset:3072 lds
    s_add_u32 m0, s55, 86016
    s_nop 0
    buffer_load_dwordx4 v27, s[28:31], s56 offen lds
    v_lshrrev_b32 v20, 4, v1
    v_and_b32 v21, 15, v1
    v_add_u32 v15, 40960, v7
    v_mul_u32_u24 v16, 5120, v20
    v_lshl_add_u32 v16, v21, 4, v16
    v_add_u32 v17, 40960, v16
    s_mul_i32 s57, s51, 10240
    s_add_u32 s57, s57, 102400
    v_add_u32 v18, s57, v7
    v_add_u32 v3, 0x10000, v2
    s_mul_i32 s58, s51, 1792
    s_add_u32 s58, s58, 153600
    v_lshrrev_b32 v22, 5, v1
    v_mul_u32_u24 v22, 240, v22
    v_lshl_add_u32 v22, v20, 3, v22
    v_lshl_add_u32 v22, v21, 4, v22
    v_add_u32 v22, s58, v22
    v_mul_u32_u24 v19, 176, v21
    v_lshl_add_u32 v19, v20, 3, v19
    v_add_u32 v19, s57, v19
    v_mul_u32_u24 v21, 0xccd, v1
    v_lshrrev_b32 v21, 15, v21
    v_lshl_add_u32 v20, v21, 4, v18
    v_mul_u32_u24 v21, 2400, v21
    v_add_u32 v21, v21, v7
    v_mov_b32 v96, 0x40000000
    v_cmp_gt_u32 vcc, 20, v1
    s_nop 1
    v_cndmask_b32 v54, v96, v21, vcc
    v_cmp_gt_u32 vcc, 60, v1
    s_nop 1
    v_cndmask_b32 v21, v96, v21, vcc
    s_add_u32 s44, s63, 0
    s_add_u32 s45, s44, 20480
    s_add_u32 s25, s50, 1
    s_and_b32 s25, s25, 7
    s_mulk_i32 s25, 5120
    s_add_u32 s25, s25, s44
    s_add_u32 s26, s50, 2
    s_and_b32 s26, s26, 7
    s_mulk_i32 s26, 5120
    s_add_u32 s26, s26, s44
    s_add_u32 s27, s50, 3
    s_and_b32 s27, s27, 7
    s_mulk_i32 s27, 5120
    s_add_u32 s27, s27, s44
    s_add_u32 s40, s50, 4
    s_and_b32 s40, s40, 7
    s_mulk_i32 s40, 5120
    s_add_u32 s40, s40, s44
    s_add_u32 s41, s50, 5
    s_and_b32 s41, s41, 7
    s_mulk_i32 s41, 5120
    s_add_u32 s41, s41, s44
    s_add_u32 s42, s50, 6
    s_and_b32 s42, s42, 7
    s_mulk_i32 s42, 5120
    s_add_u32 s42, s42, s44
    s_add_u32 s43, s50, 7
    s_and_b32 s43, s43, 7
    s_mulk_i32 s43, 5120
    s_add_u32 s43, s43, s44
    s_lshl2_add_u32 s58, s52, s51
    s_lshl_b32 s58, s58, 6
    s_add_u32 s69, s58, s68
    s_lshl3_add_u32 s58, s50, s69
    s_waitcnt vmcnt(10)
    v_cmp_ne_u32 vcc, 16, v55
    s_cbranch_vccz L_gcBa_ok
    s_mov_b32 s67, 0
L_gcBa:
    v_mov_b32 v55, 16
    s_mov_b64 exec, 1
    v_mov_b32 v55, 0
    buffer_atomic_add v55, off, s[32:35], s53 sc0 sc1
    s_mov_b64 exec, -1
    s_add_u32 s67, s67, 1
    s_waitcnt vmcnt(0)
    v_cmp_ne_u32 vcc, 16, v55
    s_cmpk_ge_u32 s67, 20000
    s_cbranch_scc1 L_gcBa_ok
    s_cbranch_vccnz L_gcBa
L_gcBa_ok:
    buffer_load_dwordx4 a[0:3], v33, s[32:35], s60 offen offset:0 sc1
    buffer_load_dwordx4 a[4:7], v33, s[32:35], s60 offen offset:256 sc1
    buffer_load_dwordx4 a[8:11], v33, s[32:35], s60 offen offset:512 sc1
    buffer_load_dwordx4 a[12:15], v35, s[32:35], s60 offen offset:768 sc1
    s_add_u32 m0, s55, 0
    s_and_b32 s56, s51, 1
    s_mul_i32 s56, s56, 409600
    s_add_u32 s56, s56, s64
    s_cmp_lt_u32 s51, 2
    s_cselect_b32 s65, 51200, 0
    s_add_u32 s56, s56, s65
    buffer_load_dwordx4 v28, s[28:31], s56 offen offset:0 lds
    buffer_load_dwordx4 v29, s[28:31], s56 offen offset:1024 lds
    buffer_load_dwordx4 v30, s[28:31], s56 offen offset:2048 lds
    buffer_load_dwordx4 v31, s[28:31], s56 offen offset:3072 lds
    s_add_u32 m0, s55, 4096
    s_nop 0
    buffer_load_dwordx4 v32, s[28:31], s56 offen lds
    v_and_b32 v121, 15, v1
    v_lshlrev_b32 v121, 2, v121
    v_and_b32 v123, 56, v121
    s_waitcnt vmcnt(5)
    v_mfma_f32_16x16x32_bf16 v[56:59], a[120:123], a[0:3], 0
    v_mfma_f32_16x16x32_bf16 v[60:63], a[120:123], a[8:11], 0
    v_mfma_f32_16x16x32_bf16 v[56:59], a[124:127], a[4:7], v[56:59]
    v_mfma_f32_16x16x32_bf16 v[60:63], a[124:127], a[12:15], v[60:63]
    s_nop 7
    v_cmp_u_f32 vcc, v56, v60
    s_cbranch_vccz L_xlBa_ok
    s_mov_b32 s67, 0
L_xlBa:
    buffer_load_dwordx4 a[0:3], v33, s[32:35], s60 offen offset:0 sc1
    buffer_load_dwordx4 a[4:7], v33, s[32:35], s60 offen offset:256 sc1
    buffer_load_dwordx4 a[8:11], v33, s[32:35], s60 offen offset:512 sc1
    buffer_load_dwordx4 a[12:15], v35, s[32:35], s60 offen offset:768 sc1
    s_add_u32 s67, s67, 1
    s_waitcnt vmcnt(0)
    v_mfma_f32_16x16x32_bf16 v[56:59], a[120:123], a[0:3], 0
    v_mfma_f32_16x16x32_bf16 v[60:63], a[120:123], a[8:11], 0
    v_mfma_f32_16x16x32_bf16 v[56:59], a[124:127], a[4:7], v[56:59]
    v_mfma_f32_16x16x32_bf16 v[60:63], a[124:127], a[12:15], v[60:63]
    s_nop 7
    v_cmp_u_f32 vcc, v56, v60
    s_cmpk_ge_u32 s67, 4000
    s_cbranch_scc1 L_xlBa_ok
    s_cbranch_vccnz L_xlBa
L_xlBa_ok:
    v_cvt_pk_bf16_f32 v56, v56, v57
    v_cvt_pk_bf16_f32 v57, v58, v59
    ds_write_b64 v22, v[56:57] offset:0
    v_cvt_pk_bf16_f32 v60, v60, v61
    v_cvt_pk_bf16_f32 v61, v62, v63
    ds_write_b64 v22, v[60:61] offset:512
    s_mov_b32 exec_hi, -1
    s_add_u32 m0, s55, 20480
    s_add_u32 s56, s51, s50
    s_and_b32 s56, s56, 7
    s_mul_i32 s56, s56, 102400
    s_add_u32 s56, s56, s64
    buffer_load_dwordx4 v23, s[28:31], s56 offen offset:0 lds
    buffer_load_dwordx4 v24, s[28:31], s56 offen offset:1024 lds
    buffer_load_dwordx4 v25, s[28:31], s56 offen offset:2048 lds
    buffer_load_dwordx4 v26, s[28:31], s56 offen offset:3072 lds
    s_add_u32 m0, s55, 24576
    s_nop 0
    buffer_load_dwordx4 v27, s[28:31], s56 offen lds
    s_waitcnt lgkmcnt(0)
    s_barrier
    ds_read_b64 v[102:103], v5 offset:0
    s_add_u32 m0, s55, 40960
    s_add_u32 s56, s51, s50
    s_add_u32 s56, s56, 4
    s_and_b32 s56, s56, 7
    s_mul_i32 s56, s56, 102400
    s_add_u32 s56, s56, s64
    ds_read_b64 v[104:105], v5 offset:8
    buffer_load_dwordx4 v23, s[28:31], s56 offen offset:0 lds
    ds_read_b64 v[106:107], v6 offset:0
    buffer_load_dwordx4 v24, s[28:31], s56 offen offset:1024 lds
    ds_read_b64 v[114:115], v5 offset:5120
    ds_read_b64 v[116:117], v5 offset:5128
    buffer_load_dwordx4 v25, s[28:31], s56 offen offset:2048 lds
    ds_read_b64 v[118:119], v6 offset:5120
    buffer_load_dwordx4 v26, s[28:31], s56 offen offset:3072 lds
    ds_read_b128 v[34:37], v9 offset:0
    ds_read_b64 v[38:39], v11 offset:0
    s_add_u32 m0, s55, 45056
    ds_read_b128 v[44:47], v9 offset:1792
    buffer_load_dwordx4 v27, s[28:31], s56 offen lds
    ds_read_b64 v[48:49], v11 offset:1792
    s_waitcnt lgkmcnt(3)
    v_mfma_f32_32x32x16_bf16 v[56:71], v[34:37], v[102:105], 0
    s_waitcnt lgkmcnt(2)
    v_mfma_f32_32x32x8_bf16 v[56:71], v[38:39], v[106:107], v[56:71]
    s_waitcnt lgkmcnt(1)
    v_mfma_f32_32x32x16_bf16 v[72:87], v[44:47], v[114:117], 0
    s_waitcnt lgkmcnt(0)
    v_mfma_f32_32x32x8_bf16 v[72:87], v[48:49], v[118:119], v[72:87]
    s_nop 7
    v_add_f32 v68, 0x358637bd, v68
    v_rcp_f32 v68, v68
    s_nop 0
    v_pk_mul_f32 v[56:57], v[56:57], v[68:69] op_sel_hi:[1,0]
    v_pk_mul_f32 v[58:59], v[58:59], v[68:69] op_sel_hi:[1,0]
    v_pk_mul_f32 v[60:61], v[60:61], v[68:69] op_sel_hi:[1,0]
    v_pk_mul_f32 v[62:63], v[62:63], v[68:69] op_sel_hi:[1,0]
    v_pk_mul_f32 v[64:65], v[64:65], v[68:69] op_sel_hi:[1,0]
    v_pk_mul_f32 v[66:67], v[66:67], v[68:69] op_sel_hi:[1,0]
    v_cvt_pk_bf16_f32 v88, v56, v57
    v_cvt_pk_bf16_f32 v89, v58, v59
    v_cvt_pk_bf16_f32 v90, v60, v61
    v_cvt_pk_bf16_f32 v91, v62, v63
    v_cvt_pk_bf16_f32 v124, v64, v65
    v_cvt_pk_bf16_f32 v125, v66, v67
    v_add_f32 v84, 0x358637bd, v84
    v_rcp_f32 v84, v84
    s_nop 0
    v_pk_mul_f32 v[72:73], v[72:73], v[84:85] op_sel_hi:[1,0]
    v_pk_mul_f32 v[74:75], v[74:75], v[84:85] op_sel_hi:[1,0]
    v_pk_mul_f32 v[76:77], v[76:77], v[84:85] op_sel_hi:[1,0]
    v_pk_mul_f32 v[78:79], v[78:79], v[84:85] op_sel_hi:[1,0]
    v_pk_mul_f32 v[80:81], v[80:81], v[84:85] op_sel_hi:[1,0]
    v_pk_mul_f32 v[82:83], v[82:83], v[84:85] op_sel_hi:[1,0]
    v_cvt_pk_bf16_f32 v92, v72, v73
    v_cvt_pk_bf16_f32 v93, v74, v75
    v_cvt_pk_bf16_f32 v94, v76, v77
    v_cvt_pk_bf16_f32 v95, v78, v79
    v_permlane16_swap_b32 v88, v92
    v_permlane16_swap_b32 v89, v93
    v_permlane16_swap_b32 v90, v94
    v_permlane16_swap_b32 v91, v95
    v_cvt_pk_bf16_f32 v126, v80, v81
    v_cvt_pk_bf16_f32 v127, v82, v83
    s_cmp_eq_u32 s61, 0
    s_cbranch_scc0 L_o1Ba_far
    buffer_store_dwordx4 v[88:91], v7, s[36:39], s62 offen
    buffer_store_dwordx4 v[92:95], v15, s[36:39], s62 offen
    buffer_store_dwordx4 v[124:127], v13, s[36:39], s62 offen offset:1024
L_o1Ba_st:
    v_accvgpr_write_b32 a0, v88
    v_accvgpr_write_b32 a1, v89
    v_accvgpr_write_b32 a2, v90
    v_accvgpr_write_b32 a3, v91
    v_accvgpr_write_b32 a4, v92
    v_accvgpr_write_b32 a5, v93
    v_accvgpr_write_b32 a6, v94
    v_accvgpr_write_b32 a7, v95
    s_setprio 2
    s_waitcnt vmcnt(0)
    v_mov_b32 v120, 1
    s_cmp_eq_u32 s61, 0
    s_cbranch_scc0 L_s2Ba_far
    s_mov_b64 exec, 1
    buffer_store_dword v120, off, s[32:35], s58 offset:1024
    s_mov_b64 exec, -1
L_s2Ba_st:
    s_barrier
    ds_read_b64_tr_b16 a[80:81], v2 offset:20480
    ds_read_b64_tr_b16 a[82:83], v2 offset:23040
    ds_read_b64_tr_b16 a[84:85], v2 offset:20512
    ds_read_b64_tr_b16 a[86:87], v2 offset:23072
    ds_read_b64_tr_b16 a[88:89], v2 offset:20544
    ds_read_b64_tr_b16 a[90:91], v2 offset:23104
    ds_read_b64_tr_b16 a[92:93], v2 offset:20576
    ds_read_b64_tr_b16 a[94:95], v2 offset:23136
    ds_read_b64_tr_b16 a[96:97], v2 offset:20608
    ds_read_b64_tr_b16 a[98:99], v2 offset:23168
    ds_read_b64_tr_b16 a[100:101], v2 offset:25600
    ds_read_b64_tr_b16 a[102:103], v2 offset:28160
    ds_read_b64_tr_b16 a[104:105], v2 offset:25632
    ds_read_b64_tr_b16 a[106:107], v2 offset:28192
    ds_read_b64_tr_b16 a[108:109], v2 offset:25664
    ds_read_b64_tr_b16 a[110:111], v2 offset:28224
    buffer_load_dword v122, v123, s[32:35], s69 offen offset:1024 sc1
    ds_read_b64_tr_b16 a[112:113], v2 offset:25696
    ds_read_b64_tr_b16 a[114:115], v2 offset:28256
    ds_read_b64_tr_b16 a[116:117], v2 offset:25728
    ds_read_b64_tr_b16 a[118:119], v2 offset:28288
    ds_read_b64_tr_b16 a[120:121], v2 offset:30720
    ds_read_b64_tr_b16 a[122:123], v2 offset:33280
    ds_read_b64_tr_b16 a[124:125], v2 offset:30752
    ds_read_b64_tr_b16 a[126:127], v2 offset:33312
    ds_read_b64_tr_b16 v[34:35], v2 offset:30784
    ds_read_b64_tr_b16 v[36:37], v2 offset:33344
    ds_read_b64_tr_b16 v[38:39], v2 offset:30816
    ds_read_b64_tr_b16 v[40:41], v2 offset:33376
    ds_read_b64_tr_b16 v[42:43], v2 offset:30848
    ds_read_b64_tr_b16 v[44:45], v2 offset:33408
    ds_read_b64_tr_b16 v[46:47], v2 offset:35840
    ds_read_b64_tr_b16 v[48:49], v2 offset:38400
    ds_read_b64_tr_b16 v[50:51], v2 offset:35872
    ds_read_b64_tr_b16 v[52:53], v2 offset:38432
    ds_read_b64_tr_b16 v[96:97], v2 offset:35904
    ds_read_b64_tr_b16 v[98:99], v2 offset:38464
    ds_read_b64_tr_b16 v[100:101], v2 offset:35936
    ds_read_b64_tr_b16 v[102:103], v2 offset:38496
    ds_read_b64_tr_b16 v[104:105], v2 offset:35968
    ds_read_b64_tr_b16 v[106:107], v2 offset:38528
    ds_read_b64_tr_b16 v[108:109], v2 offset:40960
    ds_read_b64_tr_b16 v[110:111], v2 offset:43520
    ds_read_b64_tr_b16 v[112:113], v2 offset:40992
    ds_read_b64_tr_b16 v[114:115], v2 offset:43552
    s_waitcnt vmcnt(0)
    v_cmp_eq_u32 vcc, 0, v122
    s_cbranch_vccz L_f2Ba_ok
    s_mov_b32 s67, 0
L_f2Ba:
    buffer_load_dword v122, v123, s[32:35], s69 offen offset:1024 sc1
    s_add_u32 s67, s67, 1
    s_waitcnt vmcnt(0)
    v_cmp_eq_u32 vcc, 0, v122
    s_cmpk_ge_u32 s67, 20000
    s_cbranch_scc1 L_f2Ba_ok
    s_cbranch_vccnz L_f2Ba
L_f2Ba_ok:
    buffer_load_dwordx4 a[8:11], v7, s[36:39], s25 offen sc1
    buffer_load_dwordx4 a[12:15], v15, s[36:39], s25 offen sc1
    buffer_load_dwordx4 a[16:19], v7, s[36:39], s26 offen sc1
    buffer_load_dwordx4 a[20:23], v15, s[36:39], s26 offen sc1
    s_waitcnt lgkmcnt(0)
    s_setprio 0
    v_mfma_f32_16x16x32_bf16 v[56:59], a[80:83], a[0:3], 0
    v_mfma_f32_16x16x32_bf16 v[60:63], a[80:83], a[4:7], 0
    buffer_load_dwordx4 a[24:27], v7, s[36:39], s27 offen sc1
    v_mfma_f32_16x16x32_bf16 v[64:67], a[84:87], a[0:3], 0
    v_mfma_f32_16x16x32_bf16 v[68:71], a[84:87], a[4:7], 0
    v_mfma_f32_16x16x32_bf16 v[72:75], a[88:91], a[0:3], 0
    v_mfma_f32_16x16x32_bf16 v[76:79], a[88:91], a[4:7], 0
    buffer_load_dwordx4 a[28:31], v15, s[36:39], s27 offen sc1
    v_mfma_f32_16x16x32_bf16 v[80:83], a[92:95], a[0:3], 0
    v_mfma_f32_16x16x32_bf16 v[84:87], a[92:95], a[4:7], 0
    buffer_load_dwordx4 a[32:35], v7, s[36:39], s40 offen sc1
    v_mfma_f32_16x16x32_bf16 v[88:91], a[96:99], a[0:3], 0
    v_mfma_f32_16x16x32_bf16 v[92:95], a[96:99], a[4:7], 0
    s_waitcnt vmcnt(6)
    v_mfma_f32_16x16x32_bf16 v[56:59], a[100:103], a[8:11], v[56:59]
    s_waitcnt vmcnt(5)
    v_mfma_f32_16x16x32_bf16 v[60:63], a[100:103], a[12:15], v[60:63]
    buffer_load_dwordx4 a[36:39], v15, s[36:39], s40 offen sc1
    v_mfma_f32_16x16x32_bf16 v[64:67], a[104:107], a[8:11], v[64:67]
    v_mfma_f32_16x16x32_bf16 v[68:71], a[104:107], a[12:15], v[68:71]
    v_mfma_f32_16x16x32_bf16 v[72:75], a[108:111], a[8:11], v[72:75]
    v_mfma_f32_16x16x32_bf16 v[76:79], a[108:111], a[12:15], v[76:79]
    buffer_load_dwordx4 a[40:43], v7, s[36:39], s41 offen sc1
    v_mfma_f32_16x16x32_bf16 v[80:83], a[112:115], a[8:11], v[80:83]
    v_mfma_f32_16x16x32_bf16 v[84:87], a[112:115], a[12:15], v[84:87]
    buffer_load_dwordx4 a[44:47], v15, s[36:39], s41 offen sc1
    v_mfma_f32_16x16x32_bf16 v[88:91], a[116:119], a[8:11], v[88:91]
    v_mfma_f32_16x16x32_bf16 v[92:95], a[116:119], a[12:15], v[92:95]
    s_waitcnt vmcnt(7)
    v_mfma_f32_16x16x32_bf16 v[56:59], a[120:123], a[16:19], v[56:59]
    s_waitcnt vmcnt(6)
    v_mfma_f32_16x16x32_bf16 v[60:63], a[120:123], a[20:23], v[60:63]
    buffer_load_dwordx4 a[48:51], v7, s[36:39], s42 offen sc1
    v_mfma_f32_16x16x32_bf16 v[64:67], a[124:127], a[16:19], v[64:67]
    v_mfma_f32_16x16x32_bf16 v[68:71], a[124:127], a[20:23], v[68:71]
    v_mfma_f32_16x16x32_bf16 v[72:75], v[34:37], a[16:19], v[72:75]
    v_mfma_f32_16x16x32_bf16 v[76:79], v[34:37], a[20:23], v[76:79]
    buffer_load_dwordx4 a[52:55], v15, s[36:39], s42 offen sc1
    v_mfma_f32_16x16x32_bf16 v[80:83], v[38:41], a[16:19], v[80:83]
    v_mfma_f32_16x16x32_bf16 v[84:87], v[38:41], a[20:23], v[84:87]
    buffer_load_dwordx4 a[56:59], v7, s[36:39], s43 offen sc1
    v_mfma_f32_16x16x32_bf16 v[88:91], v[42:45], a[16:19], v[88:91]
    v_mfma_f32_16x16x32_bf16 v[92:95], v[42:45], a[20:23], v[92:95]
    s_waitcnt vmcnt(8)
    v_mfma_f32_16x16x32_bf16 v[56:59], v[46:49], a[24:27], v[56:59]
    s_waitcnt vmcnt(7)
    v_mfma_f32_16x16x32_bf16 v[60:63], v[46:49], a[28:31], v[60:63]
    buffer_load_dwordx4 a[60:63], v15, s[36:39], s43 offen sc1
    v_mfma_f32_16x16x32_bf16 v[64:67], v[50:53], a[24:27], v[64:67]
    v_mfma_f32_16x16x32_bf16 v[68:71], v[50:53], a[28:31], v[68:71]
    v_mfma_f32_16x16x32_bf16 v[72:75], v[96:99], a[24:27], v[72:75]
    ds_read_b64_tr_b16 v[116:117], v2 offset:41024
    buffer_load_dwordx4 a[64:67], v16, s[36:39], s44 offen offset:1024 sc1
    v_mfma_f32_16x16x32_bf16 v[76:79], v[96:99], a[28:31], v[76:79]
    ds_read_b64_tr_b16 v[118:119], v2 offset:43584
    v_mfma_f32_16x16x32_bf16 v[80:83], v[100:103], a[24:27], v[80:83]
    ds_read_b64_tr_b16 v[96:97], v2 offset:41056
    buffer_load_dwordx4 a[68:71], v17, s[36:39], s44 offen offset:1024 sc1
    v_mfma_f32_16x16x32_bf16 v[84:87], v[100:103], a[28:31], v[84:87]
    ds_read_b64_tr_b16 v[98:99], v2 offset:43616
    v_mfma_f32_16x16x32_bf16 v[88:91], v[104:107], a[24:27], v[88:91]
    ds_read_b64_tr_b16 v[100:101], v2 offset:41088
    v_mfma_f32_16x16x32_bf16 v[92:95], v[104:107], a[28:31], v[92:95]
    ds_read_b64_tr_b16 v[102:103], v2 offset:43648
    s_waitcnt vmcnt(9)
    v_mfma_f32_16x16x32_bf16 v[56:59], v[108:111], a[32:35], v[56:59]
    ds_read_b64_tr_b16 v[104:105], v2 offset:46080
    buffer_load_dwordx4 a[72:75], v16, s[36:39], s45 offen offset:1024 sc1
    s_waitcnt vmcnt(9)
    v_mfma_f32_16x16x32_bf16 v[60:63], v[108:111], a[36:39], v[60:63]
    ds_read_b64_tr_b16 v[106:107], v2 offset:48640
    v_mfma_f32_16x16x32_bf16 v[64:67], v[112:115], a[32:35], v[64:67]
    ds_read_b64_tr_b16 v[108:109], v2 offset:46112
    v_mfma_f32_16x16x32_bf16 v[68:71], v[112:115], a[36:39], v[68:71]
    ds_read_b64_tr_b16 v[110:111], v2 offset:48672
    s_waitcnt lgkmcnt(8)
    v_mfma_f32_16x16x32_bf16 v[72:75], v[116:119], a[32:35], v[72:75]
    ds_read_b64_tr_b16 v[112:113], v2 offset:46144
    buffer_load_dwordx4 a[76:79], v17, s[36:39], s45 offen offset:1024 sc1
    v_mfma_f32_16x16x32_bf16 v[76:79], v[116:119], a[36:39], v[76:79]
    ds_read_b64_tr_b16 v[114:115], v2 offset:48704
    s_waitcnt lgkmcnt(8)
    v_mfma_f32_16x16x32_bf16 v[80:83], v[96:99], a[32:35], v[80:83]
    ds_read_b64_tr_b16 v[116:117], v2 offset:46176
    v_mfma_f32_16x16x32_bf16 v[84:87], v[96:99], a[36:39], v[84:87]
    ds_read_b64_tr_b16 v[118:119], v2 offset:48736
    s_waitcnt lgkmcnt(8)
    v_mfma_f32_16x16x32_bf16 v[88:91], v[100:103], a[32:35], v[88:91]
    ds_read_b64_tr_b16 v[96:97], v2 offset:46208
    v_mfma_f32_16x16x32_bf16 v[92:95], v[100:103], a[36:39], v[92:95]
    ds_read_b64_tr_b16 v[98:99], v2 offset:48768
    s_waitcnt vmcnt(9) lgkmcnt(8)
    v_mfma_f32_16x16x32_bf16 v[56:59], v[104:107], a[40:43], v[56:59]
    ds_read_b64_tr_b16 v[100:101], v2 offset:51200
    s_waitcnt vmcnt(8)
    v_mfma_f32_16x16x32_bf16 v[60:63], v[104:107], a[44:47], v[60:63]
    ds_read_b64_tr_b16 v[102:103], v2 offset:53760
    s_waitcnt lgkmcnt(8)
    v_mfma_f32_16x16x32_bf16 v[64:67], v[108:111], a[40:43], v[64:67]
    ds_read_b64_tr_b16 v[104:105], v2 offset:51232
    v_mfma_f32_16x16x32_bf16 v[68:71], v[108:111], a[44:47], v[68:71]
    ds_read_b64_tr_b16 v[106:107], v2 offset:53792
    s_waitcnt lgkmcnt(8)
    v_mfma_f32_16x16x32_bf16 v[72:75], v[112:115], a[40:43], v[72:75]
    ds_read_b64_tr_b16 v[108:109], v2 offset:51264
    v_mfma_f32_16x16x32_bf16 v[76:79], v[112:115], a[44:47], v[76:79]
    ds_read_b64_tr_b16 v[110:111], v2 offset:53824
    s_waitcnt lgkmcnt(8)
    v_mfma_f32_16x16x32_bf16 v[80:83], v[116:119], a[40:43], v[80:83]
    ds_read_b64_tr_b16 v[112:113], v2 offset:51296
    v_mfma_f32_16x16x32_bf16 v[84:87], v[116:119], a[44:47], v[84:87]
    ds_read_b64_tr_b16 v[114:115], v2 offset:53856
    s_waitcnt lgkmcnt(8)
    v_mfma_f32_16x16x32_bf16 v[88:91], v[96:99], a[40:43], v[88:91]
    ds_read_b64_tr_b16 v[116:117], v2 offset:51328
    v_mfma_f32_16x16x32_bf16 v[92:95], v[96:99], a[44:47], v[92:95]
    ds_read_b64_tr_b16 v[118:119], v2 offset:53888
    s_waitcnt vmcnt(7) lgkmcnt(8)
    v_mfma_f32_16x16x32_bf16 v[56:59], v[100:103], a[48:51], v[56:59]
    ds_read_b64_tr_b16 v[96:97], v2 offset:56320
    s_waitcnt vmcnt(6)
    v_mfma_f32_16x16x32_bf16 v[60:63], v[100:103], a[52:55], v[60:63]
    ds_read_b64_tr_b16 v[98:99], v2 offset:58880
    s_waitcnt lgkmcnt(8)
    v_mfma_f32_16x16x32_bf16 v[64:67], v[104:107], a[48:51], v[64:67]
    ds_read_b64_tr_b16 v[100:101], v2 offset:56352
    v_mfma_f32_16x16x32_bf16 v[68:71], v[104:107], a[52:55], v[68:71]
    ds_read_b64_tr_b16 v[102:103], v2 offset:58912
    s_waitcnt lgkmcnt(8)
    v_mfma_f32_16x16x32_bf16 v[72:75], v[108:111], a[48:51], v[72:75]
    ds_read_b64_tr_b16 v[104:105], v2 offset:56384
    v_mfma_f32_16x16x32_bf16 v[76:79], v[108:111], a[52:55], v[76:79]
    ds_read_b64_tr_b16 v[106:107], v2 offset:58944
    s_waitcnt lgkmcnt(8)
    v_mfma_f32_16x16x32_bf16 v[80:83], v[112:115], a[48:51], v[80:83]
    ds_read_b64_tr_b16 v[108:109], v2 offset:56416
    v_mfma_f32_16x16x32_bf16 v[84:87], v[112:115], a[52:55], v[84:87]
    ds_read_b64_tr_b16 v[110:111], v2 offset:58976
    s_waitcnt lgkmcnt(8)
    v_mfma_f32_16x16x32_bf16 v[88:91], v[116:119], a[48:51], v[88:91]
    ds_read_b64_tr_b16 v[112:113], v2 offset:56448
    v_mfma_f32_16x16x32_bf16 v[92:95], v[116:119], a[52:55], v[92:95]
    ds_read_b64_tr_b16 v[114:115], v2 offset:59008
    s_waitcnt vmcnt(5) lgkmcnt(8)
    v_mfma_f32_16x16x32_bf16 v[56:59], v[96:99], a[56:59], v[56:59]
    ds_read_b64_tr_b16 v[116:117], v2 offset:10240
    s_waitcnt vmcnt(4)
    v_mfma_f32_16x16x32_bf16 v[60:63], v[96:99], a[60:63], v[60:63]
    ds_read_b64_tr_b16 v[118:119], v2 offset:12800
    s_waitcnt lgkmcnt(8)
    v_mfma_f32_16x16x32_bf16 v[64:67], v[100:103], a[56:59], v[64:67]
    ds_read_b64_tr_b16 v[96:97], v2 offset:10272
    v_mfma_f32_16x16x32_bf16 v[68:71], v[100:103], a[60:63], v[68:71]
    ds_read_b64_tr_b16 v[98:99], v2 offset:12832
    s_waitcnt lgkmcnt(8)
    v_mfma_f32_16x16x32_bf16 v[72:75], v[104:107], a[56:59], v[72:75]
    ds_read_b64_tr_b16 v[100:101], v2 offset:10304
    v_mfma_f32_16x16x32_bf16 v[76:79], v[104:107], a[60:63], v[76:79]
    ds_read_b64_tr_b16 v[102:103], v2 offset:12864
    s_waitcnt vmcnt(0)
    v_mov_b32 v120, 1
    s_cmp_eq_u32 s61, 0
    s_cbranch_scc0 L_s3Ba_far
    s_mov_b64 exec, 1
    buffer_store_dword v120, off, s[32:35], s58 offset:2048
    s_mov_b64 exec, -1
L_s3Ba_st:
    s_waitcnt lgkmcnt(8)
    v_mfma_f32_16x16x32_bf16 v[80:83], v[108:111], a[56:59], v[80:83]
    ds_read_b64_tr_b16 v[104:105], v2 offset:10336
    v_mfma_f32_16x16x32_bf16 v[84:87], v[108:111], a[60:63], v[84:87]
    ds_read_b64_tr_b16 v[106:107], v2 offset:12896
    s_waitcnt lgkmcnt(8)
    v_mfma_f32_16x16x32_bf16 v[88:91], v[112:115], a[56:59], v[88:91]
    ds_read_b64_tr_b16 v[108:109], v2 offset:10368
    v_mfma_f32_16x16x32_bf16 v[92:95], v[112:115], a[60:63], v[92:95]
    ds_read_b64_tr_b16 v[110:111], v2 offset:12928
    s_waitcnt lgkmcnt(8)
    v_mfma_f32_16x16x32_bf16 v[56:59], v[116:119], a[64:67], v[56:59]
    ds_read_b64_tr_b16 v[112:113], v2 offset:15360
    v_mfma_f32_16x16x32_bf16 v[60:63], v[116:119], a[68:71], v[60:63]
    ds_read_b64_tr_b16 v[114:115], v2 offset:17920
    s_waitcnt lgkmcnt(8)
    v_mfma_f32_16x16x32_bf16 v[64:67], v[96:99], a[64:67], v[64:67]
    ds_read_b64_tr_b16 v[116:117], v2 offset:15392
    v_mfma_f32_16x16x32_bf16 v[68:71], v[96:99], a[68:71], v[68:71]
    ds_read_b64_tr_b16 v[118:119], v2 offset:17952
    s_waitcnt lgkmcnt(8)
    v_mfma_f32_16x16x32_bf16 v[72:75], v[100:103], a[64:67], v[72:75]
    ds_read_b64_tr_b16 v[96:97], v2 offset:15424
    v_mfma_f32_16x16x32_bf16 v[76:79], v[100:103], a[68:71], v[76:79]
    ds_read_b64_tr_b16 v[98:99], v2 offset:17984
    s_waitcnt lgkmcnt(8)
    v_mfma_f32_16x16x32_bf16 v[80:83], v[104:107], a[64:67], v[80:83]
    ds_read_b64_tr_b16 v[100:101], v2 offset:15456
    v_mfma_f32_16x16x32_bf16 v[84:87], v[104:107], a[68:71], v[84:87]
    ds_read_b64_tr_b16 v[102:103], v2 offset:18016
    s_waitcnt lgkmcnt(8)
    v_mfma_f32_16x16x32_bf16 v[88:91], v[108:111], a[64:67], v[88:91]
    ds_read_b64_tr_b16 v[104:105], v2 offset:15488
    v_mfma_f32_16x16x32_bf16 v[92:95], v[108:111], a[68:71], v[92:95]
    ds_read_b64_tr_b16 v[106:107], v2 offset:18048
    s_barrier
    s_waitcnt lgkmcnt(8)
    v_mfma_f32_16x16x32_bf16 v[56:59], v[112:115], a[72:75], v[56:59]
    ds_read_b128 v[34:37], v18 offset:0
    v_mfma_f32_16x16x32_bf16 v[60:63], v[112:115], a[76:79], v[60:63]
    buffer_load_dword v122, v121, s[32:35], s69 offen offset:2048 sc1
    s_waitcnt lgkmcnt(7)
    v_mfma_f32_16x16x32_bf16 v[64:67], v[116:119], a[72:75], v[64:67]
    ds_read_b128 v[38:41], v18 offset:1024
    v_mfma_f32_16x16x32_bf16 v[68:71], v[116:119], a[76:79], v[68:71]
    s_waitcnt lgkmcnt(6)
    v_mfma_f32_16x16x32_bf16 v[72:75], v[96:99], a[72:75], v[72:75]
    ds_read_b128 v[42:45], v18 offset:2048
    v_mfma_f32_16x16x32_bf16 v[76:79], v[96:99], a[76:79], v[76:79]
    s_waitcnt lgkmcnt(5)
    v_mfma_f32_16x16x32_bf16 v[80:83], v[100:103], a[72:75], v[80:83]
    ds_read_b128 v[46:49], v18 offset:3072
    v_mfma_f32_16x16x32_bf16 v[84:87], v[100:103], a[76:79], v[84:87]
    s_waitcnt lgkmcnt(4)
    v_mfma_f32_16x16x32_bf16 v[88:91], v[104:107], a[72:75], v[88:91]
    ds_read_b128 v[50:53], v18 offset:4096
    v_mfma_f32_16x16x32_bf16 v[92:95], v[104:107], a[76:79], v[92:95]
    ds_read_b128 v[96:99], v18 offset:5120
    ds_read_b128 v[100:103], v18 offset:6144
    ds_read_b128 v[104:107], v18 offset:7168
    ds_read_b128 v[108:111], v18 offset:8192
    ds_read_b128 v[112:115], v18 offset:9216
    s_add_u32 s25, s66, 15360
    s_add_u32 s26, s66, 30720
    s_add_u32 s27, s66, 46080
    s_add_u32 s40, s66, 61440
    s_add_u32 s41, s66, 76800
    s_waitcnt lgkmcnt(9)
    v_pk_add_f32 v[56:57], v[56:57], v[34:35]
    v_pk_add_f32 v[58:59], v[58:59], v[36:37]
    v_cvt_pk_bf16_f32 v56, v56, v57
    v_cvt_pk_bf16_f32 v57, v58, v59
    ds_write_b64 v19, v[56:57] offset:0
    s_waitcnt lgkmcnt(9)
    v_pk_add_f32 v[64:65], v[64:65], v[38:39]
    v_pk_add_f32 v[66:67], v[66:67], v[40:41]
    v_cvt_pk_bf16_f32 v64, v64, v65
    v_cvt_pk_bf16_f32 v65, v66, v67
    ds_write_b64 v19, v[64:65] offset:32
    s_waitcnt lgkmcnt(9)
    v_pk_add_f32 v[72:73], v[72:73], v[42:43]
    v_pk_add_f32 v[74:75], v[74:75], v[44:45]
    v_cvt_pk_bf16_f32 v72, v72, v73
    v_cvt_pk_bf16_f32 v73, v74, v75
    ds_write_b64 v19, v[72:73] offset:64
    s_waitcnt lgkmcnt(9)
    v_pk_add_f32 v[80:81], v[80:81], v[46:47]
    v_pk_add_f32 v[82:83], v[82:83], v[48:49]
    v_cvt_pk_bf16_f32 v80, v80, v81
    v_cvt_pk_bf16_f32 v81, v82, v83
    ds_write_b64 v19, v[80:81] offset:96
    s_waitcnt lgkmcnt(9)
    v_pk_add_f32 v[88:89], v[88:89], v[50:51]
    v_pk_add_f32 v[90:91], v[90:91], v[52:53]
    v_cvt_pk_bf16_f32 v88, v88, v89
    v_cvt_pk_bf16_f32 v89, v90, v91
    ds_write_b64 v19, v[88:89] offset:128
    ds_read_b128 a[0:3], v20 offset:0
    ds_read_b128 a[4:7], v20 offset:1056
    s_waitcnt lgkmcnt(11)
    v_pk_add_f32 v[60:61], v[60:61], v[96:97]
    v_pk_add_f32 v[62:63], v[62:63], v[98:99]
    v_cvt_pk_bf16_f32 v60, v60, v61
    v_cvt_pk_bf16_f32 v61, v62, v63
    ds_write_b64 v19, v[60:61] offset:2816
    s_waitcnt lgkmcnt(11)
    v_pk_add_f32 v[68:69], v[68:69], v[100:101]
    v_pk_add_f32 v[70:71], v[70:71], v[102:103]
    v_cvt_pk_bf16_f32 v68, v68, v69
    v_cvt_pk_bf16_f32 v69, v70, v71
    ds_write_b64 v19, v[68:69] offset:2848
    s_waitcnt lgkmcnt(11)
    v_pk_add_f32 v[76:77], v[76:77], v[104:105]
    v_pk_add_f32 v[78:79], v[78:79], v[106:107]
    v_cvt_pk_bf16_f32 v76, v76, v77
    v_cvt_pk_bf16_f32 v77, v78, v79
    ds_write_b64 v19, v[76:77] offset:2880
    s_waitcnt vmcnt(0)
    v_cmp_eq_u32 vcc, 0, v122
    s_cbranch_vccz L_f3Ba_ok
    s_mov_b32 s67, 0
L_f3Ba:
    buffer_load_dword v122, v121, s[32:35], s69 offen offset:2048 sc1
    s_add_u32 s67, s67, 1
    s_waitcnt vmcnt(0)
    v_cmp_eq_u32 vcc, 0, v122
    s_cmpk_ge_u32 s67, 20000
    s_cbranch_scc1 L_f3Ba_ok
    s_cbranch_vccnz L_f3Ba
L_f3Ba_ok:
    s_waitcnt lgkmcnt(4)
    buffer_store_dwordx4 a[0:3], v21, s[36:39], s66 offen
    s_waitcnt lgkmcnt(3)
    buffer_store_dwordx4 a[4:7], v21, s[36:39], s25 offen
    v_pk_add_f32 v[84:85], v[84:85], v[108:109]
    v_pk_add_f32 v[86:87], v[86:87], v[110:111]
    v_cvt_pk_bf16_f32 v84, v84, v85
    v_cvt_pk_bf16_f32 v85, v86, v87
    ds_write_b64 v19, v[84:85] offset:2912
    v_pk_add_f32 v[92:93], v[92:93], v[112:113]
    v_pk_add_f32 v[94:95], v[94:95], v[114:115]
    v_cvt_pk_bf16_f32 v92, v92, v93
    v_cvt_pk_bf16_f32 v93, v94, v95
    ds_write_b64 v19, v[92:93] offset:2944
    ds_read_b128 a[8:11], v20 offset:2112
    ds_read_b128 a[12:15], v20 offset:3168
    ds_read_b128 a[16:19], v20 offset:4224
    ds_read_b128 a[20:23], v20 offset:5280
    s_waitcnt lgkmcnt(3)
    buffer_store_dwordx4 a[8:11], v21, s[36:39], s26 offen
    s_waitcnt lgkmcnt(2)
    buffer_store_dwordx4 a[12:15], v21, s[36:39], s27 offen
    s_waitcnt lgkmcnt(1)
    buffer_store_dwordx4 a[16:19], v21, s[36:39], s40 offen
    s_waitcnt lgkmcnt(0)
    buffer_store_dwordx4 a[20:23], v54, s[36:39], s41 offen
    s_endpgm
.p2align 12
L_mainb:
    v_lshrrev_b32 v32, 2, v1
    v_and_b32 v33, 3, v1
    v_mul_u32_u24 v32, 160, v32
    v_lshl_add_u32 v2, v33, 3, v32
    v_and_b32 v34, 15, v1
    v_lshrrev_b32 v35, 4, v1
    v_lshrrev_b32 v32, 1, v34
    v_xor_b32 v32, v32, v35
    v_lshlrev_b32 v32, 4, v32
    v_lshl_add_u32 v32, v34, 7, v32
    v_add_u32 v14, s55, v32
    v_add_u32 v3, 0x10000, v2
    v_add_u32 v4, 0x20000, v2
    v_add_u32 v15, 0x10000, v14
    v_xor_b32 v16, 64, v14
    v_add_u32 v17, 0x10000, v16
    s_mul_i32 s57, s48, 0x358637bd
    v_mov_b32 v28, s57
    v_mov_b32 v29, s57
    v_mov_b32 v30, s57
    v_mov_b32 v31, s57
    s_mov_b32 s71, 0x6070504
    s_mov_b32 s72, 0x908
    s_cmp_eq_u32 s73, 1
    s_cselect_b32 s71, 0x8060503, s71
    s_cselect_b32 s72, 0x907, s72
    s_cmp_eq_u32 s73, 2
    s_cselect_b32 s71, 0x7060405, s71
    s_cselect_b32 s72, 0x809, s72
    s_cmp_eq_u32 s73, 3
    s_cselect_b32 s71, 0x7050604, s71
    s_cselect_b32 s72, 0x908, s72
    s_add_u32 s71, s71, s67
    s_add_u32 s57, s71, 0x76767676
    s_lshr_b32 s57, s57, 7
    s_and_b32 s57, s57, 0x01010101
    s_mul_i32 s57, s57, 10
    s_sub_u32 s71, s71, s57
    s_add_u32 s72, s72, s67
    s_add_u32 s57, s72, 0x76767676
    s_lshr_b32 s57, s57, 7
    s_and_b32 s57, s57, 0x01010101
    s_mul_i32 s57, s57, 10
    s_sub_u32 s72, s72, s57
    s_mov_b32 s32, s22
    s_mov_b32 s33, s23
    s_mov_b32 s34, 0x10000000
    s_mov_b32 s35, 0x20000
    s_mov_b32 s36, s18
    s_mov_b32 s37, s19
    s_mov_b32 s38, 5242880
    s_mov_b32 s39, 0x20000
    s_mov_b32 s44, s20
    s_mov_b32 s45, s21
    s_movk_i32 s46, 256
    s_mov_b32 s47, 0x20000
    s_mov_b32 s74, 0x3fb8aa3b
    s_mov_b32 s75, 0x3fb8aa3b
    v_lshlrev_b32 v7, 4, v1
    v_lshrrev_b32 v104, 4, v1
    v_and_b32 v105, 15, v1
    v_lshrrev_b32 v106, 5, v1
    v_and_b32 v107, 31, v1
    v_mov_b32 v108, 0x40000000
    v_and_b32 v109, 3, v1
    s_and_b32 s68, s2, 7
    s_lshl_b32 s68, s68, 12
    s_add_u32 s68, s68, 0x280000
    v_mov_b32 v100, 0
    v_mov_b32 v101, 0
    v_mov_b32 v102, 0
    v_mov_b32 v103, 0
    s_lshl_b32 s57, s51, 10
    s_add_u32 s57, s57, s68
    s_cmp_lt_u32 s2, 8
    s_cselect_b32 s57, s57, 0x40000000
    buffer_store_dwordx4 v[100:103], v7, s[32:35], s57 offen sc1
    v_mul_u32_u24 v96, 0xccd, v1
    s_movk_i32 s57, 3680
    s_movk_i32 s58, 3840
    v_lshrrev_b32 v98, 15, v96
    v_and_b32 v97, 12, v98
    v_mad_u32_u24 v64, v98, s57, v7
    v_mad_u32_u24 v64, v97, s58, v64
    v_add_u32 v96, 209728, v96
    v_lshrrev_b32 v98, 15, v96
    v_and_b32 v97, 12, v98
    v_mad_u32_u24 v65, v98, s57, v7
    v_mad_u32_u24 v65, v97, s58, v65
    v_add_u32 v96, 209728, v96
    v_lshrrev_b32 v98, 15, v96
    v_and_b32 v97, 12, v98
    v_mad_u32_u24 v66, v98, s57, v7
    v_mad_u32_u24 v66, v97, s58, v66
    v_lshrrev_b32 v97, 4, v98
    v_mul_u32_u24 v97, 46080, v97
    v_sub_u32 v66, v66, v97
    v_add_u32 v96, 209728, v96
    v_lshrrev_b32 v98, 15, v96
    v_and_b32 v97, 12, v98
    v_mad_u32_u24 v67, v98, s57, v7
    v_mad_u32_u24 v67, v97, s58, v67
    v_subrev_u32 v67, 46080, v67
    v_add_u32 v96, 209728, v96
    v_lshrrev_b32 v98, 15, v96
    v_and_b32 v97, 12, v98
    v_mad_u32_u24 v68, v98, s57, v7
    v_mad_u32_u24 v68, v97, s58, v68
    v_subrev_u32 v68, 41984, v68
    s_and_b32 s57, s51, 1
    s_mul_i32 s57, s57, 122880
    s_mul_i32 s58, s50, 160
    s_add_u32 s54, s57, s58
    s_lshr_b32 s57, s51, 1
    s_add_u32 s57, s57, 1
    s_mulk_i32 s57, 1280
    s_add_u32 s59, s54, s57
    s_cmp_eq_u32 s48, 0
    s_cselect_b32 s28, s6, s14
    s_cselect_b32 s29, s7, s15
    s_mov_b32 s30, 2457600
    s_mov_b32 s31, 0x20000
    buffer_load_dwordx4 v21, s[24:27], s56 offen offset:3072 lds
    s_barrier
    s_bfe_u32 s56, s70, 0x40008
    s_add_u32 m0, s55, 36864
    s_lshl_b32 s56, s56, 7
    s_add_u32 s56, s56, s53
    buffer_load_dwordx4 v18, s[24:27], s56 offen offset:0 lds
    buffer_load_dwordx4 v19, s[24:27], s56 offen offset:1024 lds
    buffer_load_dwordx4 v20, s[24:27], s56 offen offset:2048 lds
    buffer_load_dwordx4 v21, s[24:27], s56 offen offset:3072 lds
    s_setprio 1
    s_waitcnt vmcnt(4)
    s_barrier
    ds_read_b128 a[0:3], v14 offset:0
    ds_read_b128 a[4:7], v14 offset:2048
    ds_read_b128 a[8:11], v16 offset:0
    ds_read_b128 a[12:15], v16 offset:2048
    s_add_u32 m0, s55, 77824
    s_bfe_u32 s56, s70, 0x40010
    s_mul_i32 s56, s56, 245760
    s_add_u32 s56, s56, s59
    buffer_load_dwordx4 v64, s[28:31], s56 offen offset:0 lds
    buffer_load_dwordx4 v65, s[28:31], s56 offen offset:1024 lds
    buffer_load_dwordx4 v66, s[28:31], s56 offen offset:2048 lds
    buffer_load_dwordx4 v67, s[28:31], s56 offen offset:3072 lds
    s_add_u32 m0, s55, 81920
    s_nop 0
    buffer_load_dwordx4 v68, s[28:31], s56 offen lds
    s_bfe_u32 s56, s70, 0x40010
    s_add_u32 m0, s55, 73728
    s_lshl_b32 s56, s56, 7
    s_add_u32 s56, s56, s53
    buffer_load_dwordx4 v18, s[24:27], s56 offen offset:0 lds
    buffer_load_dwordx4 v19, s[24:27], s56 offen offset:1024 lds
    buffer_load_dwordx4 v20, s[24:27], s56 offen offset:2048 lds
    buffer_load_dwordx4 v21, s[24:27], s56 offen offset:3072 lds
    s_lshl_b32 s58, s2, 2
    s_lshl_b32 s57, s51, 8
    s_add_u32 s58, s58, s57
    s_cmp_lt_u32 s58, 32
    s_cselect_b32 s58, s58, 0x40000000
    s_mov_b64 exec, 1
    v_mov_b32 v116, 1
    buffer_atomic_add v116, off, s[44:47], s58 sc1
    s_mov_b64 exec, -1
    s_waitcnt lgkmcnt(0)
    s_waitcnt vmcnt(10)
    s_barrier
    ds_read_b128 a[16:19], v14 offset:36864
    ds_read_b128 a[20:23], v14 offset:38912
    ds_read_b128 a[24:27], v16 offset:36864
    ds_read_b128 a[28:31], v16 offset:38912
    s_add_u32 m0, s55, 114688
    s_bfe_u32 s56, s70, 0x40018
    s_mul_i32 s56, s56, 245760
    s_add_u32 s56, s56, s59
    buffer_load_dwordx4 v64, s[28:31], s56 offen offset:0 lds
    buffer_load_dwordx4 v65, s[28:31], s56 offen offset:1024 lds
    s_lshl2_add_u32 s57, s49, s51
    s_mul_i32 s57, s57, 81920
    s_mul_i32 s58, s48, 1280
    s_add_u32 s57, s57, s58
    buffer_load_dwordx4 v66, s[28:31], s56 offen offset:2048 lds
    s_mov_b32 s63, s57
    s_mul_i32 s64, s50, 160
    s_add_u32 s66, s63, s64
    buffer_load_dwordx4 v67, s[28:31], s56 offen offset:3072 lds
    s_mul_i32 s58, s50, 5120
    s_add_u32 s57, s57, s58
    s_add_u32 s62, s57, 2560
    s_add_u32 m0, s55, 118784
    v_and_b32 v96, 1, v104
    v_mul_u32_u24 v96, 40960, v96
    v_cmp_gt_u32 vcc, 32, v1
    v_lshl_add_u32 v96, v105, 4, v96
    buffer_load_dwordx4 v68, s[28:31], s56 offen lds
    v_cndmask_b32 v13, v108, v96, vcc
    v_lshrrev_b32 v96, 3, v107
    v_lshl_add_u32 v96, v96, 2, v109
    s_bfe_u32 s56, s70, 0x40018
    s_add_u32 m0, s55, 110592
    s_lshl_b32 s56, s56, 7
    s_add_u32 s56, s56, s53
    v_bfe_u32 v97, v1, 2, 1
    v_lshl_add_u32 v98, v97, 3, v96
    v_add_u32 v99, 8, v96
    buffer_load_dwordx4 v18, s[24:27], s56 offen offset:0 lds
    v_cmp_gt_u32 vcc, 8, v96
    v_min_u32 v99, 20, v99
    v_min_u32 v96, 9, v96
    v_cndmask_b32 v110, v99, v98, vcc
    buffer_load_dwordx4 v19, s[24:27], s56 offen offset:1024 lds
    v_mad_u32_u24 v111, v97, 10, v96
    s_cmp_eq_u32 s48, 0
    s_cbranch_scc0 L_setBb
    v_cmp_gt_u32 vcc, 16, v110
    v_mov_b32 v98, 80
    v_mov_b32 v99, 157952
    v_mov_b32 v96, 256
    v_mov_b32 v97, 157184
    v_cndmask_b32 v98, v98, v96, vcc
    v_cndmask_b32 v99, v99, v97, vcc
    v_lshl_add_u32 v99, v110, 4, v99
    v_mad_u32_u24 v9, v106, v98, v99
    v_lshl_add_u32 v10, v98, 1, v9
    v_lshlrev_b32 v98, 3, v106
    v_lshl_add_u32 v98, v110, 4, v98
    v_add_u32 v11, 158528, v98
    s_branch L_setJb
L_setBb:
    v_mul_u32_u24 v98, 336, v106
    v_cmp_gt_u32 vcc, 32, v1
    v_lshl_add_u32 v9, v110, 4, v98
    v_lshlrev_b32 v99, 4, v110
    v_add_u32 v9, 157184, v9
    v_add_u32 v99, 157856, v99
    v_mov_b32 v10, 160784
    v_cndmask_b32 v11, v10, v99, vcc
L_setJb:
    s_nop 1
    s_mul_i32 s57, s51, 1280
    buffer_load_dwordx4 v20, s[24:27], s56 offen offset:2048 lds
    s_add_u32 s57, s57, 102400
    v_mul_u32_u24 v96, 40, v105
    v_add_u32 v96, s57, v96
    buffer_load_dwordx4 v21, s[24:27], s56 offen offset:3072 lds
    v_add_u32 v97, 0, v104
    v_mul_u32_u24 v98, 52, v97
    v_lshrrev_b32 v98, 8, v98
    s_waitcnt lgkmcnt(0)
    s_waitcnt vmcnt(10)
    s_barrier
    ds_read_b128 a[32:35], v15 offset:8192
    ds_read_b128 a[36:39], v15 offset:10240
    ds_read_b128 a[40:43], v17 offset:8192
    ds_read_b128 a[44:47], v17 offset:10240
    s_add_u32 m0, s55, 4096
    s_bfe_u32 s56, s71, 0x40000
    s_mul_i32 s56, s56, 245760
    s_add_u32 s56, s56, s59
    buffer_load_dwordx4 v64, s[28:31], s56 offen offset:0 lds
    buffer_load_dwordx4 v65, s[28:31], s56 offen offset:1024 lds
    v_mul_u32_u24 v98, 5080, v98
    v_lshl_add_u32 v98, v97, 3, v98
    v_add_u32 v22, v98, v96
    v_add_u32 v97, 4, v104
    buffer_load_dwordx4 v66, s[28:31], s56 offen offset:2048 lds
    v_mul_u32_u24 v98, 52, v97
    v_lshrrev_b32 v98, 8, v98
    v_mul_u32_u24 v98, 5080, v98
    buffer_load_dwordx4 v67, s[28:31], s56 offen offset:3072 lds
    v_lshl_add_u32 v98, v97, 3, v98
    v_add_u32 v23, v98, v96
    v_add_u32 v97, 8, v104
    s_add_u32 m0, s55, 8192
    v_mul_u32_u24 v98, 52, v97
    v_lshrrev_b32 v98, 8, v98
    v_mul_u32_u24 v98, 5080, v98
    v_lshl_add_u32 v98, v97, 3, v98
    buffer_load_dwordx4 v68, s[28:31], s56 offen lds
    v_add_u32 v24, v98, v96
    v_add_u32 v97, 12, v104
    v_mul_u32_u24 v98, 52, v97
    s_bfe_u32 s56, s71, 0x40000
    s_add_u32 m0, s55, 0
    s_lshl_b32 s56, s56, 7
    s_add_u32 s56, s56, s53
    v_lshrrev_b32 v98, 8, v98
    v_mul_u32_u24 v98, 5080, v98
    v_lshl_add_u32 v98, v97, 3, v98
    buffer_load_dwordx4 v18, s[24:27], s56 offen offset:0 lds
    v_add_u32 v25, v98, v96
    v_add_u32 v97, 16, v104
    v_mul_u32_u24 v98, 52, v97
    v_lshrrev_b32 v98, 8, v98
    buffer_load_dwordx4 v19, s[24:27], s56 offen offset:1024 lds
    v_mul_u32_u24 v98, 5080, v98
    v_lshl_add_u32 v98, v97, 3, v98
    v_add_u32 v26, v98, v96
    buffer_load_dwordx4 v20, s[24:27], s56 offen offset:2048 lds
    s_addk_i32 s57, 10240
    v_mul_u32_u24 v96, 40, v107
    v_add_u32 v96, s57, v96
    buffer_load_dwordx4 v21, s[24:27], s56 offen offset:3072 lds
    v_lshl_add_u32 v5, v106, 4, v96
    v_add_u32 v6, 32, v96
    v_mul_i32_i24 v97, -40960, v106
    s_waitcnt lgkmcnt(0)
    s_waitcnt vmcnt(9)
    s_barrier
    ds_read_b128 a[48:51], v15 offset:45056
    ds_read_b128 a[52:55], v15 offset:47104
    ds_read_b128 a[56:59], v17 offset:45056
    ds_read_b128 a[60:63], v17 offset:47104
    s_add_u32 m0, s55, 40960
    s_bfe_u32 s56, s71, 0x40008
    s_mul_i32 s56, s56, 245760
    s_add_u32 s56, s56, s59
    buffer_load_dwordx4 v64, s[28:31], s56 offen offset:0 lds
    buffer_load_dwordx4 v65, s[28:31], s56 offen offset:1024 lds
    v_add_u32 v27, v96, v97
    v_lshlrev_b32 v96, 3, v1
    v_add_u32 v8, 150528, v96
    v_mul_u32_u24 v96, 26, v1
    buffer_load_dwordx4 v66, s[28:31], s56 offen offset:2048 lds
    v_lshrrev_b32 v96, 8, v96
    v_lshlrev_b32 v97, 7, v1
    v_mul_u32_u24 v98, 1280, v96
    buffer_load_dwordx4 v67, s[28:31], s56 offen offset:3072 lds
    v_lshrrev_b32 v96, 1, v96
    v_mul_u32_u24 v96, 35840, v96
    v_cmp_gt_u32 vcc, 40, v1
    s_add_u32 m0, s55, 45056
    s_sub_u32 s57, s62, 2560
    v_add3_u32 v96, v96, v97, v98
    v_add_u32 v96, s57, v96
    v_cndmask_b32 v69, v108, v96, vcc
    buffer_load_dwordx4 v68, s[28:31], s56 offen lds
    v_cmp_gt_u32 vcc, 16, v1
    s_mul_i32 s57, s51, 13
    s_nop 0
    v_cndmask_b32 v70, v108, v69, vcc
    s_bfe_u32 s56, s71, 0x40008
    s_add_u32 m0, s55, 36864
    s_lshl_b32 s56, s56, 7
    s_add_u32 s56, s56, s53
    v_cndmask_b32 v69, v69, v108, vcc
    v_add_u32 v96, s57, v1
    v_min_u32 v96, 49, v96
    buffer_load_dwordx4 v18, s[24:27], s56 offen offset:0 lds
    v_lshlrev_b32 v97, 7, v96
    s_lshl3_add_u32 s58, s49, s50
    v_cmp_gt_u32 vcc, 13, v1
    s_mulk_i32 s58, 6400
    buffer_load_dwordx4 v19, s[24:27], s56 offen offset:1024 lds
    v_add_u32 v97, s58, v97
    v_cndmask_b32 v71, v108, v97, vcc
    s_cmp_eq_u32 s48, 0
    s_cselect_b32 s40, s10, s16
    s_cselect_b32 s41, s11, s17
    s_mov_b32 s42, 819200
    buffer_load_dwordx4 v20, s[24:27], s56 offen offset:2048 lds
    s_lshl_b32 s57, s51, 10
    s_add_u32 s57, s57, 153600
    v_lshlrev_b32 v96, 1, v111
    buffer_load_dwordx4 v21, s[24:27], s56 offen offset:3072 lds
    v_add_u32 v89, s57, v96
    v_mul_u32_u24 v96, 320, v106
    v_add_u32 v88, v89, v96
    s_waitcnt lgkmcnt(0)
    s_waitcnt vmcnt(9)
    s_barrier
    ds_read_b128 a[64:67], v14 offset:0
    ds_read_b128 a[68:71], v14 offset:2048
    ds_read_b128 a[72:75], v16 offset:0
    ds_read_b128 a[76:79], v16 offset:2048
    s_add_u32 m0, s55, 77824
    s_bfe_u32 s56, s71, 0x40010
    s_mul_i32 s56, s56, 245760
    s_add_u32 s56, s56, s59
    buffer_load_dwordx4 v64, s[28:31], s56 offen offset:0 lds
    buffer_load_dwordx4 v65, s[28:31], s56 offen offset:1024 lds
    buffer_load_dwordx4 v66, s[28:31], s56 offen offset:2048 lds
    buffer_load_dwordx4 v67, s[28:31], s56 offen offset:3072 lds
    s_add_u32 m0, s55, 81920
    s_nop 0
    buffer_load_dwordx4 v68, s[28:31], s56 offen lds
    s_bfe_u32 s56, s71, 0x40010
    s_add_u32 m0, s55, 73728
    s_lshl_b32 s56, s56, 7
    s_add_u32 s56, s56, s53
    buffer_load_dwordx4 v18, s[24:27], s56 offen offset:0 lds
    buffer_load_dwordx4 v19, s[24:27], s56 offen offset:1024 lds
    buffer_load_dwordx4 v20, s[24:27], s56 offen offset:2048 lds
    buffer_load_dwordx4 v21, s[24:27], s56 offen offset:3072 lds
    s_and_b32 s58, s2, 7
    s_lshl_b32 s57, s51, 8
    s_lshl2_add_u32 s58, s58, s57
    buffer_load_dword v117, off, s[44:47], s58 sc1
    s_waitcnt lgkmcnt(0)
    s_waitcnt vmcnt(10)
    s_barrier
    ds_read_b128 a[80:83], v14 offset:36864
    ds_read_b128 a[84:87], v14 offset:38912
    ds_read_b128 a[88:91], v16 offset:36864
    ds_read_b128 a[92:95], v16 offset:38912
    s_add_u32 m0, s55, 114688
    s_bfe_u32 s56, s71, 0x40018
    s_mul_i32 s56, s56, 245760
    s_add_u32 s56, s56, s59
    buffer_load_dwordx4 v64, s[28:31], s56 offen offset:0 lds
    buffer_load_dwordx4 v65, s[28:31], s56 offen offset:1024 lds
    buffer_load_dwordx4 v66, s[28:31], s56 offen offset:2048 lds
    buffer_load_dwordx4 v67, s[28:31], s56 offen offset:3072 lds
    s_add_u32 m0, s55, 118784
    s_nop 0
    buffer_load_dwordx4 v68, s[28:31], s56 offen lds
    s_bfe_u32 s56, s71, 0x40018
    s_add_u32 m0, s55, 110592
    s_lshl_b32 s56, s56, 7
    s_add_u32 s56, s56, s53
    buffer_load_dwordx4 v18, s[24:27], s56 offen offset:0 lds
    buffer_load_dwordx4 v19, s[24:27], s56 offen offset:1024 lds
    buffer_load_dwordx4 v20, s[24:27], s56 offen offset:2048 lds
    buffer_load_dwordx4 v21, s[24:27], s56 offen offset:3072 lds
    s_waitcnt lgkmcnt(0)
    s_waitcnt vmcnt(10)
    s_barrier
    ds_read_b128 a[96:99], v15 offset:8192
    ds_read_b128 a[100:103], v15 offset:10240
    ds_read_b128 a[104:107], v17 offset:8192
    ds_read_b128 a[108:111], v17 offset:10240
    s_waitcnt vmcnt(9)
    v_cmp_eq_u32 vcc, s51, v117
    s_cbranch_vccnz L_ld_slow
L_ld_ok:
    s_getreg_b32 s57, hwreg(HW_REG_XCC_ID)
    s_and_b32 s57, s57, 15
    s_add_u32 s57, s57, 1
    v_mov_b32 v117, s57
    s_lshr_b32 s57, s2, 3
    s_lshl_b32 s58, s57, 7
    s_lshl2_add_u32 s57, s57, s68
    s_add_u32 s58, s58, s68
    s_cmp_lt_u32 s2, 192
    s_cselect_b32 s58, s58, 0x40000000
    s_cmp_eq_u32 s51, 0
    s_cselect_b32 s58, s58, 0x40000000
    s_cselect_b32 s57, s57, 0x40000000
    s_mov_b64 exec, 1
    buffer_load_dword v0, off, s[32:35], s58 sc1
    buffer_store_dword v117, off, s[32:35], s57 offset:512
    s_mov_b64 exec, -1
    s_add_u32 m0, s55, 4096
    s_bfe_u32 s56, s72, 0x40000
    s_mul_i32 s56, s56, 245760
    s_add_u32 s56, s56, s59
    buffer_load_dwordx4 v64, s[28:31], s56 offen offset:0 lds
    buffer_load_dwordx4 v65, s[28:31], s56 offen offset:1024 lds
    buffer_load_dwordx4 v66, s[28:31], s56 offen offset:2048 lds
    buffer_load_dwordx4 v67, s[28:31], s56 offen offset:3072 lds
    s_add_u32 m0, s55, 8192
    s_nop 0
    buffer_load_dwordx4 v68, s[28:31], s56 offen lds
    s_bfe_u32 s56, s72, 0x40000
    s_add_u32 m0, s55, 0
    s_lshl_b32 s56, s56, 7
    s_add_u32 s56, s56, s53
    buffer_load_dwordx4 v18, s[24:27], s56 offen offset:0 lds
    buffer_load_dwordx4 v19, s[24:27], s56 offen offset:1024 lds
    buffer_load_dwordx4 v20, s[24:27], s56 offen offset:2048 lds
    buffer_load_dwordx4 v21, s[24:27], s56 offen offset:3072 lds
    s_waitcnt lgkmcnt(0)
    s_waitcnt vmcnt(11)
    s_barrier
    ds_read_b128 a[112:115], v15 offset:45056
    ds_read_b128 a[116:119], v15 offset:47104
    ds_read_b128 a[120:123], v17 offset:45056
    ds_read_b128 a[124:127], v17 offset:47104
    s_add_u32 m0, s55, 40960
    s_bfe_u32 s56, s72, 0x40008
    s_mul_i32 s56, s56, 245760
    s_add_u32 s56, s56, s59
    buffer_load_dwordx4 v64, s[28:31], s56 offen offset:0 lds
    buffer_load_dwordx4 v65, s[28:31], s56 offen offset:1024 lds
    buffer_load_dwordx4 v66, s[28:31], s56 offen offset:2048 lds
    buffer_load_dwordx4 v67, s[28:31], s56 offen offset:3072 lds
    s_add_u32 m0, s55, 45056
    s_nop 0
    buffer_load_dwordx4 v68, s[28:31], s56 offen lds
    s_bfe_u32 s56, s72, 0x40008
    s_add_u32 m0, s55, 36864
    s_lshl_b32 s56, s56, 7
    s_add_u32 s56, s56, s53
    buffer_load_dwordx4 v18, s[24:27], s56 offen offset:0 lds
    buffer_load_dwordx4 v19, s[24:27], s56 offen offset:1024 lds
    buffer_load_dwordx4 v20, s[24:27], s56 offen offset:2048 lds
    buffer_load_dwordx4 v21, s[24:27], s56 offen offset:3072 lds
    s_waitcnt lgkmcnt(0)
    s_waitcnt vmcnt(9)
    s_barrier
    ds_read_b128 v[96:99], v14 offset:0
    ds_read_b128 v[100:103], v14 offset:2048
    ds_read_b128 v[104:107], v16 offset:0
    ds_read_b128 v[108:111], v16 offset:2048
    s_mul_i32 s55, s51, 5120
    s_lshr_b32 s57, s51, 1
    s_lshl_b32 s57, s57, 3
    s_lshr_b32 s70, s70, s57
    s_lshr_b32 s71, s71, s57
    s_lshr_b32 s72, s72, s57
    s_add_u32 m0, s55, 81920
    s_bfe_u32 s56, s70, 0x40000
    s_mul_i32 s56, s56, 245760
    s_add_u32 s56, s56, s54
    buffer_load_dwordx4 v64, s[28:31], s56 offen offset:0 lds
    buffer_load_dwordx4 v65, s[28:31], s56 offen offset:1024 lds
    buffer_load_dwordx4 v66, s[28:31], s56 offen offset:2048 lds
    buffer_load_dwordx4 v67, s[28:31], s56 offen offset:3072 lds
    s_add_u32 m0, s55, 86016
    s_nop 0
    buffer_load_dwordx4 v68, s[28:31], s56 offen lds
    buffer_load_dword v0, v70, s[36:39], 0 offen sc1
    buffer_load_dword v0, v71, s[40:43], 0 offen
    s_waitcnt lgkmcnt(0)
    s_waitcnt vmcnt(7)
    s_barrier
    ds_read_b128 v[112:115], v14 offset:36864
    ds_read_b128 v[116:119], v14 offset:38912
    ds_read_b128 v[120:123], v16 offset:36864
    ds_read_b128 v[124:127], v16 offset:38912
    s_add_u32 m0, s55, 0
    s_bfe_u32 s56, s70, 0x40010
    s_mul_i32 s56, s56, 245760
    s_add_u32 s56, s56, s54
    buffer_load_dwordx4 v64, s[28:31], s56 offen offset:0 lds
    buffer_load_dwordx4 v65, s[28:31], s56 offen offset:1024 lds
    buffer_load_dwordx4 v66, s[28:31], s56 offen offset:2048 lds
    buffer_load_dwordx4 v67, s[28:31], s56 offen offset:3072 lds
    s_add_u32 m0, s55, 4096
    s_nop 0
    buffer_load_dwordx4 v68, s[28:31], s56 offen lds
    s_waitcnt lgkmcnt(0)
    s_setprio 0
    s_cmp_eq_u32 s48, 0
    s_cbranch_scc0 L_Bb
    s_branch L_Ab
.p2align 12
.fill 685, 4, 0xbf800000
L_Ab:
    ds_read_u16 v72, v88 offset:0
    ds_read_u16 v73, v88 offset:40
    ds_read_u16 v74, v88 offset:80
    ds_read_u16 v75, v88 offset:120
    ds_read_u16 v76, v88 offset:160
    ds_read_u16 v77, v88 offset:200
    ds_read_u16 v78, v88 offset:240
    ds_read_u16 v79, v88 offset:280
    ds_read_u16 v90, v89 offset:640
    ds_read_u16 v91, v89 offset:680
    ds_read_u16 v92, v89 offset:720
    ds_read_u16 v93, v89 offset:760
    v_cmp_gt_u32 vcc, 32, v1
    s_mul_i32 s58, s51, 1536
    s_sub_u32 s58, s58, 3072
    s_waitcnt lgkmcnt(11)
    v_lshlrev_b32 v72, 16, v72
    v_mul_f32 v72, s74, v72
    s_waitcnt lgkmcnt(10)
    v_lshlrev_b32 v73, 16, v73
    v_mul_f32 v73, s74, v73
    s_waitcnt lgkmcnt(9)
    v_lshlrev_b32 v74, 16, v74
    v_mul_f32 v74, s74, v74
    s_waitcnt lgkmcnt(8)
    v_lshlrev_b32 v75, 16, v75
    v_mul_f32 v75, s74, v75
    s_waitcnt lgkmcnt(7)
    v_lshlrev_b32 v76, 16, v76
    v_mul_f32 v76, s74, v76
    s_waitcnt lgkmcnt(6)
    v_lshlrev_b32 v77, 16, v77
    v_mul_f32 v77, s74, v77
    s_waitcnt lgkmcnt(5)
    v_lshlrev_b32 v78, 16, v78
    v_mul_f32 v78, s74, v78
    s_waitcnt lgkmcnt(4)
    v_lshlrev_b32 v79, 16, v79
    v_mul_f32 v79, s74, v79
    s_waitcnt lgkmcnt(3)
    v_lshlrev_b32 v90, 16, v90
    v_mul_f32 v90, s74, v90
    s_waitcnt lgkmcnt(2)
    v_lshlrev_b32 v91, 16, v91
    v_mul_f32 v91, s74, v91
    s_waitcnt lgkmcnt(1)
    v_lshlrev_b32 v92, 16, v92
    v_mul_f32 v92, s74, v92
    s_waitcnt lgkmcnt(0)
    v_lshlrev_b32 v93, 16, v93
    v_mul_f32 v93, s74, v93
    v_cvt_pk_bf16_f32 v72, v72, v73
    v_cvt_pk_bf16_f32 v73, v74, v75
    v_cvt_pk_bf16_f32 v74, v76, v77
    v_cvt_pk_bf16_f32 v75, v78, v79
    v_cvt_pk_bf16_f32 v76, v90, v91
    v_cvt_pk_bf16_f32 v77, v92, v93
    v_cndmask_b32 v76, 0, v76, vcc
    v_cndmask_b32 v77, 0, v77, vcc
    v_add_u32 v78, s58, v8
    ds_write_b64 v78, v[72:73] offset:0
    ds_write_b64 v78, v[74:75] offset:512
    ds_write_b64 v78, v[76:77] offset:1024
    s_waitcnt lgkmcnt(0)
    s_barrier
    ds_read_b64 v[72:73], v8 offset:0
    ds_read_b64 v[74:75], v8 offset:512
    ds_read_b64 v[76:77], v8 offset:1024
    ds_read_b64 v[78:79], v5 offset:0
    ds_read_b64 v[80:81], v5 offset:8
    ds_read_b64 v[82:83], v6 offset:0
    ds_read_b64 v[84:85], v8 offset:1536
    ds_read_b64 v[86:87], v8 offset:2048
    ds_read_b64 v[88:89], v8 offset:2560
    ds_read_b64 v[90:91], v5 offset:5120
    ds_read_b64 v[92:93], v5 offset:5128
    ds_read_b64 v[94:95], v6 offset:5120
    s_waitcnt lgkmcnt(7)
    v_mfma_f32_32x32x16_bf16 v[32:47], v[72:75], v[78:81], 0
    s_waitcnt lgkmcnt(6)
    v_mfma_f32_32x32x8_bf16 v[32:47], v[76:77], v[82:83], v[32:47]
    s_waitcnt lgkmcnt(1)
    v_mfma_f32_32x32x16_bf16 v[48:63], v[84:87], v[90:93], 0
    s_waitcnt lgkmcnt(0)
    v_mfma_f32_32x32x8_bf16 v[48:63], v[88:89], v[94:95], v[48:63]
    s_nop 7
    v_exp_f32 v72, v32
    v_exp_f32_e64 v32, -v32
    v_exp_f32 v73, v33
    v_exp_f32_e64 v33, -v33
    v_exp_f32 v74, v34
    v_exp_f32_e64 v34, -v34
    v_exp_f32 v75, v35
    v_exp_f32_e64 v35, -v35
    v_exp_f32 v76, v36
    v_exp_f32_e64 v36, -v36
    v_exp_f32 v77, v37
    v_exp_f32_e64 v37, -v37
    v_exp_f32 v78, v38
    v_exp_f32_e64 v38, -v38
    v_exp_f32 v79, v39
    v_exp_f32_e64 v39, -v39
    v_exp_f32 v80, v40
    v_exp_f32_e64 v40, -v40
    v_exp_f32 v81, v41
    v_exp_f32_e64 v41, -v41
    v_pk_add_f32 v[42:43], v[72:73], v[74:75]
    v_pk_add_f32 v[44:45], v[32:33], v[34:35]
    v_pk_add_f32 v[42:43], v[42:43], v[76:77]
    v_pk_add_f32 v[44:45], v[44:45], v[36:37]
    v_pk_add_f32 v[42:43], v[42:43], v[78:79]
    v_pk_add_f32 v[44:45], v[44:45], v[38:39]
    v_pk_add_f32 v[42:43], v[42:43], v[80:81]
    v_pk_add_f32 v[44:45], v[44:45], v[40:41]
    v_add_f32 v42, v42, v43
    v_add_f32 v44, v44, v45
    s_nop 1
    v_permlane32_swap_b32 v42, v44
    v_add_f32 v42, v42, v44
    v_cmp_ngt_f32 vcc, 0x56800000, v42
    v_rcp_f32 v42, v42
    s_cbranch_vccnz L_k0Ab_max
L_k0Ab_sum:
    v_mov_b32 v44, v42
    s_nop 1
    v_permlane32_swap_b32 v42, v44
    v_pk_mul_f32 v[72:73], v[72:73], v[42:43] op_sel_hi:[1,0]
    v_pk_mul_f32 v[32:33], v[32:33], v[44:45] op_sel_hi:[1,0]
    v_pk_mul_f32 v[74:75], v[74:75], v[42:43] op_sel_hi:[1,0]
    v_pk_mul_f32 v[34:35], v[34:35], v[44:45] op_sel_hi:[1,0]
    v_pk_mul_f32 v[76:77], v[76:77], v[42:43] op_sel_hi:[1,0]
    v_pk_mul_f32 v[36:37], v[36:37], v[44:45] op_sel_hi:[1,0]
    v_pk_mul_f32 v[78:79], v[78:79], v[42:43] op_sel_hi:[1,0]
    v_pk_mul_f32 v[38:39], v[38:39], v[44:45] op_sel_hi:[1,0]
    v_pk_mul_f32 v[80:81], v[80:81], v[42:43] op_sel_hi:[1,0]
    v_pk_mul_f32 v[40:41], v[40:41], v[44:45] op_sel_hi:[1,0]
    v_cvt_pk_bf16_f32 v72, v72, v73
    v_cvt_pk_bf16_f32 v73, v74, v75
    v_cvt_pk_bf16_f32 v74, v76, v77
    v_cvt_pk_bf16_f32 v75, v78, v79
    v_cvt_pk_bf16_f32 v76, v80, v81
    v_cvt_pk_bf16_f32 v77, v32, v33
    v_cvt_pk_bf16_f32 v78, v34, v35
    v_cvt_pk_bf16_f32 v79, v36, v37
    v_cvt_pk_bf16_f32 v80, v38, v39
    v_cvt_pk_bf16_f32 v81, v40, v41
    ds_write_b64 v27, v[72:73] offset:0
    ds_write_b64 v27, v[74:75] offset:8
    ds_write_b64 v27, v[76:77] offset:16
    ds_write_b64 v27, v[78:79] offset:24
    ds_write_b64 v27, v[80:81] offset:32
    v_exp_f32 v84, v48
    buffer_load_dword v0, v69, s[36:39], 0 offen sc1
    v_exp_f32_e64 v48, -v48
    v_exp_f32 v85, v49
    v_exp_f32_e64 v49, -v49
    v_exp_f32 v86, v50
    v_exp_f32_e64 v50, -v50
    v_exp_f32 v87, v51
    v_exp_f32_e64 v51, -v51
    v_exp_f32 v88, v52
    v_exp_f32_e64 v52, -v52
    v_exp_f32 v89, v53
    v_exp_f32_e64 v53, -v53
    v_exp_f32 v90, v54
    v_exp_f32_e64 v54, -v54
    v_exp_f32 v91, v55
    v_exp_f32_e64 v55, -v55
    v_exp_f32 v92, v56
    v_exp_f32_e64 v56, -v56
    v_exp_f32 v93, v57
    v_exp_f32_e64 v57, -v57
    v_pk_add_f32 v[58:59], v[84:85], v[86:87]
    v_pk_add_f32 v[60:61], v[48:49], v[50:51]
    v_pk_add_f32 v[58:59], v[58:59], v[88:89]
    v_pk_add_f32 v[60:61], v[60:61], v[52:53]
    v_pk_add_f32 v[58:59], v[58:59], v[90:91]
    v_pk_add_f32 v[60:61], v[60:61], v[54:55]
    v_pk_add_f32 v[58:59], v[58:59], v[92:93]
    v_pk_add_f32 v[60:61], v[60:61], v[56:57]
    v_add_f32 v58, v58, v59
    v_add_f32 v60, v60, v61
    s_nop 1
    v_permlane32_swap_b32 v58, v60
    v_add_f32 v58, v58, v60
    v_cmp_ngt_f32 vcc, 0x56800000, v58
    v_rcp_f32 v58, v58
    s_cbranch_vccnz L_k1Ab_max
L_k1Ab_sum:
    v_mov_b32 v60, v58
    s_nop 1
    v_permlane32_swap_b32 v58, v60
    v_pk_mul_f32 v[84:85], v[84:85], v[58:59] op_sel_hi:[1,0]
    v_pk_mul_f32 v[48:49], v[48:49], v[60:61] op_sel_hi:[1,0]
    v_pk_mul_f32 v[86:87], v[86:87], v[58:59] op_sel_hi:[1,0]
    v_pk_mul_f32 v[50:51], v[50:51], v[60:61] op_sel_hi:[1,0]
    v_pk_mul_f32 v[88:89], v[88:89], v[58:59] op_sel_hi:[1,0]
    v_pk_mul_f32 v[52:53], v[52:53], v[60:61] op_sel_hi:[1,0]
    v_pk_mul_f32 v[90:91], v[90:91], v[58:59] op_sel_hi:[1,0]
    v_pk_mul_f32 v[54:55], v[54:55], v[60:61] op_sel_hi:[1,0]
    v_pk_mul_f32 v[92:93], v[92:93], v[58:59] op_sel_hi:[1,0]
    v_pk_mul_f32 v[56:57], v[56:57], v[60:61] op_sel_hi:[1,0]
    v_cvt_pk_bf16_f32 v84, v84, v85
    v_cvt_pk_bf16_f32 v85, v86, v87
    v_cvt_pk_bf16_f32 v86, v88, v89
    v_cvt_pk_bf16_f32 v87, v90, v91
    v_cvt_pk_bf16_f32 v88, v92, v93
    v_cvt_pk_bf16_f32 v89, v48, v49
    v_cvt_pk_bf16_f32 v90, v50, v51
    v_cvt_pk_bf16_f32 v91, v52, v53
    v_cvt_pk_bf16_f32 v92, v54, v55
    v_cvt_pk_bf16_f32 v93, v56, v57
    ds_write_b64 v27, v[84:85] offset:5120
    ds_write_b64 v27, v[86:87] offset:5128
    ds_write_b64 v27, v[88:89] offset:5136
    ds_write_b64 v27, v[90:91] offset:5144
    ds_write_b64 v27, v[92:93] offset:5152
    s_waitcnt vmcnt(1)
    s_waitcnt lgkmcnt(0)
    s_barrier
    ds_read_b64_tr_b16 v[72:73], v3 offset:16384
    ds_read_b64_tr_b16 v[74:75], v3 offset:18944
    ds_read_b64_tr_b16 v[76:77], v3 offset:16416
    ds_read_b64_tr_b16 v[78:79], v3 offset:18976
    ds_read_b64_tr_b16 v[80:81], v3 offset:16448
    ds_read_b64_tr_b16 v[82:83], v3 offset:19008
    ds_read_b64_tr_b16 v[84:85], v3 offset:16480
    ds_read_b64_tr_b16 v[86:87], v3 offset:19040
    ds_read_b64_tr_b16 v[88:89], v3 offset:16512
    ds_read_b64_tr_b16 v[90:91], v3 offset:19072
    s_waitcnt lgkmcnt(8)
    v_mfma_f32_16x16x32_bf16 v[32:35], v[72:75], a[0:3], v[28:31]
    ds_read_b64_tr_b16 v[92:93], v3 offset:21504
    v_mfma_f32_16x16x32_bf16 v[36:39], v[72:75], a[4:7], v[28:31]
    ds_read_b64_tr_b16 v[94:95], v3 offset:24064
    s_waitcnt lgkmcnt(8)
    v_mfma_f32_16x16x32_bf16 v[40:43], v[76:79], a[0:3], v[28:31]
    ds_read_b64_tr_b16 v[72:73], v3 offset:21536
    v_mfma_f32_16x16x32_bf16 v[44:47], v[76:79], a[4:7], v[28:31]
    ds_read_b64_tr_b16 v[74:75], v3 offset:24096
    s_waitcnt lgkmcnt(8)
    v_mfma_f32_16x16x32_bf16 v[48:51], v[80:83], a[0:3], v[28:31]
    ds_read_b64_tr_b16 v[76:77], v3 offset:21568
    v_mfma_f32_16x16x32_bf16 v[52:55], v[80:83], a[4:7], v[28:31]
    ds_read_b64_tr_b16 v[78:79], v3 offset:24128
    s_waitcnt lgkmcnt(8)
    v_mfma_f32_16x16x32_bf16 v[56:59], v[84:87], a[0:3], v[28:31]
    ds_read_b64_tr_b16 v[80:81], v3 offset:21600
    v_mfma_f32_16x16x32_bf16 v[60:63], v[84:87], a[4:7], v[28:31]
    ds_read_b64_tr_b16 v[82:83], v3 offset:24160
    s_waitcnt lgkmcnt(8)
    v_mfma_f32_16x16x32_bf16 v[64:67], v[88:91], a[0:3], v[28:31]
    ds_read_b64_tr_b16 v[84:85], v3 offset:21632
    v_mfma_f32_16x16x32_bf16 v[68:71], v[88:91], a[4:7], v[28:31]
    ds_read_b64_tr_b16 v[86:87], v3 offset:24192
    s_waitcnt lgkmcnt(8)
    v_mfma_f32_16x16x32_bf16 v[32:35], v[92:95], a[8:11], v[32:35]
    ds_read_b64_tr_b16 v[88:89], v3 offset:26624
    v_mfma_f32_16x16x32_bf16 v[36:39], v[92:95], a[12:15], v[36:39]
    ds_read_b64_tr_b16 v[90:91], v3 offset:29184
    s_waitcnt lgkmcnt(8)
    v_mfma_f32_16x16x32_bf16 v[40:43], v[72:75], a[8:11], v[40:43]
    ds_read_b64_tr_b16 v[92:93], v3 offset:26656
    v_lshrrev_b32 v20, 4, v1
    v_mfma_f32_16x16x32_bf16 v[44:47], v[72:75], a[12:15], v[44:47]
    ds_read_b64_tr_b16 v[94:95], v3 offset:29216
    s_waitcnt lgkmcnt(8)
    v_mfma_f32_16x16x32_bf16 v[48:51], v[76:79], a[8:11], v[48:51]
    ds_read_b64_tr_b16 v[72:73], v3 offset:26688
    v_and_b32 v21, 15, v1
    v_mfma_f32_16x16x32_bf16 v[52:55], v[76:79], a[12:15], v[52:55]
    ds_read_b64_tr_b16 v[74:75], v3 offset:29248
    s_waitcnt lgkmcnt(8)
    v_mfma_f32_16x16x32_bf16 v[56:59], v[80:83], a[8:11], v[56:59]
    ds_read_b64_tr_b16 v[76:77], v3 offset:26720
    v_add_u32 v15, 40960, v7
    v_mfma_f32_16x16x32_bf16 v[60:63], v[80:83], a[12:15], v[60:63]
    ds_read_b64_tr_b16 v[78:79], v3 offset:29280
    s_waitcnt lgkmcnt(8)
    v_mfma_f32_16x16x32_bf16 v[64:67], v[84:87], a[8:11], v[64:67]
    ds_read_b64_tr_b16 v[80:81], v3 offset:26752
    v_mul_u32_u24 v16, 5120, v20
    v_mfma_f32_16x16x32_bf16 v[68:71], v[84:87], a[12:15], v[68:71]
    ds_read_b64_tr_b16 v[82:83], v3 offset:29312
    s_waitcnt lgkmcnt(8)
    v_mfma_f32_16x16x32_bf16 v[32:35], v[88:91], a[16:19], v[32:35]
    ds_read_b64_tr_b16 v[84:85], v3 offset:31744
    v_lshl_add_u32 v16, v21, 4, v16
    v_mfma_f32_16x16x32_bf16 v[36:39], v[88:91], a[20:23], v[36:39]
    ds_read_b64_tr_b16 v[86:87], v3 offset:34304
    s_waitcnt lgkmcnt(8)
    v_mfma_f32_16x16x32_bf16 v[40:43], v[92:95], a[16:19], v[40:43]
    ds_read_b64_tr_b16 v[88:89], v3 offset:31776
    v_add_u32 v17, 40960, v16
    v_mfma_f32_16x16x32_bf16 v[44:47], v[92:95], a[20:23], v[44:47]
    ds_read_b64_tr_b16 v[90:91], v3 offset:34336
    s_waitcnt lgkmcnt(8)
    v_mfma_f32_16x16x32_bf16 v[48:51], v[72:75], a[16:19], v[48:51]
    ds_read_b64_tr_b16 v[92:93], v3 offset:31808
    s_mul_i32 s57, s51, 10240
    v_mfma_f32_16x16x32_bf16 v[52:55], v[72:75], a[20:23], v[52:55]
    ds_read_b64_tr_b16 v[94:95], v3 offset:34368
    s_waitcnt lgkmcnt(8)
    v_mfma_f32_16x16x32_bf16 v[56:59], v[76:79], a[16:19], v[56:59]
    ds_read_b64_tr_b16 v[72:73], v3 offset:31840
    s_add_u32 s57, s57, 102400
    v_mfma_f32_16x16x32_bf16 v[60:63], v[76:79], a[20:23], v[60:63]
    ds_read_b64_tr_b16 v[74:75], v3 offset:34400
    s_waitcnt lgkmcnt(8)
    v_mfma_f32_16x16x32_bf16 v[64:67], v[80:83], a[16:19], v[64:67]
    ds_read_b64_tr_b16 v[76:77], v3 offset:31872
    v_add_u32 v18, s57, v7
    v_mfma_f32_16x16x32_bf16 v[68:71], v[80:83], a[20:23], v[68:71]
    ds_read_b64_tr_b16 v[78:79], v3 offset:34432
    s_waitcnt lgkmcnt(8)
    v_mfma_f32_16x16x32_bf16 v[32:35], v[84:87], a[24:27], v[32:35]
    ds_read_b64_tr_b16 v[80:81], v2 offset:0
    s_add_u32 s44, s63, 2560
    v_mfma_f32_16x16x32_bf16 v[36:39], v[84:87], a[28:31], v[36:39]
    ds_read_b64_tr_b16 v[82:83], v2 offset:2560
    s_waitcnt lgkmcnt(8)
    v_mfma_f32_16x16x32_bf16 v[40:43], v[88:91], a[24:27], v[40:43]
    ds_read_b64_tr_b16 v[84:85], v2 offset:32
    s_add_u32 s45, s44, 20480
    v_mfma_f32_16x16x32_bf16 v[44:47], v[88:91], a[28:31], v[44:47]
    ds_read_b64_tr_b16 v[86:87], v2 offset:2592
    s_waitcnt lgkmcnt(8)
    v_mfma_f32_16x16x32_bf16 v[48:51], v[92:95], a[24:27], v[48:51]
    ds_read_b64_tr_b16 v[88:89], v2 offset:64
    s_add_u32 s25, s50, 1
    v_mfma_f32_16x16x32_bf16 v[52:55], v[92:95], a[28:31], v[52:55]
    ds_read_b64_tr_b16 v[90:91], v2 offset:2624
    s_waitcnt lgkmcnt(8)
    v_mfma_f32_16x16x32_bf16 v[56:59], v[72:75], a[24:27], v[56:59]
    ds_read_b64_tr_b16 v[92:93], v2 offset:96
    s_and_b32 s25, s25, 7
    v_mfma_f32_16x16x32_bf16 v[60:63], v[72:75], a[28:31], v[60:63]
    ds_read_b64_tr_b16 v[94:95], v2 offset:2656
    s_waitcnt lgkmcnt(8)
    v_mfma_f32_16x16x32_bf16 v[64:67], v[76:79], a[24:27], v[64:67]
    ds_read_b64_tr_b16 v[72:73], v2 offset:128
    s_mulk_i32 s25, 5120
    v_mfma_f32_16x16x32_bf16 v[68:71], v[76:79], a[28:31], v[68:71]
    ds_read_b64_tr_b16 v[74:75], v2 offset:2688
    s_waitcnt lgkmcnt(8)
    v_mfma_f32_16x16x32_bf16 v[32:35], v[80:83], a[32:35], v[32:35]
    ds_read_b64_tr_b16 v[76:77], v2 offset:5120
    s_add_u32 s25, s25, s44
    v_mfma_f32_16x16x32_bf16 v[36:39], v[80:83], a[36:39], v[36:39]
    ds_read_b64_tr_b16 v[78:79], v2 offset:7680
    s_waitcnt lgkmcnt(8)
    v_mfma_f32_16x16x32_bf16 v[40:43], v[84:87], a[32:35], v[40:43]
    ds_read_b64_tr_b16 v[80:81], v2 offset:5152
    s_add_u32 s26, s50, 2
    v_mfma_f32_16x16x32_bf16 v[44:47], v[84:87], a[36:39], v[44:47]
    ds_read_b64_tr_b16 v[82:83], v2 offset:7712
    s_waitcnt lgkmcnt(8)
    v_mfma_f32_16x16x32_bf16 v[48:51], v[88:91], a[32:35], v[48:51]
    ds_read_b64_tr_b16 v[84:85], v2 offset:5184
    s_and_b32 s26, s26, 7
    v_mfma_f32_16x16x32_bf16 v[52:55], v[88:91], a[36:39], v[52:55]
    ds_read_b64_tr_b16 v[86:87], v2 offset:7744
    s_waitcnt lgkmcnt(8)
    v_mfma_f32_16x16x32_bf16 v[56:59], v[92:95], a[32:35], v[56:59]
    ds_read_b64_tr_b16 v[88:89], v2 offset:5216
    s_mulk_i32 s26, 5120
    v_mfma_f32_16x16x32_bf16 v[60:63], v[92:95], a[36:39], v[60:63]
    ds_read_b64_tr_b16 v[90:91], v2 offset:7776
    s_waitcnt lgkmcnt(8)
    v_mfma_f32_16x16x32_bf16 v[64:67], v[72:75], a[32:35], v[64:67]
    ds_read_b64_tr_b16 v[92:93], v2 offset:5248
    s_add_u32 s26, s26, s44
    v_mfma_f32_16x16x32_bf16 v[68:71], v[72:75], a[36:39], v[68:71]
    ds_read_b64_tr_b16 v[94:95], v2 offset:7808
    s_barrier
    s_waitcnt lgkmcnt(8)
    v_mfma_f32_16x16x32_bf16 v[32:35], v[76:79], a[40:43], v[32:35]
    ds_read_b64_tr_b16 v[72:73], v2 offset:10240
    s_add_u32 s27, s50, 3
    v_mfma_f32_16x16x32_bf16 v[36:39], v[76:79], a[44:47], v[36:39]
    ds_read_b64_tr_b16 v[74:75], v2 offset:12800
    s_waitcnt lgkmcnt(8)
    v_mfma_f32_16x16x32_bf16 v[40:43], v[80:83], a[40:43], v[40:43]
    ds_read_b64_tr_b16 v[76:77], v2 offset:10272
    s_and_b32 s27, s27, 7
    v_mfma_f32_16x16x32_bf16 v[44:47], v[80:83], a[44:47], v[44:47]
    ds_read_b64_tr_b16 v[78:79], v2 offset:12832
    s_waitcnt lgkmcnt(8)
    v_mfma_f32_16x16x32_bf16 v[48:51], v[84:87], a[40:43], v[48:51]
    ds_read_b64_tr_b16 v[80:81], v2 offset:10304
    s_mulk_i32 s27, 5120
    v_mfma_f32_16x16x32_bf16 v[52:55], v[84:87], a[44:47], v[52:55]
    ds_read_b64_tr_b16 v[82:83], v2 offset:12864
    s_waitcnt lgkmcnt(8)
    v_mfma_f32_16x16x32_bf16 v[56:59], v[88:91], a[40:43], v[56:59]
    ds_read_b64_tr_b16 v[84:85], v2 offset:10336
    s_add_u32 s27, s27, s44
    v_mfma_f32_16x16x32_bf16 v[60:63], v[88:91], a[44:47], v[60:63]
    ds_read_b64_tr_b16 v[86:87], v2 offset:12896
    s_waitcnt lgkmcnt(8)
    v_mfma_f32_16x16x32_bf16 v[64:67], v[92:95], a[40:43], v[64:67]
    ds_read_b64_tr_b16 v[88:89], v2 offset:10368
    s_add_u32 s40, s50, 4
    v_mfma_f32_16x16x32_bf16 v[68:71], v[92:95], a[44:47], v[68:71]
    ds_read_b64_tr_b16 v[90:91], v2 offset:12928
    s_waitcnt lgkmcnt(8)
    v_mfma_f32_16x16x32_bf16 v[32:35], v[72:75], a[48:51], v[32:35]
    ds_read_b64_tr_b16 v[92:93], v2 offset:15360
    s_and_b32 s40, s40, 7
    v_mfma_f32_16x16x32_bf16 v[36:39], v[72:75], a[52:55], v[36:39]
    ds_read_b64_tr_b16 v[94:95], v2 offset:17920
    s_waitcnt lgkmcnt(8)
    v_mfma_f32_16x16x32_bf16 v[40:43], v[76:79], a[48:51], v[40:43]
    ds_read_b64_tr_b16 v[72:73], v2 offset:15392
    s_mulk_i32 s40, 5120
    v_mfma_f32_16x16x32_bf16 v[44:47], v[76:79], a[52:55], v[44:47]
    ds_read_b64_tr_b16 v[74:75], v2 offset:17952
    s_waitcnt lgkmcnt(8)
    v_mfma_f32_16x16x32_bf16 v[48:51], v[80:83], a[48:51], v[48:51]
    ds_read_b64_tr_b16 v[76:77], v2 offset:15424
    s_add_u32 s40, s40, s44
    v_mfma_f32_16x16x32_bf16 v[52:55], v[80:83], a[52:55], v[52:55]
    ds_read_b64_tr_b16 v[78:79], v2 offset:17984
    s_waitcnt lgkmcnt(8)
    v_mfma_f32_16x16x32_bf16 v[56:59], v[84:87], a[48:51], v[56:59]
    ds_read_b64_tr_b16 v[80:81], v2 offset:15456
    s_add_u32 s41, s50, 5
    v_mfma_f32_16x16x32_bf16 v[60:63], v[84:87], a[52:55], v[60:63]
    ds_read_b64_tr_b16 v[82:83], v2 offset:18016
    s_waitcnt lgkmcnt(8)
    v_mfma_f32_16x16x32_bf16 v[64:67], v[88:91], a[48:51], v[64:67]
    ds_read_b64_tr_b16 v[84:85], v2 offset:15488
    s_and_b32 s41, s41, 7
    v_mfma_f32_16x16x32_bf16 v[68:71], v[88:91], a[52:55], v[68:71]
    ds_read_b64_tr_b16 v[86:87], v2 offset:18048
    s_waitcnt lgkmcnt(8)
    v_mfma_f32_16x16x32_bf16 v[32:35], v[92:95], a[56:59], v[32:35]
    ds_read_b64_tr_b16 v[88:89], v2 offset:20480
    s_mulk_i32 s41, 5120
    v_mfma_f32_16x16x32_bf16 v[36:39], v[92:95], a[60:63], v[36:39]
    ds_read_b64_tr_b16 v[90:91], v2 offset:23040
    s_waitcnt lgkmcnt(8)
    v_mfma_f32_16x16x32_bf16 v[40:43], v[72:75], a[56:59], v[40:43]
    ds_read_b64_tr_b16 v[92:93], v2 offset:20512
    s_add_u32 s41, s41, s44
    v_mfma_f32_16x16x32_bf16 v[44:47], v[72:75], a[60:63], v[44:47]
    ds_read_b64_tr_b16 v[94:95], v2 offset:23072
    s_waitcnt lgkmcnt(8)
    v_mfma_f32_16x16x32_bf16 v[48:51], v[76:79], a[56:59], v[48:51]
    ds_read_b64_tr_b16 v[72:73], v2 offset:20544
    s_add_u32 s42, s50, 6
    v_mfma_f32_16x16x32_bf16 v[52:55], v[76:79], a[60:63], v[52:55]
    ds_read_b64_tr_b16 v[74:75], v2 offset:23104
    s_waitcnt lgkmcnt(8)
    v_mfma_f32_16x16x32_bf16 v[56:59], v[80:83], a[56:59], v[56:59]
    ds_read_b64_tr_b16 v[76:77], v2 offset:20576
    s_and_b32 s42, s42, 7
    v_mfma_f32_16x16x32_bf16 v[60:63], v[80:83], a[60:63], v[60:63]
    ds_read_b64_tr_b16 v[78:79], v2 offset:23136
    s_waitcnt lgkmcnt(8)
    v_mfma_f32_16x16x32_bf16 v[64:67], v[84:87], a[56:59], v[64:67]
    ds_read_b64_tr_b16 v[80:81], v2 offset:20608
    s_mulk_i32 s42, 5120
    v_mfma_f32_16x16x32_bf16 v[68:71], v[84:87], a[60:63], v[68:71]
    ds_read_b64_tr_b16 v[82:83], v2 offset:23168
    s_waitcnt lgkmcnt(8)
    v_mfma_f32_16x16x32_bf16 v[32:35], v[88:91], a[64:67], v[32:35]
    ds_read_b64_tr_b16 v[84:85], v2 offset:25600
    s_add_u32 s42, s42, s44
    v_mfma_f32_16x16x32_bf16 v[36:39], v[88:91], a[68:71], v[36:39]
    ds_read_b64_tr_b16 v[86:87], v2 offset:28160
    s_waitcnt lgkmcnt(8)
    v_mfma_f32_16x16x32_bf16 v[40:43], v[92:95], a[64:67], v[40:43]
    ds_read_b64_tr_b16 v[88:89], v2 offset:25632
    s_add_u32 s43, s50, 7
    v_mfma_f32_16x16x32_bf16 v[44:47], v[92:95], a[68:71], v[44:47]
    ds_read_b64_tr_b16 v[90:91], v2 offset:28192
    s_waitcnt lgkmcnt(8)
    v_mfma_f32_16x16x32_bf16 v[48:51], v[72:75], a[64:67], v[48:51]
    ds_read_b64_tr_b16 v[92:93], v2 offset:25664
    s_and_b32 s43, s43, 7
    v_mfma_f32_16x16x32_bf16 v[52:55], v[72:75], a[68:71], v[52:55]
    ds_read_b64_tr_b16 v[94:95], v2 offset:28224
    s_waitcnt lgkmcnt(8)
    v_mfma_f32_16x16x32_bf16 v[56:59], v[76:79], a[64:67], v[56:59]
    ds_read_b64_tr_b16 v[72:73], v2 offset:25696
    s_mulk_i32 s43, 5120
    v_mfma_f32_16x16x32_bf16 v[60:63], v[76:79], a[68:71], v[60:63]
    ds_read_b64_tr_b16 v[74:75], v2 offset:28256
    s_waitcnt lgkmcnt(8)
    v_mfma_f32_16x16x32_bf16 v[64:67], v[80:83], a[64:67], v[64:67]
    ds_read_b64_tr_b16 v[76:77], v2 offset:25728
    s_add_u32 s43, s43, s44
    v_mfma_f32_16x16x32_bf16 v[68:71], v[80:83], a[68:71], v[68:71]
    ds_read_b64_tr_b16 v[78:79], v2 offset:28288
    s_waitcnt lgkmcnt(8)
    v_mfma_f32_16x16x32_bf16 v[32:35], v[84:87], a[72:75], v[32:35]
    ds_read_b64_tr_b16 v[80:81], v2 offset:30720
    s_lshl2_add_u32 s58, s52, s51
    v_mfma_f32_16x16x32_bf16 v[36:39], v[84:87], a[76:79], v[36:39]
    ds_read_b64_tr_b16 v[82:83], v2 offset:33280
    s_waitcnt lgkmcnt(8)
    v_mfma_f32_16x16x32_bf16 v[40:43], v[88:91], a[72:75], v[40:43]
    ds_read_b64_tr_b16 v[84:85], v2 offset:30752
    s_lshl_b32 s58, s58, 6
    v_mfma_f32_16x16x32_bf16 v[44:47], v[88:91], a[76:79], v[44:47]
    ds_read_b64_tr_b16 v[86:87], v2 offset:33312
    s_waitcnt lgkmcnt(8)
    v_mfma_f32_16x16x32_bf16 v[48:51], v[92:95], a[72:75], v[48:51]
    ds_read_b64_tr_b16 v[88:89], v2 offset:30784
    s_add_u32 s69, s58, s68
    v_mfma_f32_16x16x32_bf16 v[52:55], v[92:95], a[76:79], v[52:55]
    ds_read_b64_tr_b16 v[90:91], v2 offset:33344
    s_waitcnt lgkmcnt(8)
    v_mfma_f32_16x16x32_bf16 v[56:59], v[72:75], a[72:75], v[56:59]
    ds_read_b64_tr_b16 v[92:93], v2 offset:30816
    s_lshl3_add_u32 s58, s50, s69
    v_mfma_f32_16x16x32_bf16 v[60:63], v[72:75], a[76:79], v[60:63]
    ds_read_b64_tr_b16 v[94:95], v2 offset:33376
    s_waitcnt lgkmcnt(8)
    v_mfma_f32_16x16x32_bf16 v[64:67], v[76:79], a[72:75], v[64:67]
    ds_read_b64_tr_b16 v[72:73], v2 offset:30848
    v_mfma_f32_16x16x32_bf16 v[68:71], v[76:79], a[76:79], v[68:71]
    ds_read_b64_tr_b16 v[74:75], v2 offset:33408
    s_waitcnt lgkmcnt(8)
    v_mfma_f32_16x16x32_bf16 v[32:35], v[80:83], a[80:83], v[32:35]
    ds_read_b64_tr_b16 v[76:77], v2 offset:35840
    v_mfma_f32_16x16x32_bf16 v[36:39], v[80:83], a[84:87], v[36:39]
    ds_read_b64_tr_b16 v[78:79], v2 offset:38400
    s_waitcnt lgkmcnt(8)
    v_mfma_f32_16x16x32_bf16 v[40:43], v[84:87], a[80:83], v[40:43]
    ds_read_b64_tr_b16 v[80:81], v2 offset:35872
    v_mfma_f32_16x16x32_bf16 v[44:47], v[84:87], a[84:87], v[44:47]
    ds_read_b64_tr_b16 v[82:83], v2 offset:38432
    s_waitcnt lgkmcnt(8)
    v_mfma_f32_16x16x32_bf16 v[48:51], v[88:91], a[80:83], v[48:51]
    ds_read_b64_tr_b16 v[84:85], v2 offset:35904
    v_mfma_f32_16x16x32_bf16 v[52:55], v[88:91], a[84:87], v[52:55]
    ds_read_b64_tr_b16 v[86:87], v2 offset:38464
    s_waitcnt lgkmcnt(8)
    v_mfma_f32_16x16x32_bf16 v[56:59], v[92:95], a[80:83], v[56:59]
    ds_read_b64_tr_b16 v[88:89], v2 offset:35936
    v_mfma_f32_16x16x32_bf16 v[60:63], v[92:95], a[84:87], v[60:63]
    ds_read_b64_tr_b16 v[90:91], v2 offset:38496
    s_waitcnt lgkmcnt(8)
    v_mfma_f32_16x16x32_bf16 v[64:67], v[72:75], a[80:83], v[64:67]
    ds_read_b64_tr_b16 v[92:93], v2 offset:35968
    v_mfma_f32_16x16x32_bf16 v[68:71], v[72:75], a[84:87], v[68:71]
    ds_read_b64_tr_b16 v[94:95], v2 offset:38528
    s_waitcnt lgkmcnt(8)
    v_mfma_f32_16x16x32_bf16 v[32:35], v[76:79], a[88:91], v[32:35]
    ds_read_b64_tr_b16 v[72:73], v2 offset:40960
    v_mfma_f32_16x16x32_bf16 v[36:39], v[76:79], a[92:95], v[36:39]
    ds_read_b64_tr_b16 v[74:75], v2 offset:43520
    s_waitcnt lgkmcnt(8)
    v_mfma_f32_16x16x32_bf16 v[40:43], v[80:83], a[88:91], v[40:43]
    ds_read_b64_tr_b16 v[76:77], v2 offset:40992
    v_mfma_f32_16x16x32_bf16 v[44:47], v[80:83], a[92:95], v[44:47]
    ds_read_b64_tr_b16 v[78:79], v2 offset:43552
    s_waitcnt lgkmcnt(8)
    v_mfma_f32_16x16x32_bf16 v[48:51], v[84:87], a[88:91], v[48:51]
    ds_read_b64_tr_b16 v[80:81], v2 offset:41024
    v_mfma_f32_16x16x32_bf16 v[52:55], v[84:87], a[92:95], v[52:55]
    ds_read_b64_tr_b16 v[82:83], v2 offset:43584
    s_waitcnt lgkmcnt(8)
    v_mfma_f32_16x16x32_bf16 v[56:59], v[88:91], a[88:91], v[56:59]
    ds_read_b64_tr_b16 v[84:85], v2 offset:41056
    v_mfma_f32_16x16x32_bf16 v[60:63], v[88:91], a[92:95], v[60:63]
    ds_read_b64_tr_b16 v[86:87], v2 offset:43616
    s_waitcnt lgkmcnt(8)
    v_mfma_f32_16x16x32_bf16 v[64:67], v[92:95], a[88:91], v[64:67]
    ds_read_b64_tr_b16 v[88:89], v2 offset:41088
    v_mfma_f32_16x16x32_bf16 v[68:71], v[92:95], a[92:95], v[68:71]
    ds_read_b64_tr_b16 v[90:91], v2 offset:43648
    s_waitcnt lgkmcnt(8)
    v_mfma_f32_16x16x32_bf16 v[32:35], v[72:75], a[96:99], v[32:35]
    ds_read_b64_tr_b16 v[92:93], v2 offset:46080
    v_mfma_f32_16x16x32_bf16 v[36:39], v[72:75], a[100:103], v[36:39]
    ds_read_b64_tr_b16 v[94:95], v2 offset:48640
    s_waitcnt lgkmcnt(8)
    v_mfma_f32_16x16x32_bf16 v[40:43], v[76:79], a[96:99], v[40:43]
    ds_read_b64_tr_b16 v[72:73], v2 offset:46112
    v_mfma_f32_16x16x32_bf16 v[44:47], v[76:79], a[100:103], v[44:47]
    ds_read_b64_tr_b16 v[74:75], v2 offset:48672
    s_waitcnt lgkmcnt(8)
    v_mfma_f32_16x16x32_bf16 v[48:51], v[80:83], a[96:99], v[48:51]
    ds_read_b64_tr_b16 v[76:77], v2 offset:46144
    v_mfma_f32_16x16x32_bf16 v[52:55], v[80:83], a[100:103], v[52:55]
    ds_read_b64_tr_b16 v[78:79], v2 offset:48704
    s_waitcnt lgkmcnt(8)
    v_mfma_f32_16x16x32_bf16 v[56:59], v[84:87], a[96:99], v[56:59]
    ds_read_b64_tr_b16 v[80:81], v2 offset:46176
    v_mfma_f32_16x16x32_bf16 v[60:63], v[84:87], a[100:103], v[60:63]
    ds_read_b64_tr_b16 v[82:83], v2 offset:48736
    s_waitcnt lgkmcnt(8)
    v_mfma_f32_16x16x32_bf16 v[64:67], v[88:91], a[96:99], v[64:67]
    ds_read_b64_tr_b16 v[84:85], v2 offset:46208
    v_mfma_f32_16x16x32_bf16 v[68:71], v[88:91], a[100:103], v[68:71]
    ds_read_b64_tr_b16 v[86:87], v2 offset:48768
    s_waitcnt lgkmcnt(8)
    v_mfma_f32_16x16x32_bf16 v[32:35], v[92:95], a[104:107], v[32:35]
    ds_read_b64_tr_b16 v[88:89], v2 offset:51200
    v_mfma_f32_16x16x32_bf16 v[36:39], v[92:95], a[108:111], v[36:39]
    ds_read_b64_tr_b16 v[90:91], v2 offset:53760
    s_waitcnt lgkmcnt(8)
    v_mfma_f32_16x16x32_bf16 v[40:43], v[72:75], a[104:107], v[40:43]
    ds_read_b64_tr_b16 v[92:93], v2 offset:51232
    v_mfma_f32_16x16x32_bf16 v[44:47], v[72:75], a[108:111], v[44:47]
    ds_read_b64_tr_b16 v[94:95], v2 offset:53792
    s_waitcnt lgkmcnt(8)
    v_mfma_f32_16x16x32_bf16 v[48:51], v[76:79], a[104:107], v[48:51]
    ds_read_b64_tr_b16 v[72:73], v2 offset:51264
    v_mfma_f32_16x16x32_bf16 v[52:55], v[76:79], a[108:111], v[52:55]
    ds_read_b64_tr_b16 v[74:75], v2 offset:53824
    s_waitcnt lgkmcnt(8)
    v_mfma_f32_16x16x32_bf16 v[56:59], v[80:83], a[104:107], v[56:59]
    ds_read_b64_tr_b16 v[76:77], v2 offset:51296
    v_mfma_f32_16x16x32_bf16 v[60:63], v[80:83], a[108:111], v[60:63]
    ds_read_b64_tr_b16 v[78:79], v2 offset:53856
    s_waitcnt lgkmcnt(8)
    v_mfma_f32_16x16x32_bf16 v[64:67], v[84:87], a[104:107], v[64:67]
    ds_read_b64_tr_b16 v[80:81], v2 offset:51328
    v_mfma_f32_16x16x32_bf16 v[68:71], v[84:87], a[108:111], v[68:71]
    ds_read_b64_tr_b16 v[82:83], v2 offset:53888
    s_waitcnt lgkmcnt(8)
    v_mfma_f32_16x16x32_bf16 v[32:35], v[88:91], a[112:115], v[32:35]
    ds_read_b64_tr_b16 v[84:85], v2 offset:56320
    v_mfma_f32_16x16x32_bf16 v[36:39], v[88:91], a[116:119], v[36:39]
    ds_read_b64_tr_b16 v[86:87], v2 offset:58880
    s_waitcnt lgkmcnt(8)
    v_mfma_f32_16x16x32_bf16 v[40:43], v[92:95], a[112:115], v[40:43]
    ds_read_b64_tr_b16 v[88:89], v2 offset:56352
    v_mfma_f32_16x16x32_bf16 v[44:47], v[92:95], a[116:119], v[44:47]
    ds_read_b64_tr_b16 v[90:91], v2 offset:58912
    s_waitcnt lgkmcnt(8)
    v_mfma_f32_16x16x32_bf16 v[48:51], v[72:75], a[112:115], v[48:51]
    ds_read_b64_tr_b16 v[92:93], v2 offset:56384
    v_mfma_f32_16x16x32_bf16 v[52:55], v[72:75], a[116:119], v[52:55]
    ds_read_b64_tr_b16 v[94:95], v2 offset:58944
    s_waitcnt lgkmcnt(8)
    v_mfma_f32_16x16x32_bf16 v[56:59], v[76:79], a[112:115], v[56:59]
    ds_read_b64_tr_b16 v[72:73], v2 offset:56416
    v_mfma_f32_16x16x32_bf16 v[60:63], v[76:79], a[116:119], v[60:63]
    ds_read_b64_tr_b16 v[74:75], v2 offset:58976
    s_waitcnt lgkmcnt(8)
    v_mfma_f32_16x16x32_bf16 v[64:67], v[80:83], a[112:115], v[64:67]
    ds_read_b64_tr_b16 v[76:77], v2 offset:56448
    v_mfma_f32_16x16x32_bf16 v[68:71], v[80:83], a[116:119], v[68:71]
    ds_read_b64_tr_b16 v[78:79], v2 offset:59008
    s_barrier
    s_waitcnt lgkmcnt(8)
    v_mfma_f32_16x16x32_bf16 v[32:35], v[84:87], a[120:123], v[32:35]
    ds_read_b64_tr_b16 v[80:81], v3 offset:57344
    v_mfma_f32_16x16x32_bf16 v[36:39], v[84:87], a[124:127], v[36:39]
    ds_read_b64_tr_b16 v[82:83], v3 offset:59904
    s_waitcnt lgkmcnt(8)
    v_mfma_f32_16x16x32_bf16 v[40:43], v[88:91], a[120:123], v[40:43]
    ds_read_b64_tr_b16 v[84:85], v3 offset:57376
    v_mfma_f32_16x16x32_bf16 v[44:47], v[88:91], a[124:127], v[44:47]
    ds_read_b64_tr_b16 v[86:87], v3 offset:59936
    s_waitcnt lgkmcnt(8)
    v_mfma_f32_16x16x32_bf16 v[48:51], v[92:95], a[120:123], v[48:51]
    ds_read_b64_tr_b16 v[88:89], v3 offset:57408
    v_mfma_f32_16x16x32_bf16 v[52:55], v[92:95], a[124:127], v[52:55]
    ds_read_b64_tr_b16 v[90:91], v3 offset:59968
    s_waitcnt lgkmcnt(8)
    v_mfma_f32_16x16x32_bf16 v[56:59], v[72:75], a[120:123], v[56:59]
    ds_read_b64_tr_b16 v[92:93], v3 offset:57440
    v_mfma_f32_16x16x32_bf16 v[60:63], v[72:75], a[124:127], v[60:63]
    ds_read_b64_tr_b16 v[94:95], v3 offset:60000
    s_waitcnt lgkmcnt(8)
    v_mfma_f32_16x16x32_bf16 v[64:67], v[76:79], a[120:123], v[64:67]
    ds_read_b64_tr_b16 v[72:73], v3 offset:57472
    v_mfma_f32_16x16x32_bf16 v[68:71], v[76:79], a[124:127], v[68:71]
    ds_read_b64_tr_b16 v[74:75], v3 offset:60032
    s_waitcnt lgkmcnt(8)
    v_mfma_f32_16x16x32_bf16 v[32:35], v[80:83], v[96:99], v[32:35]
    ds_read_b64_tr_b16 v[76:77], v3 offset:62464
    v_mfma_f32_16x16x32_bf16 v[36:39], v[80:83], v[100:103], v[36:39]
    ds_read_b64_tr_b16 v[78:79], v3 offset:65024
    s_waitcnt lgkmcnt(8)
    v_mfma_f32_16x16x32_bf16 v[40:43], v[84:87], v[96:99], v[40:43]
    ds_read_b64_tr_b16 v[80:81], v3 offset:62496
    v_mfma_f32_16x16x32_bf16 v[44:47], v[84:87], v[100:103], v[44:47]
    ds_read_b64_tr_b16 v[82:83], v3 offset:65056
    s_waitcnt lgkmcnt(8)
    v_mfma_f32_16x16x32_bf16 v[48:51], v[88:91], v[96:99], v[48:51]
    ds_read_b64_tr_b16 v[84:85], v3 offset:62528
    v_mfma_f32_16x16x32_bf16 v[52:55], v[88:91], v[100:103], v[52:55]
    ds_read_b64_tr_b16 v[86:87], v3 offset:65088
    s_waitcnt lgkmcnt(8)
    v_mfma_f32_16x16x32_bf16 v[56:59], v[92:95], v[96:99], v[56:59]
    ds_read_b64_tr_b16 v[88:89], v3 offset:62560
    v_mfma_f32_16x16x32_bf16 v[60:63], v[92:95], v[100:103], v[60:63]
    ds_read_b64_tr_b16 v[90:91], v3 offset:65120
    s_waitcnt lgkmcnt(8)
    v_mfma_f32_16x16x32_bf16 v[64:67], v[72:75], v[96:99], v[64:67]
    ds_read_b64_tr_b16 v[92:93], v3 offset:62592
    v_mfma_f32_16x16x32_bf16 v[68:71], v[72:75], v[100:103], v[68:71]
    ds_read_b64_tr_b16 v[94:95], v3 offset:65152
    s_waitcnt lgkmcnt(8)
    v_mfma_f32_16x16x32_bf16 v[32:35], v[76:79], v[104:107], v[32:35]
    ds_read_b64_tr_b16 v[72:73], v4 offset:2048
    v_mfma_f32_16x16x32_bf16 v[36:39], v[76:79], v[108:111], v[36:39]
    ds_read_b64_tr_b16 v[74:75], v4 offset:4608
    s_waitcnt lgkmcnt(8)
    v_mfma_f32_16x16x32_bf16 v[40:43], v[80:83], v[104:107], v[40:43]
    ds_read_b64_tr_b16 v[76:77], v4 offset:2080
    v_mfma_f32_16x16x32_bf16 v[44:47], v[80:83], v[108:111], v[44:47]
    ds_read_b64_tr_b16 v[78:79], v4 offset:4640
    s_waitcnt lgkmcnt(8)
    v_mfma_f32_16x16x32_bf16 v[48:51], v[84:87], v[104:107], v[48:51]
    ds_read_b64_tr_b16 v[80:81], v4 offset:2112
    v_mfma_f32_16x16x32_bf16 v[52:55], v[84:87], v[108:111], v[52:55]
    ds_read_b64_tr_b16 v[82:83], v4 offset:4672
    s_waitcnt lgkmcnt(8)
    v_mfma_f32_16x16x32_bf16 v[56:59], v[88:91], v[104:107], v[56:59]
    ds_read_b64_tr_b16 v[84:85], v4 offset:2144
    v_mfma_f32_16x16x32_bf16 v[60:63], v[88:91], v[108:111], v[60:63]
    ds_read_b64_tr_b16 v[86:87], v4 offset:4704
    s_waitcnt lgkmcnt(8)
    v_mfma_f32_16x16x32_bf16 v[64:67], v[92:95], v[104:107], v[64:67]
    ds_read_b64_tr_b16 v[88:89], v4 offset:2176
    v_mfma_f32_16x16x32_bf16 v[68:71], v[92:95], v[108:111], v[68:71]
    ds_read_b64_tr_b16 v[90:91], v4 offset:4736
    s_waitcnt lgkmcnt(8)
    v_mfma_f32_16x16x32_bf16 v[32:35], v[72:75], v[112:115], v[32:35]
    ds_read_b64_tr_b16 v[92:93], v4 offset:7168
    v_mfma_f32_16x16x32_bf16 v[36:39], v[72:75], v[116:119], v[36:39]
    ds_read_b64_tr_b16 v[94:95], v4 offset:9728
    s_waitcnt lgkmcnt(8)
    v_mfma_f32_16x16x32_bf16 v[40:43], v[76:79], v[112:115], v[40:43]
    ds_read_b64_tr_b16 v[72:73], v4 offset:7200
    v_mfma_f32_16x16x32_bf16 v[44:47], v[76:79], v[116:119], v[44:47]
    ds_read_b64_tr_b16 v[74:75], v4 offset:9760
    s_waitcnt lgkmcnt(8)
    v_mfma_f32_16x16x32_bf16 v[48:51], v[80:83], v[112:115], v[48:51]
    ds_read_b64_tr_b16 v[76:77], v4 offset:7232
    v_mfma_f32_16x16x32_bf16 v[52:55], v[80:83], v[116:119], v[52:55]
    ds_read_b64_tr_b16 v[78:79], v4 offset:9792
    s_waitcnt lgkmcnt(8)
    v_mfma_f32_16x16x32_bf16 v[56:59], v[84:87], v[112:115], v[56:59]
    ds_read_b64_tr_b16 v[80:81], v4 offset:7264
    v_mfma_f32_16x16x32_bf16 v[60:63], v[84:87], v[116:119], v[60:63]
    ds_read_b64_tr_b16 v[82:83], v4 offset:9824
    s_waitcnt lgkmcnt(8)
    v_mfma_f32_16x16x32_bf16 v[64:67], v[88:91], v[112:115], v[64:67]
    ds_read_b64_tr_b16 v[84:85], v4 offset:7296
    v_mfma_f32_16x16x32_bf16 v[68:71], v[88:91], v[116:119], v[68:71]
    ds_read_b64_tr_b16 v[86:87], v4 offset:9856
    s_waitcnt lgkmcnt(8)
    v_mfma_f32_16x16x32_bf16 v[32:35], v[92:95], v[120:123], v[32:35]
    v_mfma_f32_16x16x32_bf16 v[36:39], v[92:95], v[124:127], v[36:39]
    s_waitcnt lgkmcnt(6)
    v_mfma_f32_16x16x32_bf16 v[40:43], v[72:75], v[120:123], v[40:43]
    v_mfma_f32_16x16x32_bf16 v[44:47], v[72:75], v[124:127], v[44:47]
    s_waitcnt lgkmcnt(4)
    v_mfma_f32_16x16x32_bf16 v[48:51], v[76:79], v[120:123], v[48:51]
    s_nop 1
    v_cvt_pk_bf16_f32 v32, v32, v33
    v_cvt_pk_bf16_f32 v33, v34, v35
    ds_write_b64 v22, v[32:33] offset:0
    v_mfma_f32_16x16x32_bf16 v[52:55], v[76:79], v[124:127], v[52:55]
    v_cvt_pk_bf16_f32 v36, v36, v37
    v_cvt_pk_bf16_f32 v37, v38, v39
    ds_write_b64 v22, v[36:37] offset:640
    s_waitcnt lgkmcnt(4)
    v_mfma_f32_16x16x32_bf16 v[56:59], v[80:83], v[120:123], v[56:59]
    v_cvt_pk_bf16_f32 v40, v40, v41
    v_cvt_pk_bf16_f32 v41, v42, v43
    ds_write_b64 v23, v[40:41] offset:0
    v_mfma_f32_16x16x32_bf16 v[60:63], v[80:83], v[124:127], v[60:63]
    v_cvt_pk_bf16_f32 v44, v44, v45
    v_cvt_pk_bf16_f32 v45, v46, v47
    ds_write_b64 v23, v[44:45] offset:640
    s_waitcnt lgkmcnt(4)
    v_mfma_f32_16x16x32_bf16 v[64:67], v[84:87], v[120:123], v[64:67]
    v_cvt_pk_bf16_f32 v48, v48, v49
    v_cvt_pk_bf16_f32 v49, v50, v51
    ds_write_b64 v24, v[48:49] offset:0
    v_mfma_f32_16x16x32_bf16 v[68:71], v[84:87], v[124:127], v[68:71]
    v_cvt_pk_bf16_f32 v52, v52, v53
    v_cvt_pk_bf16_f32 v53, v54, v55
    ds_write_b64 v24, v[52:53] offset:640
    v_cvt_pk_bf16_f32 v56, v56, v57
    v_cvt_pk_bf16_f32 v57, v58, v59
    ds_write_b64 v25, v[56:57] offset:0
    v_cvt_pk_bf16_f32 v60, v60, v61
    v_cvt_pk_bf16_f32 v61, v62, v63
    ds_write_b64 v25, v[60:61] offset:640
    v_cvt_pk_bf16_f32 v64, v64, v65
    v_cvt_pk_bf16_f32 v65, v66, v67
    ds_write_b64 v26, v[64:65] offset:0
    v_cvt_pk_bf16_f32 v68, v68, v69
    v_cvt_pk_bf16_f32 v69, v70, v71
    ds_write_b64 v26, v[68:69] offset:640
    v_and_b32 v126, 31, v1
    v_lshlrev_b32 v126, 2, v126
    buffer_load_dword v124, v126, s[32:35], s68 offen offset:512 sc1
    ds_read_b64 v[72:73], v8 offset:0
    ds_read_b64 v[74:75], v8 offset:512
    ds_read_b64 v[76:77], v8 offset:1024
    ds_read_b64 v[78:79], v5 offset:0
    ds_read_b64 v[80:81], v5 offset:8
    ds_read_b64 v[82:83], v6 offset:0
    ds_read_b64 v[84:85], v8 offset:1536
    ds_read_b64 v[86:87], v8 offset:2048
    ds_read_b64 v[88:89], v8 offset:2560
    ds_read_b64 v[90:91], v5 offset:5120
    ds_read_b64 v[92:93], v5 offset:5128
    ds_read_b64 v[94:95], v6 offset:5120
    v_and_b32 v117, 15, v1
    v_lshlrev_b32 v117, 2, v117
    v_and_b32 v119, 56, v117
    s_waitcnt lgkmcnt(7)
    v_mfma_f32_32x32x16_bf16 v[32:47], v[72:75], v[78:81], 0
    s_barrier
    s_waitcnt lgkmcnt(6)
    v_mfma_f32_32x32x8_bf16 v[32:47], v[76:77], v[82:83], v[32:47]
    s_waitcnt lgkmcnt(1)
    v_mfma_f32_32x32x16_bf16 v[48:63], v[84:87], v[90:93], 0
    s_waitcnt lgkmcnt(0)
    v_mfma_f32_32x32x8_bf16 v[48:63], v[88:89], v[94:95], v[48:63]
    s_nop 7
    v_exp_f32 v72, v32
    v_exp_f32_e64 v32, -v32
    v_exp_f32 v73, v33
    v_exp_f32_e64 v33, -v33
    v_exp_f32 v74, v34
    v_exp_f32_e64 v34, -v34
    v_exp_f32 v75, v35
    v_exp_f32_e64 v35, -v35
    v_exp_f32 v76, v36
    v_exp_f32_e64 v36, -v36
    v_exp_f32 v77, v37
    v_exp_f32_e64 v37, -v37
    v_exp_f32 v78, v38
    v_exp_f32_e64 v38, -v38
    v_exp_f32 v79, v39
    v_exp_f32_e64 v39, -v39
    v_exp_f32 v80, v40
    v_exp_f32_e64 v40, -v40
    v_exp_f32 v81, v41
    v_exp_f32_e64 v41, -v41
    v_pk_add_f32 v[42:43], v[72:73], v[74:75]
    v_pk_add_f32 v[44:45], v[32:33], v[34:35]
    v_pk_add_f32 v[42:43], v[42:43], v[76:77]
    v_pk_add_f32 v[44:45], v[44:45], v[36:37]
    v_pk_add_f32 v[42:43], v[42:43], v[78:79]
    v_pk_add_f32 v[44:45], v[44:45], v[38:39]
    v_pk_add_f32 v[42:43], v[42:43], v[80:81]
    v_pk_add_f32 v[44:45], v[44:45], v[40:41]
    v_add_f32 v42, v42, v43
    v_add_f32 v44, v44, v45
    s_nop 1
    v_permlane32_swap_b32 v42, v44
    v_add_f32 v42, v42, v44
    v_cmp_ngt_f32 vcc, 0x56800000, v42
    v_rcp_f32 v42, v42
    s_cbranch_vccnz L_q0Ab_max
L_q0Ab_sum:
    v_mov_b32 v44, v42
    s_nop 1
    v_permlane32_swap_b32 v42, v44
    v_pk_mul_f32 v[72:73], v[72:73], v[42:43] op_sel_hi:[1,0]
    v_pk_mul_f32 v[32:33], v[32:33], v[44:45] op_sel_hi:[1,0]
    v_pk_mul_f32 v[74:75], v[74:75], v[42:43] op_sel_hi:[1,0]
    v_pk_mul_f32 v[34:35], v[34:35], v[44:45] op_sel_hi:[1,0]
    v_pk_mul_f32 v[76:77], v[76:77], v[42:43] op_sel_hi:[1,0]
    v_pk_mul_f32 v[36:37], v[36:37], v[44:45] op_sel_hi:[1,0]
    v_pk_mul_f32 v[78:79], v[78:79], v[42:43] op_sel_hi:[1,0]
    v_pk_mul_f32 v[38:39], v[38:39], v[44:45] op_sel_hi:[1,0]
    v_pk_mul_f32 v[80:81], v[80:81], v[42:43] op_sel_hi:[1,0]
    v_pk_mul_f32 v[40:41], v[40:41], v[44:45] op_sel_hi:[1,0]
    v_cvt_pk_bf16_f32 v72, v72, v73
    v_cvt_pk_bf16_f32 v73, v74, v75
    v_cvt_pk_bf16_f32 v74, v76, v77
    v_cvt_pk_bf16_f32 v75, v78, v79
    v_cvt_pk_bf16_f32 v76, v80, v81
    v_cvt_pk_bf16_f32 v77, v32, v33
    v_cvt_pk_bf16_f32 v78, v34, v35
    v_cvt_pk_bf16_f32 v79, v36, v37
    v_cvt_pk_bf16_f32 v80, v38, v39
    v_cvt_pk_bf16_f32 v81, v40, v41
    v_exp_f32 v84, v48
    v_exp_f32_e64 v48, -v48
    v_exp_f32 v85, v49
    v_exp_f32_e64 v49, -v49
    v_exp_f32 v86, v50
    v_exp_f32_e64 v50, -v50
    v_exp_f32 v87, v51
    v_exp_f32_e64 v51, -v51
    v_exp_f32 v88, v52
    v_exp_f32_e64 v52, -v52
    v_exp_f32 v89, v53
    v_exp_f32_e64 v53, -v53
    v_exp_f32 v90, v54
    v_exp_f32_e64 v54, -v54
    v_exp_f32 v91, v55
    v_exp_f32_e64 v55, -v55
    v_exp_f32 v92, v56
    v_exp_f32_e64 v56, -v56
    v_exp_f32 v93, v57
    v_exp_f32_e64 v57, -v57
    v_pk_add_f32 v[58:59], v[84:85], v[86:87]
    v_pk_add_f32 v[60:61], v[48:49], v[50:51]
    v_pk_add_f32 v[58:59], v[58:59], v[88:89]
    v_pk_add_f32 v[60:61], v[60:61], v[52:53]
    v_pk_add_f32 v[58:59], v[58:59], v[90:91]
    v_pk_add_f32 v[60:61], v[60:61], v[54:55]
    v_pk_add_f32 v[58:59], v[58:59], v[92:93]
    v_pk_add_f32 v[60:61], v[60:61], v[56:57]
    v_add_f32 v58, v58, v59
    v_add_f32 v60, v60, v61
    s_nop 1
    v_permlane32_swap_b32 v58, v60
    v_add_f32 v58, v58, v60
    v_cmp_ngt_f32 vcc, 0x56800000, v58
    v_rcp_f32 v58, v58
    s_cbranch_vccnz L_q1Ab_max
L_q1Ab_sum:
    v_mov_b32 v60, v58
    s_nop 1
    v_permlane32_swap_b32 v58, v60
    v_pk_mul_f32 v[84:85], v[84:85], v[58:59] op_sel_hi:[1,0]
    v_pk_mul_f32 v[48:49], v[48:49], v[60:61] op_sel_hi:[1,0]
    v_pk_mul_f32 v[86:87], v[86:87], v[58:59] op_sel_hi:[1,0]
    v_pk_mul_f32 v[50:51], v[50:51], v[60:61] op_sel_hi:[1,0]
    v_pk_mul_f32 v[88:89], v[88:89], v[58:59] op_sel_hi:[1,0]
    v_pk_mul_f32 v[52:53], v[52:53], v[60:61] op_sel_hi:[1,0]
    v_pk_mul_f32 v[90:91], v[90:91], v[58:59] op_sel_hi:[1,0]
    v_pk_mul_f32 v[54:55], v[54:55], v[60:61] op_sel_hi:[1,0]
    v_pk_mul_f32 v[92:93], v[92:93], v[58:59] op_sel_hi:[1,0]
    v_pk_mul_f32 v[56:57], v[56:57], v[60:61] op_sel_hi:[1,0]
    v_cvt_pk_bf16_f32 v84, v84, v85
    v_cvt_pk_bf16_f32 v85, v86, v87
    v_cvt_pk_bf16_f32 v86, v88, v89
    v_cvt_pk_bf16_f32 v87, v90, v91
    v_cvt_pk_bf16_f32 v88, v92, v93
    v_cvt_pk_bf16_f32 v89, v48, v49
    v_cvt_pk_bf16_f32 v90, v50, v51
    v_cvt_pk_bf16_f32 v91, v52, v53
    v_cvt_pk_bf16_f32 v92, v54, v55
    v_cvt_pk_bf16_f32 v93, v56, v57
    s_getreg_b32 s57, hwreg(HW_REG_XCC_ID)
    s_and_b32 s57, s57, 15
    s_add_u32 s57, s57, 1
    s_mov_b32 s61, 0
    s_waitcnt vmcnt(0)
    v_cmp_ne_u32 vcc, s57, v124
    s_cbranch_vccnz L_hsAb_slow
L_hsAb_ok:
    s_barrier
    s_setprio 1
    ds_read_b128 v[96:99], v9 offset:0
    ds_read_b128 v[100:103], v10 offset:0
    ds_read_b64 v[104:105], v11 offset:0
    ds_read_b128 v[106:109], v9 offset:1792
    ds_read_b128 v[110:113], v10 offset:1792
    ds_read_b64 v[114:115], v11 offset:1792
    s_waitcnt lgkmcnt(5)
    v_mfma_f32_32x32x16_bf16 v[32:47], v[96:99], v[72:75], 0
    s_waitcnt lgkmcnt(4)
    v_mfma_f32_32x32x16_bf16 v[32:47], v[100:103], v[76:79], v[32:47]
    s_waitcnt lgkmcnt(3)
    v_mfma_f32_32x32x8_bf16 v[32:47], v[104:105], v[80:81], v[32:47]
    s_waitcnt lgkmcnt(2)
    v_mfma_f32_32x32x16_bf16 v[48:63], v[106:109], v[84:87], 0
    s_waitcnt lgkmcnt(1)
    v_mfma_f32_32x32x16_bf16 v[48:63], v[110:113], v[88:91], v[48:63]
    s_waitcnt lgkmcnt(0)
    v_mfma_f32_32x32x8_bf16 v[48:63], v[114:115], v[92:93], v[48:63]
    s_nop 5
    v_add_f32 v44, 0x358637bd, v44
    v_rcp_f32 v44, v44
    s_nop 0
    v_pk_mul_f32 v[32:33], v[32:33], v[44:45] op_sel_hi:[1,0]
    v_pk_mul_f32 v[34:35], v[34:35], v[44:45] op_sel_hi:[1,0]
    v_pk_mul_f32 v[36:37], v[36:37], v[44:45] op_sel_hi:[1,0]
    v_pk_mul_f32 v[38:39], v[38:39], v[44:45] op_sel_hi:[1,0]
    v_pk_mul_f32 v[40:41], v[40:41], v[44:45] op_sel_hi:[1,0]
    v_pk_mul_f32 v[42:43], v[42:43], v[44:45] op_sel_hi:[1,0]
    v_cvt_pk_bf16_f32 v64, v32, v33
    v_cvt_pk_bf16_f32 v65, v34, v35
    v_cvt_pk_bf16_f32 v66, v36, v37
    v_cvt_pk_bf16_f32 v67, v38, v39
    v_cvt_pk_bf16_f32 v120, v40, v41
    v_cvt_pk_bf16_f32 v121, v42, v43
    v_add_f32 v60, 0x358637bd, v60
    v_rcp_f32 v60, v60
    s_nop 0
    v_pk_mul_f32 v[48:49], v[48:49], v[60:61] op_sel_hi:[1,0]
    v_pk_mul_f32 v[50:51], v[50:51], v[60:61] op_sel_hi:[1,0]
    v_pk_mul_f32 v[52:53], v[52:53], v[60:61] op_sel_hi:[1,0]
    v_pk_mul_f32 v[54:55], v[54:55], v[60:61] op_sel_hi:[1,0]
    v_pk_mul_f32 v[56:57], v[56:57], v[60:61] op_sel_hi:[1,0]
    v_pk_mul_f32 v[58:59], v[58:59], v[60:61] op_sel_hi:[1,0]
    v_cvt_pk_bf16_f32 v68, v48, v49
    v_cvt_pk_bf16_f32 v69, v50, v51
    v_cvt_pk_bf16_f32 v70, v52, v53
    v_cvt_pk_bf16_f32 v71, v54, v55
    v_permlane16_swap_b32 v64, v68
    v_permlane16_swap_b32 v65, v69
    v_permlane16_swap_b32 v66, v70
    v_permlane16_swap_b32 v67, v71
    v_cvt_pk_bf16_f32 v122, v56, v57
    v_cvt_pk_bf16_f32 v123, v58, v59
    s_cmp_eq_u32 s61, 0
    s_cbranch_scc0 L_o1Ab_far
    buffer_store_dwordx4 v[64:67], v7, s[36:39], s62 offen
    buffer_store_dwordx4 v[68:71], v15, s[36:39], s62 offen
    buffer_store_dwordx4 v[120:123], v13, s[36:39], s62 offen offset:1024
L_o1Ab_st:
    v_accvgpr_write_b32 a0, v64
    v_accvgpr_write_b32 a1, v65
    v_accvgpr_write_b32 a2, v66
    v_accvgpr_write_b32 a3, v67
    v_accvgpr_write_b32 a4, v68
    v_accvgpr_write_b32 a5, v69
    v_accvgpr_write_b32 a6, v70
    v_accvgpr_write_b32 a7, v71
    ds_read_b64_tr_b16 a[80:81], v2 offset:61440
    ds_read_b64_tr_b16 a[82:83], v2 offset:64000
    ds_read_b64_tr_b16 a[84:85], v2 offset:61472
    ds_read_b64_tr_b16 a[86:87], v2 offset:64032
    ds_read_b64_tr_b16 a[88:89], v2 offset:61504
    ds_read_b64_tr_b16 a[90:91], v2 offset:64064
    ds_read_b64_tr_b16 a[92:93], v2 offset:61536
    ds_read_b64_tr_b16 a[94:95], v2 offset:64096
    ds_read_b64_tr_b16 a[96:97], v2 offset:61568
    ds_read_b64_tr_b16 a[98:99], v2 offset:64128
    ds_read_b64_tr_b16 a[100:101], v3 offset:1024
    ds_read_b64_tr_b16 a[102:103], v3 offset:3584
    s_waitcnt vmcnt(0)
    v_mov_b32 v116, 1
    s_cmp_eq_u32 s61, 0
    s_cbranch_scc0 L_s2Ab_far
    s_mov_b64 exec, 1
    buffer_store_dword v116, off, s[32:35], s58 offset:1028
    s_mov_b64 exec, -1
L_s2Ab_st:
    ds_read_b64_tr_b16 a[104:105], v3 offset:1056
    ds_read_b64_tr_b16 a[106:107], v3 offset:3616
    ds_read_b64_tr_b16 a[108:109], v3 offset:1088
    ds_read_b64_tr_b16 a[110:111], v3 offset:3648
    ds_read_b64_tr_b16 a[112:113], v3 offset:1120
    ds_read_b64_tr_b16 a[114:115], v3 offset:3680
    ds_read_b64_tr_b16 a[116:117], v3 offset:1152
    ds_read_b64_tr_b16 a[118:119], v3 offset:3712
    ds_read_b64_tr_b16 a[120:121], v3 offset:6144
    ds_read_b64_tr_b16 a[122:123], v3 offset:8704
    ds_read_b64_tr_b16 a[124:125], v3 offset:6176
    ds_read_b64_tr_b16 a[126:127], v3 offset:8736
    ds_read_b64_tr_b16 v[96:97], v3 offset:6208
    ds_read_b64_tr_b16 v[98:99], v3 offset:8768
    ds_read_b64_tr_b16 v[100:101], v3 offset:6240
    ds_read_b64_tr_b16 v[102:103], v3 offset:8800
    buffer_load_dword v118, v119, s[32:35], s69 offen offset:1028 sc1
    ds_read_b64_tr_b16 v[104:105], v3 offset:6272
    ds_read_b64_tr_b16 v[106:107], v3 offset:8832
    ds_read_b64_tr_b16 v[108:109], v3 offset:11264
    ds_read_b64_tr_b16 v[110:111], v3 offset:13824
    ds_read_b64_tr_b16 v[112:113], v3 offset:11296
    ds_read_b64_tr_b16 v[114:115], v3 offset:13856
    ds_read_b64_tr_b16 v[72:73], v3 offset:11328
    ds_read_b64_tr_b16 v[74:75], v3 offset:13888
    ds_read_b64_tr_b16 v[76:77], v3 offset:11360
    ds_read_b64_tr_b16 v[78:79], v3 offset:13920
    ds_read_b64_tr_b16 v[80:81], v3 offset:11392
    ds_read_b64_tr_b16 v[82:83], v3 offset:13952
    ds_read_b64_tr_b16 v[84:85], v3 offset:16384
    ds_read_b64_tr_b16 v[86:87], v3 offset:18944
    ds_read_b64_tr_b16 v[88:89], v3 offset:16416
    ds_read_b64_tr_b16 v[90:91], v3 offset:18976
    s_waitcnt vmcnt(0)
    v_cmp_eq_u32 vcc, 0, v118
    s_cbranch_vccz L_f2Ab_ok
    s_mov_b32 s67, 0
L_f2Ab:
    buffer_load_dword v118, v119, s[32:35], s69 offen offset:1028 sc1
    s_add_u32 s67, s67, 1
    s_waitcnt vmcnt(0)
    v_cmp_eq_u32 vcc, 0, v118
    s_cmpk_ge_u32 s67, 20000
    s_cbranch_scc1 L_f2Ab_ok
    s_cbranch_vccnz L_f2Ab
L_f2Ab_ok:
    buffer_load_dwordx4 a[8:11], v7, s[36:39], s25 offen sc1
    buffer_load_dwordx4 a[12:15], v15, s[36:39], s25 offen sc1
    buffer_load_dwordx4 a[16:19], v7, s[36:39], s26 offen sc1
    buffer_load_dwordx4 a[20:23], v15, s[36:39], s26 offen sc1
    buffer_load_dwordx4 a[24:27], v7, s[36:39], s27 offen sc1
    buffer_load_dwordx4 a[28:31], v15, s[36:39], s27 offen sc1
    buffer_load_dwordx4 a[32:35], v7, s[36:39], s40 offen sc1
    buffer_load_dwordx4 a[36:39], v15, s[36:39], s40 offen sc1
    s_barrier
    s_waitcnt lgkmcnt(0)
    v_mfma_f32_16x16x32_bf16 v[32:35], a[80:83], a[0:3], 0
    v_mfma_f32_16x16x32_bf16 v[36:39], a[80:83], a[4:7], 0
    v_mfma_f32_16x16x32_bf16 v[40:43], a[84:87], a[0:3], 0
    v_mfma_f32_16x16x32_bf16 v[44:47], a[84:87], a[4:7], 0
    buffer_load_dwordx4 a[40:43], v7, s[36:39], s41 offen sc1
    v_mfma_f32_16x16x32_bf16 v[48:51], a[88:91], a[0:3], 0
    v_mfma_f32_16x16x32_bf16 v[52:55], a[88:91], a[4:7], 0
    v_mfma_f32_16x16x32_bf16 v[56:59], a[92:95], a[0:3], 0
    v_mfma_f32_16x16x32_bf16 v[60:63], a[92:95], a[4:7], 0
    buffer_load_dwordx4 a[44:47], v15, s[36:39], s41 offen sc1
    v_mfma_f32_16x16x32_bf16 v[64:67], a[96:99], a[0:3], 0
    v_mfma_f32_16x16x32_bf16 v[68:71], a[96:99], a[4:7], 0
    s_waitcnt vmcnt(9)
    v_mfma_f32_16x16x32_bf16 v[32:35], a[100:103], a[8:11], v[32:35]
    s_waitcnt vmcnt(8)
    v_mfma_f32_16x16x32_bf16 v[36:39], a[100:103], a[12:15], v[36:39]
    v_mfma_f32_16x16x32_bf16 v[40:43], a[104:107], a[8:11], v[40:43]
    v_mfma_f32_16x16x32_bf16 v[44:47], a[104:107], a[12:15], v[44:47]
    buffer_load_dwordx4 a[48:51], v7, s[36:39], s42 offen sc1
    v_mfma_f32_16x16x32_bf16 v[48:51], a[108:111], a[8:11], v[48:51]
    v_mfma_f32_16x16x32_bf16 v[52:55], a[108:111], a[12:15], v[52:55]
    v_mfma_f32_16x16x32_bf16 v[56:59], a[112:115], a[8:11], v[56:59]
    v_mfma_f32_16x16x32_bf16 v[60:63], a[112:115], a[12:15], v[60:63]
    buffer_load_dwordx4 a[52:55], v15, s[36:39], s42 offen sc1
    v_mfma_f32_16x16x32_bf16 v[64:67], a[116:119], a[8:11], v[64:67]
    v_mfma_f32_16x16x32_bf16 v[68:71], a[116:119], a[12:15], v[68:71]
    s_waitcnt vmcnt(9)
    v_mfma_f32_16x16x32_bf16 v[32:35], a[120:123], a[16:19], v[32:35]
    s_waitcnt vmcnt(8)
    v_mfma_f32_16x16x32_bf16 v[36:39], a[120:123], a[20:23], v[36:39]
    v_mfma_f32_16x16x32_bf16 v[40:43], a[124:127], a[16:19], v[40:43]
    v_mfma_f32_16x16x32_bf16 v[44:47], a[124:127], a[20:23], v[44:47]
    buffer_load_dwordx4 a[56:59], v7, s[36:39], s43 offen sc1
    v_mfma_f32_16x16x32_bf16 v[48:51], v[96:99], a[16:19], v[48:51]
    v_mfma_f32_16x16x32_bf16 v[52:55], v[96:99], a[20:23], v[52:55]
    v_mfma_f32_16x16x32_bf16 v[56:59], v[100:103], a[16:19], v[56:59]
    v_mfma_f32_16x16x32_bf16 v[60:63], v[100:103], a[20:23], v[60:63]
    buffer_load_dwordx4 a[60:63], v15, s[36:39], s43 offen sc1
    v_mfma_f32_16x16x32_bf16 v[64:67], v[104:107], a[16:19], v[64:67]
    v_mfma_f32_16x16x32_bf16 v[68:71], v[104:107], a[20:23], v[68:71]
    s_waitcnt vmcnt(9)
    v_mfma_f32_16x16x32_bf16 v[32:35], v[108:111], a[24:27], v[32:35]
    s_waitcnt vmcnt(8)
    v_mfma_f32_16x16x32_bf16 v[36:39], v[108:111], a[28:31], v[36:39]
    v_mfma_f32_16x16x32_bf16 v[40:43], v[112:115], a[24:27], v[40:43]
    v_mfma_f32_16x16x32_bf16 v[44:47], v[112:115], a[28:31], v[44:47]
    buffer_load_dwordx4 a[64:67], v16, s[36:39], s44 offen offset:1024 sc1
    v_mfma_f32_16x16x32_bf16 v[48:51], v[72:75], a[24:27], v[48:51]
    ds_read_b64_tr_b16 v[92:93], v3 offset:16448
    v_mfma_f32_16x16x32_bf16 v[52:55], v[72:75], a[28:31], v[52:55]
    ds_read_b64_tr_b16 v[94:95], v3 offset:19008
    v_mfma_f32_16x16x32_bf16 v[56:59], v[76:79], a[24:27], v[56:59]
    ds_read_b64_tr_b16 v[72:73], v3 offset:16480
    buffer_load_dwordx4 a[68:71], v17, s[36:39], s44 offen offset:1024 sc1
    v_mfma_f32_16x16x32_bf16 v[60:63], v[76:79], a[28:31], v[60:63]
    ds_read_b64_tr_b16 v[74:75], v3 offset:19040
    v_mfma_f32_16x16x32_bf16 v[64:67], v[80:83], a[24:27], v[64:67]
    ds_read_b64_tr_b16 v[76:77], v3 offset:16512
    v_mfma_f32_16x16x32_bf16 v[68:71], v[80:83], a[28:31], v[68:71]
    ds_read_b64_tr_b16 v[78:79], v3 offset:19072
    s_waitcnt vmcnt(9)
    v_mfma_f32_16x16x32_bf16 v[32:35], v[84:87], a[32:35], v[32:35]
    ds_read_b64_tr_b16 v[80:81], v3 offset:21504
    s_waitcnt vmcnt(8)
    v_mfma_f32_16x16x32_bf16 v[36:39], v[84:87], a[36:39], v[36:39]
    ds_read_b64_tr_b16 v[82:83], v3 offset:24064
    v_mfma_f32_16x16x32_bf16 v[40:43], v[88:91], a[32:35], v[40:43]
    ds_read_b64_tr_b16 v[84:85], v3 offset:21536
    buffer_load_dwordx4 a[72:75], v16, s[36:39], s45 offen offset:1024 sc1
    v_mfma_f32_16x16x32_bf16 v[44:47], v[88:91], a[36:39], v[44:47]
    ds_read_b64_tr_b16 v[86:87], v3 offset:24096
    s_waitcnt lgkmcnt(8)
    v_mfma_f32_16x16x32_bf16 v[48:51], v[92:95], a[32:35], v[48:51]
    ds_read_b64_tr_b16 v[88:89], v3 offset:21568
    v_mfma_f32_16x16x32_bf16 v[52:55], v[92:95], a[36:39], v[52:55]
    ds_read_b64_tr_b16 v[90:91], v3 offset:24128
    s_waitcnt lgkmcnt(8)
    v_mfma_f32_16x16x32_bf16 v[56:59], v[72:75], a[32:35], v[56:59]
    ds_read_b64_tr_b16 v[92:93], v3 offset:21600
    buffer_load_dwordx4 a[76:79], v17, s[36:39], s45 offen offset:1024 sc1
    v_mfma_f32_16x16x32_bf16 v[60:63], v[72:75], a[36:39], v[60:63]
    ds_read_b64_tr_b16 v[94:95], v3 offset:24160
    s_waitcnt lgkmcnt(8)
    v_mfma_f32_16x16x32_bf16 v[64:67], v[76:79], a[32:35], v[64:67]
    ds_read_b64_tr_b16 v[72:73], v3 offset:21632
    v_mfma_f32_16x16x32_bf16 v[68:71], v[76:79], a[36:39], v[68:71]
    ds_read_b64_tr_b16 v[74:75], v3 offset:24192
    s_waitcnt vmcnt(9) lgkmcnt(8)
    v_mfma_f32_16x16x32_bf16 v[32:35], v[80:83], a[40:43], v[32:35]
    ds_read_b64_tr_b16 v[76:77], v3 offset:26624
    s_waitcnt vmcnt(8)
    v_mfma_f32_16x16x32_bf16 v[36:39], v[80:83], a[44:47], v[36:39]
    ds_read_b64_tr_b16 v[78:79], v3 offset:29184
    s_waitcnt lgkmcnt(8)
    v_mfma_f32_16x16x32_bf16 v[40:43], v[84:87], a[40:43], v[40:43]
    ds_read_b64_tr_b16 v[80:81], v3 offset:26656
    v_mfma_f32_16x16x32_bf16 v[44:47], v[84:87], a[44:47], v[44:47]
    ds_read_b64_tr_b16 v[82:83], v3 offset:29216
    s_waitcnt lgkmcnt(8)
    v_mfma_f32_16x16x32_bf16 v[48:51], v[88:91], a[40:43], v[48:51]
    ds_read_b64_tr_b16 v[84:85], v3 offset:26688
    v_mfma_f32_16x16x32_bf16 v[52:55], v[88:91], a[44:47], v[52:55]
    ds_read_b64_tr_b16 v[86:87], v3 offset:29248
    s_waitcnt lgkmcnt(8)
    v_mfma_f32_16x16x32_bf16 v[56:59], v[92:95], a[40:43], v[56:59]
    ds_read_b64_tr_b16 v[88:89], v3 offset:26720
    v_mfma_f32_16x16x32_bf16 v[60:63], v[92:95], a[44:47], v[60:63]
    ds_read_b64_tr_b16 v[90:91], v3 offset:29280
    s_waitcnt lgkmcnt(8)
    v_mfma_f32_16x16x32_bf16 v[64:67], v[72:75], a[40:43], v[64:67]
    ds_read_b64_tr_b16 v[92:93], v3 offset:26752
    v_mfma_f32_16x16x32_bf16 v[68:71], v[72:75], a[44:47], v[68:71]
    ds_read_b64_tr_b16 v[94:95], v3 offset:29312
    s_waitcnt vmcnt(7) lgkmcnt(8)
    v_mfma_f32_16x16x32_bf16 v[32:35], v[76:79], a[48:51], v[32:35]
    ds_read_b64_tr_b16 v[72:73], v3 offset:31744
    s_waitcnt vmcnt(6)
    v_mfma_f32_16x16x32_bf16 v[36:39], v[76:79], a[52:55], v[36:39]
    ds_read_b64_tr_b16 v[74:75], v3 offset:34304
    s_waitcnt lgkmcnt(8)
    v_mfma_f32_16x16x32_bf16 v[40:43], v[80:83], a[48:51], v[40:43]
    ds_read_b64_tr_b16 v[76:77], v3 offset:31776
    v_mfma_f32_16x16x32_bf16 v[44:47], v[80:83], a[52:55], v[44:47]
    ds_read_b64_tr_b16 v[78:79], v3 offset:34336
    s_waitcnt lgkmcnt(8)
    v_mfma_f32_16x16x32_bf16 v[48:51], v[84:87], a[48:51], v[48:51]
    ds_read_b64_tr_b16 v[80:81], v3 offset:31808
    v_mfma_f32_16x16x32_bf16 v[52:55], v[84:87], a[52:55], v[52:55]
    ds_read_b64_tr_b16 v[82:83], v3 offset:34368
    s_waitcnt lgkmcnt(8)
    v_mfma_f32_16x16x32_bf16 v[56:59], v[88:91], a[48:51], v[56:59]
    ds_read_b64_tr_b16 v[84:85], v3 offset:31840
    v_mfma_f32_16x16x32_bf16 v[60:63], v[88:91], a[52:55], v[60:63]
    ds_read_b64_tr_b16 v[86:87], v3 offset:34400
    s_waitcnt lgkmcnt(8)
    v_mfma_f32_16x16x32_bf16 v[64:67], v[92:95], a[48:51], v[64:67]
    ds_read_b64_tr_b16 v[88:89], v3 offset:31872
    v_mfma_f32_16x16x32_bf16 v[68:71], v[92:95], a[52:55], v[68:71]
    ds_read_b64_tr_b16 v[90:91], v3 offset:34432
    s_waitcnt vmcnt(5) lgkmcnt(8)
    v_mfma_f32_16x16x32_bf16 v[32:35], v[72:75], a[56:59], v[32:35]
    ds_read_b64_tr_b16 v[92:93], v2 offset:0
    s_waitcnt vmcnt(4)
    v_mfma_f32_16x16x32_bf16 v[36:39], v[72:75], a[60:63], v[36:39]
    ds_read_b64_tr_b16 v[94:95], v2 offset:2560
    s_waitcnt lgkmcnt(8)
    v_mfma_f32_16x16x32_bf16 v[40:43], v[76:79], a[56:59], v[40:43]
    ds_read_b64_tr_b16 v[72:73], v2 offset:32
    v_mfma_f32_16x16x32_bf16 v[44:47], v[76:79], a[60:63], v[44:47]
    ds_read_b64_tr_b16 v[74:75], v2 offset:2592
    s_waitcnt lgkmcnt(8)
    v_mfma_f32_16x16x32_bf16 v[48:51], v[80:83], a[56:59], v[48:51]
    ds_read_b64_tr_b16 v[76:77], v2 offset:64
    v_mfma_f32_16x16x32_bf16 v[52:55], v[80:83], a[60:63], v[52:55]
    ds_read_b64_tr_b16 v[78:79], v2 offset:2624
    s_waitcnt lgkmcnt(8)
    v_mfma_f32_16x16x32_bf16 v[56:59], v[84:87], a[56:59], v[56:59]
    ds_read_b64_tr_b16 v[80:81], v2 offset:96
    v_mfma_f32_16x16x32_bf16 v[60:63], v[84:87], a[60:63], v[60:63]
    ds_read_b64_tr_b16 v[82:83], v2 offset:2656
    s_waitcnt lgkmcnt(8)
    v_mfma_f32_16x16x32_bf16 v[64:67], v[88:91], a[56:59], v[64:67]
    ds_read_b64_tr_b16 v[84:85], v2 offset:128
    v_mfma_f32_16x16x32_bf16 v[68:71], v[88:91], a[60:63], v[68:71]
    ds_read_b64_tr_b16 v[86:87], v2 offset:2688
    s_waitcnt vmcnt(0)
    v_mov_b32 v116, 1
    s_cmp_eq_u32 s61, 0
    s_cbranch_scc0 L_s3Ab_far
    s_mov_b64 exec, 1
    buffer_store_dword v116, off, s[32:35], s58 offset:2052
    s_mov_b64 exec, -1
L_s3Ab_st:
    s_waitcnt lgkmcnt(8)
    v_mfma_f32_16x16x32_bf16 v[32:35], v[92:95], a[64:67], v[32:35]
    ds_read_b64_tr_b16 v[88:89], v2 offset:5120
    v_mfma_f32_16x16x32_bf16 v[36:39], v[92:95], a[68:71], v[36:39]
    ds_read_b64_tr_b16 v[90:91], v2 offset:7680
    s_waitcnt lgkmcnt(8)
    v_mfma_f32_16x16x32_bf16 v[40:43], v[72:75], a[64:67], v[40:43]
    ds_read_b64_tr_b16 v[92:93], v2 offset:5152
    v_mfma_f32_16x16x32_bf16 v[44:47], v[72:75], a[68:71], v[44:47]
    ds_read_b64_tr_b16 v[94:95], v2 offset:7712
    s_waitcnt lgkmcnt(8)
    v_mfma_f32_16x16x32_bf16 v[48:51], v[76:79], a[64:67], v[48:51]
    ds_read_b64_tr_b16 v[72:73], v2 offset:5184
    v_mfma_f32_16x16x32_bf16 v[52:55], v[76:79], a[68:71], v[52:55]
    ds_read_b64_tr_b16 v[74:75], v2 offset:7744
    s_waitcnt lgkmcnt(8)
    v_mfma_f32_16x16x32_bf16 v[56:59], v[80:83], a[64:67], v[56:59]
    ds_read_b64_tr_b16 v[76:77], v2 offset:5216
    v_mfma_f32_16x16x32_bf16 v[60:63], v[80:83], a[68:71], v[60:63]
    ds_read_b64_tr_b16 v[78:79], v2 offset:7776
    s_waitcnt lgkmcnt(8)
    v_mfma_f32_16x16x32_bf16 v[64:67], v[84:87], a[64:67], v[64:67]
    ds_read_b64_tr_b16 v[80:81], v2 offset:5248
    v_mfma_f32_16x16x32_bf16 v[68:71], v[84:87], a[68:71], v[68:71]
    ds_read_b64_tr_b16 v[82:83], v2 offset:7808
    s_waitcnt lgkmcnt(8)
    v_mfma_f32_16x16x32_bf16 v[32:35], v[88:91], a[72:75], v[32:35]
    v_mfma_f32_16x16x32_bf16 v[36:39], v[88:91], a[76:79], v[36:39]
    s_waitcnt lgkmcnt(6)
    v_mfma_f32_16x16x32_bf16 v[40:43], v[92:95], a[72:75], v[40:43]
    v_mfma_f32_16x16x32_bf16 v[44:47], v[92:95], a[76:79], v[44:47]
    s_waitcnt lgkmcnt(4)
    v_mfma_f32_16x16x32_bf16 v[48:51], v[72:75], a[72:75], v[48:51]
    v_mfma_f32_16x16x32_bf16 v[52:55], v[72:75], a[76:79], v[52:55]
    s_waitcnt lgkmcnt(2)
    v_mfma_f32_16x16x32_bf16 v[56:59], v[76:79], a[72:75], v[56:59]
    v_mfma_f32_16x16x32_bf16 v[60:63], v[76:79], a[76:79], v[60:63]
    s_waitcnt lgkmcnt(0)
    v_mfma_f32_16x16x32_bf16 v[64:67], v[80:83], a[72:75], v[64:67]
    v_mfma_f32_16x16x32_bf16 v[68:71], v[80:83], a[76:79], v[68:71]
    s_setprio 0
    ds_write_b128 v18, v[32:35] offset:0
    ds_write_b128 v18, v[40:43] offset:1024
    ds_write_b128 v18, v[48:51] offset:2048
    ds_write_b128 v18, v[56:59] offset:3072
    s_nop 1
    ds_write_b128 v18, v[64:67] offset:4096
    ds_write_b128 v18, v[36:39] offset:5120
    ds_write_b128 v18, v[44:47] offset:6144
    ds_write_b128 v18, v[52:55] offset:7168
    ds_write_b128 v18, v[60:63] offset:8192
    ds_write_b128 v18, v[68:71] offset:9216
    s_waitcnt lgkmcnt(0)
    s_barrier
    s_endpgm
.p2align 12
L_Bb:
    buffer_load_dword v0, v69, s[36:39], 0 offen sc1
    s_waitcnt vmcnt(1)
    s_barrier
    ds_read_b64_tr_b16 v[72:73], v3 offset:16384
    ds_read_b64_tr_b16 v[74:75], v3 offset:18944
    ds_read_b64_tr_b16 v[76:77], v3 offset:16416
    ds_read_b64_tr_b16 v[78:79], v3 offset:18976
    ds_read_b64_tr_b16 v[80:81], v3 offset:16448
    ds_read_b64_tr_b16 v[82:83], v3 offset:19008
    ds_read_b64_tr_b16 v[84:85], v3 offset:16480
    ds_read_b64_tr_b16 v[86:87], v3 offset:19040
    ds_read_b64_tr_b16 v[88:89], v3 offset:16512
    ds_read_b64_tr_b16 v[90:91], v3 offset:19072
    s_waitcnt lgkmcnt(8)
    v_mfma_f32_16x16x32_bf16 v[32:35], v[72:75], a[0:3], v[28:31]
    ds_read_b64_tr_b16 v[92:93], v3 offset:21504
    v_mfma_f32_16x16x32_bf16 v[36:39], v[72:75], a[4:7], v[28:31]
    ds_read_b64_tr_b16 v[94:95], v3 offset:24064
    s_waitcnt lgkmcnt(8)
    v_mfma_f32_16x16x32_bf16 v[40:43], v[76:79], a[0:3], v[28:31]
    ds_read_b64_tr_b16 v[72:73], v3 offset:21536
    v_mfma_f32_16x16x32_bf16 v[44:47], v[76:79], a[4:7], v[28:31]
    ds_read_b64_tr_b16 v[74:75], v3 offset:24096
    s_waitcnt lgkmcnt(8)
    v_mfma_f32_16x16x32_bf16 v[48:51], v[80:83], a[0:3], v[28:31]
    ds_read_b64_tr_b16 v[76:77], v3 offset:21568
    v_mfma_f32_16x16x32_bf16 v[52:55], v[80:83], a[4:7], v[28:31]
    ds_read_b64_tr_b16 v[78:79], v3 offset:24128
    s_waitcnt lgkmcnt(8)
    v_mfma_f32_16x16x32_bf16 v[56:59], v[84:87], a[0:3], v[28:31]
    ds_read_b64_tr_b16 v[80:81], v3 offset:21600
    v_mfma_f32_16x16x32_bf16 v[60:63], v[84:87], a[4:7], v[28:31]
    ds_read_b64_tr_b16 v[82:83], v3 offset:24160
    s_waitcnt lgkmcnt(8)
    v_mfma_f32_16x16x32_bf16 v[64:67], v[88:91], a[0:3], v[28:31]
    ds_read_b64_tr_b16 v[84:85], v3 offset:21632
    v_mfma_f32_16x16x32_bf16 v[68:71], v[88:91], a[4:7], v[28:31]
    ds_read_b64_tr_b16 v[86:87], v3 offset:24192
    s_waitcnt lgkmcnt(8)
    v_mfma_f32_16x16x32_bf16 v[32:35], v[92:95], a[8:11], v[32:35]
    ds_read_b64_tr_b16 v[88:89], v3 offset:26624
    v_mfma_f32_16x16x32_bf16 v[36:39], v[92:95], a[12:15], v[36:39]
    ds_read_b64_tr_b16 v[90:91], v3 offset:29184
    s_waitcnt lgkmcnt(8)
    v_mfma_f32_16x16x32_bf16 v[40:43], v[72:75], a[8:11], v[40:43]
    ds_read_b64_tr_b16 v[92:93], v3 offset:26656
    v_lshrrev_b32 v20, 4, v1
    v_mfma_f32_16x16x32_bf16 v[44:47], v[72:75], a[12:15], v[44:47]
    ds_read_b64_tr_b16 v[94:95], v3 offset:29216
    s_waitcnt lgkmcnt(8)
    v_mfma_f32_16x16x32_bf16 v[48:51], v[76:79], a[8:11], v[48:51]
    ds_read_b64_tr_b16 v[72:73], v3 offset:26688
    v_and_b32 v21, 15, v1
    v_mfma_f32_16x16x32_bf16 v[52:55], v[76:79], a[12:15], v[52:55]
    ds_read_b64_tr_b16 v[74:75], v3 offset:29248
    s_waitcnt lgkmcnt(8)
    v_mfma_f32_16x16x32_bf16 v[56:59], v[80:83], a[8:11], v[56:59]
    ds_read_b64_tr_b16 v[76:77], v3 offset:26720
    v_add_u32 v15, 40960, v7
    v_mfma_f32_16x16x32_bf16 v[60:63], v[80:83], a[12:15], v[60:63]
    ds_read_b64_tr_b16 v[78:79], v3 offset:29280
    s_waitcnt lgkmcnt(8)
    v_mfma_f32_16x16x32_bf16 v[64:67], v[84:87], a[8:11], v[64:67]
    ds_read_b64_tr_b16 v[80:81], v3 offset:26752
    v_mul_u32_u24 v16, 5120, v20
    v_mfma_f32_16x16x32_bf16 v[68:71], v[84:87], a[12:15], v[68:71]
    ds_read_b64_tr_b16 v[82:83], v3 offset:29312
    s_waitcnt lgkmcnt(8)
    v_mfma_f32_16x16x32_bf16 v[32:35], v[88:91], a[16:19], v[32:35]
    ds_read_b64_tr_b16 v[84:85], v3 offset:31744
    v_lshl_add_u32 v16, v21, 4, v16
    v_mfma_f32_16x16x32_bf16 v[36:39], v[88:91], a[20:23], v[36:39]
    ds_read_b64_tr_b16 v[86:87], v3 offset:34304
    s_waitcnt lgkmcnt(8)
    v_mfma_f32_16x16x32_bf16 v[40:43], v[92:95], a[16:19], v[40:43]
    ds_read_b64_tr_b16 v[88:89], v3 offset:31776
    v_add_u32 v17, 40960, v16
    v_mfma_f32_16x16x32_bf16 v[44:47], v[92:95], a[20:23], v[44:47]
    ds_read_b64_tr_b16 v[90:91], v3 offset:34336
    s_waitcnt lgkmcnt(8)
    v_mfma_f32_16x16x32_bf16 v[48:51], v[72:75], a[16:19], v[48:51]
    ds_read_b64_tr_b16 v[92:93], v3 offset:31808
    s_mul_i32 s57, s51, 10240
    v_mfma_f32_16x16x32_bf16 v[52:55], v[72:75], a[20:23], v[52:55]
    ds_read_b64_tr_b16 v[94:95], v3 offset:34368
    s_waitcnt lgkmcnt(8)
    v_mfma_f32_16x16x32_bf16 v[56:59], v[76:79], a[16:19], v[56:59]
    ds_read_b64_tr_b16 v[72:73], v3 offset:31840
    s_add_u32 s57, s57, 102400
    v_mfma_f32_16x16x32_bf16 v[60:63], v[76:79], a[20:23], v[60:63]
    ds_read_b64_tr_b16 v[74:75], v3 offset:34400
    s_waitcnt lgkmcnt(8)
    v_mfma_f32_16x16x32_bf16 v[64:67], v[80:83], a[16:19], v[64:67]
    ds_read_b64_tr_b16 v[76:77], v3 offset:31872
    v_add_u32 v18, s57, v7
    v_mfma_f32_16x16x32_bf16 v[68:71], v[80:83], a[20:23], v[68:71]
    ds_read_b64_tr_b16 v[78:79], v3 offset:34432
    s_waitcnt lgkmcnt(8)
    v_mfma_f32_16x16x32_bf16 v[32:35], v[84:87], a[24:27], v[32:35]
    ds_read_b64_tr_b16 v[80:81], v2 offset:0
    s_add_u32 s44, s63, 2560
    v_mfma_f32_16x16x32_bf16 v[36:39], v[84:87], a[28:31], v[36:39]
    ds_read_b64_tr_b16 v[82:83], v2 offset:2560
    s_waitcnt lgkmcnt(8)
    v_mfma_f32_16x16x32_bf16 v[40:43], v[88:91], a[24:27], v[40:43]
    ds_read_b64_tr_b16 v[84:85], v2 offset:32
    s_add_u32 s45, s44, 20480
    v_mfma_f32_16x16x32_bf16 v[44:47], v[88:91], a[28:31], v[44:47]
    ds_read_b64_tr_b16 v[86:87], v2 offset:2592
    s_waitcnt lgkmcnt(8)
    v_mfma_f32_16x16x32_bf16 v[48:51], v[92:95], a[24:27], v[48:51]
    ds_read_b64_tr_b16 v[88:89], v2 offset:64
    s_add_u32 s25, s50, 1
    v_mfma_f32_16x16x32_bf16 v[52:55], v[92:95], a[28:31], v[52:55]
    ds_read_b64_tr_b16 v[90:91], v2 offset:2624
    s_waitcnt lgkmcnt(8)
    v_mfma_f32_16x16x32_bf16 v[56:59], v[72:75], a[24:27], v[56:59]
    ds_read_b64_tr_b16 v[92:93], v2 offset:96
    s_and_b32 s25, s25, 7
    v_mfma_f32_16x16x32_bf16 v[60:63], v[72:75], a[28:31], v[60:63]
    ds_read_b64_tr_b16 v[94:95], v2 offset:2656
    s_waitcnt lgkmcnt(8)
    v_mfma_f32_16x16x32_bf16 v[64:67], v[76:79], a[24:27], v[64:67]
    ds_read_b64_tr_b16 v[72:73], v2 offset:128
    s_mulk_i32 s25, 5120
    v_mfma_f32_16x16x32_bf16 v[68:71], v[76:79], a[28:31], v[68:71]
    ds_read_b64_tr_b16 v[74:75], v2 offset:2688
    s_waitcnt lgkmcnt(8)
    v_mfma_f32_16x16x32_bf16 v[32:35], v[80:83], a[32:35], v[32:35]
    ds_read_b64_tr_b16 v[76:77], v2 offset:5120
    s_add_u32 s25, s25, s44
    v_mfma_f32_16x16x32_bf16 v[36:39], v[80:83], a[36:39], v[36:39]
    ds_read_b64_tr_b16 v[78:79], v2 offset:7680
    s_waitcnt lgkmcnt(8)
    v_mfma_f32_16x16x32_bf16 v[40:43], v[84:87], a[32:35], v[40:43]
    ds_read_b64_tr_b16 v[80:81], v2 offset:5152
    s_add_u32 s26, s50, 2
    v_mfma_f32_16x16x32_bf16 v[44:47], v[84:87], a[36:39], v[44:47]
    ds_read_b64_tr_b16 v[82:83], v2 offset:7712
    s_waitcnt lgkmcnt(8)
    v_mfma_f32_16x16x32_bf16 v[48:51], v[88:91], a[32:35], v[48:51]
    ds_read_b64_tr_b16 v[84:85], v2 offset:5184
    s_and_b32 s26, s26, 7
    v_mfma_f32_16x16x32_bf16 v[52:55], v[88:91], a[36:39], v[52:55]
    ds_read_b64_tr_b16 v[86:87], v2 offset:7744
    s_waitcnt lgkmcnt(8)
    v_mfma_f32_16x16x32_bf16 v[56:59], v[92:95], a[32:35], v[56:59]
    ds_read_b64_tr_b16 v[88:89], v2 offset:5216
    s_mulk_i32 s26, 5120
    v_mfma_f32_16x16x32_bf16 v[60:63], v[92:95], a[36:39], v[60:63]
    ds_read_b64_tr_b16 v[90:91], v2 offset:7776
    s_waitcnt lgkmcnt(8)
    v_mfma_f32_16x16x32_bf16 v[64:67], v[72:75], a[32:35], v[64:67]
    ds_read_b64_tr_b16 v[92:93], v2 offset:5248
    s_add_u32 s26, s26, s44
    v_mfma_f32_16x16x32_bf16 v[68:71], v[72:75], a[36:39], v[68:71]
    ds_read_b64_tr_b16 v[94:95], v2 offset:7808
    s_waitcnt lgkmcnt(8)
    v_mfma_f32_16x16x32_bf16 v[32:35], v[76:79], a[40:43], v[32:35]
    ds_read_b64_tr_b16 v[72:73], v2 offset:10240
    s_add_u32 s27, s50, 3
    v_mfma_f32_16x16x32_bf16 v[36:39], v[76:79], a[44:47], v[36:39]
    ds_read_b64_tr_b16 v[74:75], v2 offset:12800
    s_waitcnt lgkmcnt(8)
    v_mfma_f32_16x16x32_bf16 v[40:43], v[80:83], a[40:43], v[40:43]
    ds_read_b64_tr_b16 v[76:77], v2 offset:10272
    s_and_b32 s27, s27, 7
    v_mfma_f32_16x16x32_bf16 v[44:47], v[80:83], a[44:47], v[44:47]
    ds_read_b64_tr_b16 v[78:79], v2 offset:12832
    s_waitcnt lgkmcnt(8)
    v_mfma_f32_16x16x32_bf16 v[48:51], v[84:87], a[40:43], v[48:51]
    ds_read_b64_tr_b16 v[80:81], v2 offset:10304
    s_mulk_i32 s27, 5120
    v_mfma_f32_16x16x32_bf16 v[52:55], v[84:87], a[44:47], v[52:55]
    ds_read_b64_tr_b16 v[82:83], v2 offset:12864
    s_waitcnt lgkmcnt(8)
    v_mfma_f32_16x16x32_bf16 v[56:59], v[88:91], a[40:43], v[56:59]
    ds_read_b64_tr_b16 v[84:85], v2 offset:10336
    s_add_u32 s27, s27, s44
    v_mfma_f32_16x16x32_bf16 v[60:63], v[88:91], a[44:47], v[60:63]
    ds_read_b64_tr_b16 v[86:87], v2 offset:12896
    s_waitcnt lgkmcnt(8)
    v_mfma_f32_16x16x32_bf16 v[64:67], v[92:95], a[40:43], v[64:67]
    ds_read_b64_tr_b16 v[88:89], v2 offset:10368
    s_add_u32 s40, s50, 4
    v_mfma_f32_16x16x32_bf16 v[68:71], v[92:95], a[44:47], v[68:71]
    ds_read_b64_tr_b16 v[90:91], v2 offset:12928
    s_waitcnt lgkmcnt(8)
    v_mfma_f32_16x16x32_bf16 v[32:35], v[72:75], a[48:51], v[32:35]
    ds_read_b64_tr_b16 v[92:93], v2 offset:15360
    s_and_b32 s40, s40, 7
    v_mfma_f32_16x16x32_bf16 v[36:39], v[72:75], a[52:55], v[36:39]
    ds_read_b64_tr_b16 v[94:95], v2 offset:17920
    s_waitcnt lgkmcnt(8)
    v_mfma_f32_16x16x32_bf16 v[40:43], v[76:79], a[48:51], v[40:43]
    ds_read_b64_tr_b16 v[72:73], v2 offset:15392
    s_mulk_i32 s40, 5120
    v_mfma_f32_16x16x32_bf16 v[44:47], v[76:79], a[52:55], v[44:47]
    ds_read_b64_tr_b16 v[74:75], v2 offset:17952
    s_waitcnt lgkmcnt(8)
    v_mfma_f32_16x16x32_bf16 v[48:51], v[80:83], a[48:51], v[48:51]
    ds_read_b64_tr_b16 v[76:77], v2 offset:15424
    s_add_u32 s40, s40, s44
    v_mfma_f32_16x16x32_bf16 v[52:55], v[80:83], a[52:55], v[52:55]
    ds_read_b64_tr_b16 v[78:79], v2 offset:17984
    s_waitcnt lgkmcnt(8)
    v_mfma_f32_16x16x32_bf16 v[56:59], v[84:87], a[48:51], v[56:59]
    ds_read_b64_tr_b16 v[80:81], v2 offset:15456
    s_add_u32 s41, s50, 5
    v_mfma_f32_16x16x32_bf16 v[60:63], v[84:87], a[52:55], v[60:63]
    ds_read_b64_tr_b16 v[82:83], v2 offset:18016
    s_waitcnt lgkmcnt(8)
    v_mfma_f32_16x16x32_bf16 v[64:67], v[88:91], a[48:51], v[64:67]
    ds_read_b64_tr_b16 v[84:85], v2 offset:15488
    s_and_b32 s41, s41, 7
    v_mfma_f32_16x16x32_bf16 v[68:71], v[88:91], a[52:55], v[68:71]
    ds_read_b64_tr_b16 v[86:87], v2 offset:18048
    s_barrier
    s_waitcnt lgkmcnt(8)
    v_mfma_f32_16x16x32_bf16 v[32:35], v[92:95], a[56:59], v[32:35]
    ds_read_b64_tr_b16 v[88:89], v2 offset:20480
    s_mulk_i32 s41, 5120
    v_mfma_f32_16x16x32_bf16 v[36:39], v[92:95], a[60:63], v[36:39]
    ds_read_b64_tr_b16 v[90:91], v2 offset:23040
    s_waitcnt lgkmcnt(8)
    v_mfma_f32_16x16x32_bf16 v[40:43], v[72:75], a[56:59], v[40:43]
    ds_read_b64_tr_b16 v[92:93], v2 offset:20512
    s_add_u32 s41, s41, s44
    v_mfma_f32_16x16x32_bf16 v[44:47], v[72:75], a[60:63], v[44:47]
    ds_read_b64_tr_b16 v[94:95], v2 offset:23072
    s_waitcnt lgkmcnt(8)
    v_mfma_f32_16x16x32_bf16 v[48:51], v[76:79], a[56:59], v[48:51]
    ds_read_b64_tr_b16 v[72:73], v2 offset:20544
    s_add_u32 s42, s50, 6
    v_mfma_f32_16x16x32_bf16 v[52:55], v[76:79], a[60:63], v[52:55]
    ds_read_b64_tr_b16 v[74:75], v2 offset:23104
    s_waitcnt lgkmcnt(8)
    v_mfma_f32_16x16x32_bf16 v[56:59], v[80:83], a[56:59], v[56:59]
    ds_read_b64_tr_b16 v[76:77], v2 offset:20576
    s_and_b32 s42, s42, 7
    v_mfma_f32_16x16x32_bf16 v[60:63], v[80:83], a[60:63], v[60:63]
    ds_read_b64_tr_b16 v[78:79], v2 offset:23136
    s_waitcnt lgkmcnt(8)
    v_mfma_f32_16x16x32_bf16 v[64:67], v[84:87], a[56:59], v[64:67]
    ds_read_b64_tr_b16 v[80:81], v2 offset:20608
    s_mulk_i32 s42, 5120
    v_mfma_f32_16x16x32_bf16 v[68:71], v[84:87], a[60:63], v[68:71]
    ds_read_b64_tr_b16 v[82:83], v2 offset:23168
    s_waitcnt lgkmcnt(8)
    v_mfma_f32_16x16x32_bf16 v[32:35], v[88:91], a[64:67], v[32:35]
    ds_read_b64_tr_b16 v[84:85], v2 offset:25600
    s_add_u32 s42, s42, s44
    v_mfma_f32_16x16x32_bf16 v[36:39], v[88:91], a[68:71], v[36:39]
    ds_read_b64_tr_b16 v[86:87], v2 offset:28160
    s_waitcnt lgkmcnt(8)
    v_mfma_f32_16x16x32_bf16 v[40:43], v[92:95], a[64:67], v[40:43]
    ds_read_b64_tr_b16 v[88:89], v2 offset:25632
    s_add_u32 s43, s50, 7
    v_mfma_f32_16x16x32_bf16 v[44:47], v[92:95], a[68:71], v[44:47]
    ds_read_b64_tr_b16 v[90:91], v2 offset:28192
    s_waitcnt lgkmcnt(8)
    v_mfma_f32_16x16x32_bf16 v[48:51], v[72:75], a[64:67], v[48:51]
    ds_read_b64_tr_b16 v[92:93], v2 offset:25664
    s_and_b32 s43, s43, 7
    v_mfma_f32_16x16x32_bf16 v[52:55], v[72:75], a[68:71], v[52:55]
    ds_read_b64_tr_b16 v[94:95], v2 offset:28224
    s_waitcnt lgkmcnt(8)
    v_mfma_f32_16x16x32_bf16 v[56:59], v[76:79], a[64:67], v[56:59]
    ds_read_b64_tr_b16 v[72:73], v2 offset:25696
    s_mulk_i32 s43, 5120
    v_mfma_f32_16x16x32_bf16 v[60:63], v[76:79], a[68:71], v[60:63]
    ds_read_b64_tr_b16 v[74:75], v2 offset:28256
    s_waitcnt lgkmcnt(8)
    v_mfma_f32_16x16x32_bf16 v[64:67], v[80:83], a[64:67], v[64:67]
    ds_read_b64_tr_b16 v[76:77], v2 offset:25728
    s_add_u32 s43, s43, s44
    v_mfma_f32_16x16x32_bf16 v[68:71], v[80:83], a[68:71], v[68:71]
    ds_read_b64_tr_b16 v[78:79], v2 offset:28288
    s_waitcnt lgkmcnt(8)
    v_mfma_f32_16x16x32_bf16 v[32:35], v[84:87], a[72:75], v[32:35]
    ds_read_b64_tr_b16 v[80:81], v2 offset:30720
    s_lshl2_add_u32 s58, s52, s51
    v_mfma_f32_16x16x32_bf16 v[36:39], v[84:87], a[76:79], v[36:39]
    ds_read_b64_tr_b16 v[82:83], v2 offset:33280
    s_waitcnt lgkmcnt(8)
    v_mfma_f32_16x16x32_bf16 v[40:43], v[88:91], a[72:75], v[40:43]
    ds_read_b64_tr_b16 v[84:85], v2 offset:30752
    s_lshl_b32 s58, s58, 6
    v_mfma_f32_16x16x32_bf16 v[44:47], v[88:91], a[76:79], v[44:47]
    ds_read_b64_tr_b16 v[86:87], v2 offset:33312
    s_waitcnt lgkmcnt(8)
    v_mfma_f32_16x16x32_bf16 v[48:51], v[92:95], a[72:75], v[48:51]
    ds_read_b64_tr_b16 v[88:89], v2 offset:30784
    s_add_u32 s69, s58, s68
    v_mfma_f32_16x16x32_bf16 v[52:55], v[92:95], a[76:79], v[52:55]
    ds_read_b64_tr_b16 v[90:91], v2 offset:33344
    s_waitcnt lgkmcnt(8)
    v_mfma_f32_16x16x32_bf16 v[56:59], v[72:75], a[72:75], v[56:59]
    ds_read_b64_tr_b16 v[92:93], v2 offset:30816
    s_lshl3_add_u32 s58, s50, s69
    v_mfma_f32_16x16x32_bf16 v[60:63], v[72:75], a[76:79], v[60:63]
    ds_read_b64_tr_b16 v[94:95], v2 offset:33376
    s_waitcnt lgkmcnt(8)
    v_mfma_f32_16x16x32_bf16 v[64:67], v[76:79], a[72:75], v[64:67]
    ds_read_b64_tr_b16 v[72:73], v2 offset:30848
    v_mfma_f32_16x16x32_bf16 v[68:71], v[76:79], a[76:79], v[68:71]
    ds_read_b64_tr_b16 v[74:75], v2 offset:33408
    s_waitcnt lgkmcnt(8)
    v_mfma_f32_16x16x32_bf16 v[32:35], v[80:83], a[80:83], v[32:35]
    ds_read_b64_tr_b16 v[76:77], v2 offset:35840
    v_mfma_f32_16x16x32_bf16 v[36:39], v[80:83], a[84:87], v[36:39]
    ds_read_b64_tr_b16 v[78:79], v2 offset:38400
    s_waitcnt lgkmcnt(8)
    v_mfma_f32_16x16x32_bf16 v[40:43], v[84:87], a[80:83], v[40:43]
    ds_read_b64_tr_b16 v[80:81], v2 offset:35872
    v_mfma_f32_16x16x32_bf16 v[44:47], v[84:87], a[84:87], v[44:47]
    ds_read_b64_tr_b16 v[82:83], v2 offset:38432
    s_waitcnt lgkmcnt(8)
    v_mfma_f32_16x16x32_bf16 v[48:51], v[88:91], a[80:83], v[48:51]
    ds_read_b64_tr_b16 v[84:85], v2 offset:35904
    v_mfma_f32_16x16x32_bf16 v[52:55], v[88:91], a[84:87], v[52:55]
    ds_read_b64_tr_b16 v[86:87], v2 offset:38464
    s_waitcnt lgkmcnt(8)
    v_mfma_f32_16x16x32_bf16 v[56:59], v[92:95], a[80:83], v[56:59]
    ds_read_b64_tr_b16 v[88:89], v2 offset:35936
    v_mfma_f32_16x16x32_bf16 v[60:63], v[92:95], a[84:87], v[60:63]
    ds_read_b64_tr_b16 v[90:91], v2 offset:38496
    s_waitcnt lgkmcnt(8)
    v_mfma_f32_16x16x32_bf16 v[64:67], v[72:75], a[80:83], v[64:67]
    ds_read_b64_tr_b16 v[92:93], v2 offset:35968
    v_mfma_f32_16x16x32_bf16 v[68:71], v[72:75], a[84:87], v[68:71]
    ds_read_b64_tr_b16 v[94:95], v2 offset:38528
    s_barrier
    s_waitcnt lgkmcnt(8)
    v_mfma_f32_16x16x32_bf16 v[32:35], v[76:79], a[88:91], v[32:35]
    ds_read_b64_tr_b16 v[72:73], v2 offset:40960
    v_mfma_f32_16x16x32_bf16 v[36:39], v[76:79], a[92:95], v[36:39]
    ds_read_b64_tr_b16 v[74:75], v2 offset:43520
    s_waitcnt lgkmcnt(8)
    v_mfma_f32_16x16x32_bf16 v[40:43], v[80:83], a[88:91], v[40:43]
    ds_read_b64_tr_b16 v[76:77], v2 offset:40992
    v_mfma_f32_16x16x32_bf16 v[44:47], v[80:83], a[92:95], v[44:47]
    ds_read_b64_tr_b16 v[78:79], v2 offset:43552
    s_waitcnt lgkmcnt(8)
    v_mfma_f32_16x16x32_bf16 v[48:51], v[84:87], a[88:91], v[48:51]
    ds_read_b64_tr_b16 v[80:81], v2 offset:41024
    v_mfma_f32_16x16x32_bf16 v[52:55], v[84:87], a[92:95], v[52:55]
    ds_read_b64_tr_b16 v[82:83], v2 offset:43584
    s_waitcnt lgkmcnt(8)
    v_mfma_f32_16x16x32_bf16 v[56:59], v[88:91], a[88:91], v[56:59]
    ds_read_b64_tr_b16 v[84:85], v2 offset:41056
    v_mfma_f32_16x16x32_bf16 v[60:63], v[88:91], a[92:95], v[60:63]
    ds_read_b64_tr_b16 v[86:87], v2 offset:43616
    s_waitcnt lgkmcnt(8)
    v_mfma_f32_16x16x32_bf16 v[64:67], v[92:95], a[88:91], v[64:67]
    ds_read_b64_tr_b16 v[88:89], v2 offset:41088
    v_mfma_f32_16x16x32_bf16 v[68:71], v[92:95], a[92:95], v[68:71]
    ds_read_b64_tr_b16 v[90:91], v2 offset:43648
    s_waitcnt lgkmcnt(8)
    v_mfma_f32_16x16x32_bf16 v[32:35], v[72:75], a[96:99], v[32:35]
    ds_read_b64_tr_b16 v[92:93], v2 offset:46080
    v_mfma_f32_16x16x32_bf16 v[36:39], v[72:75], a[100:103], v[36:39]
    ds_read_b64_tr_b16 v[94:95], v2 offset:48640
    s_waitcnt lgkmcnt(8)
    v_mfma_f32_16x16x32_bf16 v[40:43], v[76:79], a[96:99], v[40:43]
    ds_read_b64_tr_b16 v[72:73], v2 offset:46112
    v_mfma_f32_16x16x32_bf16 v[44:47], v[76:79], a[100:103], v[44:47]
    ds_read_b64_tr_b16 v[74:75], v2 offset:48672
    s_waitcnt lgkmcnt(8)
    v_mfma_f32_16x16x32_bf16 v[48:51], v[80:83], a[96:99], v[48:51]
    ds_read_b64_tr_b16 v[76:77], v2 offset:46144
    v_mfma_f32_16x16x32_bf16 v[52:55], v[80:83], a[100:103], v[52:55]
    ds_read_b64_tr_b16 v[78:79], v2 offset:48704
    s_waitcnt lgkmcnt(8)
    v_mfma_f32_16x16x32_bf16 v[56:59], v[84:87], a[96:99], v[56:59]
    ds_read_b64_tr_b16 v[80:81], v2 offset:46176
    v_mfma_f32_16x16x32_bf16 v[60:63], v[84:87], a[100:103], v[60:63]
    ds_read_b64_tr_b16 v[82:83], v2 offset:48736
    s_waitcnt lgkmcnt(8)
    v_mfma_f32_16x16x32_bf16 v[64:67], v[88:91], a[96:99], v[64:67]
    ds_read_b64_tr_b16 v[84:85], v2 offset:46208
    v_mfma_f32_16x16x32_bf16 v[68:71], v[88:91], a[100:103], v[68:71]
    ds_read_b64_tr_b16 v[86:87], v2 offset:48768
    s_waitcnt lgkmcnt(8)
    v_mfma_f32_16x16x32_bf16 v[32:35], v[92:95], a[104:107], v[32:35]
    ds_read_b64_tr_b16 v[88:89], v2 offset:51200
    v_mfma_f32_16x16x32_bf16 v[36:39], v[92:95], a[108:111], v[36:39]
    ds_read_b64_tr_b16 v[90:91], v2 offset:53760
    s_waitcnt lgkmcnt(8)
    v_mfma_f32_16x16x32_bf16 v[40:43], v[72:75], a[104:107], v[40:43]
    ds_read_b64_tr_b16 v[92:93], v2 offset:51232
    v_mfma_f32_16x16x32_bf16 v[44:47], v[72:75], a[108:111], v[44:47]
    ds_read_b64_tr_b16 v[94:95], v2 offset:53792
    s_waitcnt lgkmcnt(8)
    v_mfma_f32_16x16x32_bf16 v[48:51], v[76:79], a[104:107], v[48:51]
    ds_read_b64_tr_b16 v[72:73], v2 offset:51264
    v_mfma_f32_16x16x32_bf16 v[52:55], v[76:79], a[108:111], v[52:55]
    ds_read_b64_tr_b16 v[74:75], v2 offset:53824
    s_waitcnt lgkmcnt(8)
    v_mfma_f32_16x16x32_bf16 v[56:59], v[80:83], a[104:107], v[56:59]
    ds_read_b64_tr_b16 v[76:77], v2 offset:51296
    v_mfma_f32_16x16x32_bf16 v[60:63], v[80:83], a[108:111], v[60:63]
    ds_read_b64_tr_b16 v[78:79], v2 offset:53856
    s_waitcnt lgkmcnt(8)
    v_mfma_f32_16x16x32_bf16 v[64:67], v[84:87], a[104:107], v[64:67]
    ds_read_b64_tr_b16 v[80:81], v2 offset:51328
    v_mfma_f32_16x16x32_bf16 v[68:71], v[84:87], a[108:111], v[68:71]
    ds_read_b64_tr_b16 v[82:83], v2 offset:53888
    s_waitcnt lgkmcnt(8)
    v_mfma_f32_16x16x32_bf16 v[32:35], v[88:91], a[112:115], v[32:35]
    ds_read_b64_tr_b16 v[84:85], v2 offset:56320
    v_mfma_f32_16x16x32_bf16 v[36:39], v[88:91], a[116:119], v[36:39]
    ds_read_b64_tr_b16 v[86:87], v2 offset:58880
    s_waitcnt lgkmcnt(8)
    v_mfma_f32_16x16x32_bf16 v[40:43], v[92:95], a[112:115], v[40:43]
    ds_read_b64_tr_b16 v[88:89], v2 offset:56352
    v_mfma_f32_16x16x32_bf16 v[44:47], v[92:95], a[116:119], v[44:47]
    ds_read_b64_tr_b16 v[90:91], v2 offset:58912
    s_waitcnt lgkmcnt(8)
    v_mfma_f32_16x16x32_bf16 v[48:51], v[72:75], a[112:115], v[48:51]
    ds_read_b64_tr_b16 v[92:93], v2 offset:56384
    v_mfma_f32_16x16x32_bf16 v[52:55], v[72:75], a[116:119], v[52:55]
    ds_read_b64_tr_b16 v[94:95], v2 offset:58944
    s_waitcnt lgkmcnt(8)
    v_mfma_f32_16x16x32_bf16 v[56:59], v[76:79], a[112:115], v[56:59]
    ds_read_b64_tr_b16 v[72:73], v2 offset:56416
    v_mfma_f32_16x16x32_bf16 v[60:63], v[76:79], a[116:119], v[60:63]
    ds_read_b64_tr_b16 v[74:75], v2 offset:58976
    s_waitcnt lgkmcnt(8)
    v_mfma_f32_16x16x32_bf16 v[64:67], v[80:83], a[112:115], v[64:67]
    ds_read_b64_tr_b16 v[76:77], v2 offset:56448
    v_mfma_f32_16x16x32_bf16 v[68:71], v[80:83], a[116:119], v[68:71]
    ds_read_b64_tr_b16 v[78:79], v2 offset:59008
    s_barrier
    s_waitcnt lgkmcnt(8)
    v_mfma_f32_16x16x32_bf16 v[32:35], v[84:87], a[120:123], v[32:35]
    ds_read_b64_tr_b16 v[80:81], v3 offset:57344
    v_mfma_f32_16x16x32_bf16 v[36:39], v[84:87], a[124:127], v[36:39]
    ds_read_b64_tr_b16 v[82:83], v3 offset:59904
    s_waitcnt lgkmcnt(8)
    v_mfma_f32_16x16x32_bf16 v[40:43], v[88:91], a[120:123], v[40:43]
    ds_read_b64_tr_b16 v[84:85], v3 offset:57376
    v_mfma_f32_16x16x32_bf16 v[44:47], v[88:91], a[124:127], v[44:47]
    ds_read_b64_tr_b16 v[86:87], v3 offset:59936
    s_waitcnt lgkmcnt(8)
    v_mfma_f32_16x16x32_bf16 v[48:51], v[92:95], a[120:123], v[48:51]
    ds_read_b64_tr_b16 v[88:89], v3 offset:57408
    v_mfma_f32_16x16x32_bf16 v[52:55], v[92:95], a[124:127], v[52:55]
    ds_read_b64_tr_b16 v[90:91], v3 offset:59968
    s_waitcnt lgkmcnt(8)
    v_mfma_f32_16x16x32_bf16 v[56:59], v[72:75], a[120:123], v[56:59]
    ds_read_b64_tr_b16 v[92:93], v3 offset:57440
    v_mfma_f32_16x16x32_bf16 v[60:63], v[72:75], a[124:127], v[60:63]
    ds_read_b64_tr_b16 v[94:95], v3 offset:60000
    s_waitcnt lgkmcnt(8)
    v_mfma_f32_16x16x32_bf16 v[64:67], v[76:79], a[120:123], v[64:67]
    ds_read_b64_tr_b16 v[72:73], v3 offset:57472
    v_mfma_f32_16x16x32_bf16 v[68:71], v[76:79], a[124:127], v[68:71]
    ds_read_b64_tr_b16 v[74:75], v3 offset:60032
    s_waitcnt lgkmcnt(8)
    v_mfma_f32_16x16x32_bf16 v[32:35], v[80:83], v[96:99], v[32:35]
    ds_read_b64_tr_b16 v[76:77], v3 offset:62464
    v_mfma_f32_16x16x32_bf16 v[36:39], v[80:83], v[100:103], v[36:39]
    ds_read_b64_tr_b16 v[78:79], v3 offset:65024
    s_waitcnt lgkmcnt(8)
    v_mfma_f32_16x16x32_bf16 v[40:43], v[84:87], v[96:99], v[40:43]
    ds_read_b64_tr_b16 v[80:81], v3 offset:62496
    v_mfma_f32_16x16x32_bf16 v[44:47], v[84:87], v[100:103], v[44:47]
    ds_read_b64_tr_b16 v[82:83], v3 offset:65056
    s_waitcnt lgkmcnt(8)
    v_mfma_f32_16x16x32_bf16 v[48:51], v[88:91], v[96:99], v[48:51]
    ds_read_b64_tr_b16 v[84:85], v3 offset:62528
    v_mfma_f32_16x16x32_bf16 v[52:55], v[88:91], v[100:103], v[52:55]
    ds_read_b64_tr_b16 v[86:87], v3 offset:65088
    s_waitcnt lgkmcnt(8)
    v_mfma_f32_16x16x32_bf16 v[56:59], v[92:95], v[96:99], v[56:59]
    ds_read_b64_tr_b16 v[88:89], v3 offset:62560
    v_mfma_f32_16x16x32_bf16 v[60:63], v[92:95], v[100:103], v[60:63]
    ds_read_b64_tr_b16 v[90:91], v3 offset:65120
    s_waitcnt lgkmcnt(8)
    v_mfma_f32_16x16x32_bf16 v[64:67], v[72:75], v[96:99], v[64:67]
    ds_read_b64_tr_b16 v[92:93], v3 offset:62592
    v_mfma_f32_16x16x32_bf16 v[68:71], v[72:75], v[100:103], v[68:71]
    ds_read_b64_tr_b16 v[94:95], v3 offset:65152
    s_waitcnt lgkmcnt(8)
    v_mfma_f32_16x16x32_bf16 v[32:35], v[76:79], v[104:107], v[32:35]
    ds_read_b64_tr_b16 v[72:73], v4 offset:2048
    v_mfma_f32_16x16x32_bf16 v[36:39], v[76:79], v[108:111], v[36:39]
    ds_read_b64_tr_b16 v[74:75], v4 offset:4608
    s_waitcnt lgkmcnt(8)
    v_mfma_f32_16x16x32_bf16 v[40:43], v[80:83], v[104:107], v[40:43]
    ds_read_b64_tr_b16 v[76:77], v4 offset:2080
    v_mfma_f32_16x16x32_bf16 v[44:47], v[80:83], v[108:111], v[44:47]
    ds_read_b64_tr_b16 v[78:79], v4 offset:4640
    s_waitcnt lgkmcnt(8)
    v_mfma_f32_16x16x32_bf16 v[48:51], v[84:87], v[104:107], v[48:51]
    ds_read_b64_tr_b16 v[80:81], v4 offset:2112
    v_mfma_f32_16x16x32_bf16 v[52:55], v[84:87], v[108:111], v[52:55]
    ds_read_b64_tr_b16 v[82:83], v4 offset:4672
    s_waitcnt lgkmcnt(8)
    v_mfma_f32_16x16x32_bf16 v[56:59], v[88:91], v[104:107], v[56:59]
    ds_read_b64_tr_b16 v[84:85], v4 offset:2144
    v_mfma_f32_16x16x32_bf16 v[60:63], v[88:91], v[108:111], v[60:63]
    ds_read_b64_tr_b16 v[86:87], v4 offset:4704
    s_waitcnt lgkmcnt(8)
    v_mfma_f32_16x16x32_bf16 v[64:67], v[92:95], v[104:107], v[64:67]
    ds_read_b64_tr_b16 v[88:89], v4 offset:2176
    v_mfma_f32_16x16x32_bf16 v[68:71], v[92:95], v[108:111], v[68:71]
    ds_read_b64_tr_b16 v[90:91], v4 offset:4736
    s_waitcnt lgkmcnt(8)
    v_mfma_f32_16x16x32_bf16 v[32:35], v[72:75], v[112:115], v[32:35]
    ds_read_b64_tr_b16 v[92:93], v4 offset:7168
    v_mfma_f32_16x16x32_bf16 v[36:39], v[72:75], v[116:119], v[36:39]
    ds_read_b64_tr_b16 v[94:95], v4 offset:9728
    s_waitcnt lgkmcnt(8)
    v_mfma_f32_16x16x32_bf16 v[40:43], v[76:79], v[112:115], v[40:43]
    ds_read_b64_tr_b16 v[72:73], v4 offset:7200
    v_mfma_f32_16x16x32_bf16 v[44:47], v[76:79], v[116:119], v[44:47]
    ds_read_b64_tr_b16 v[74:75], v4 offset:9760
    s_waitcnt lgkmcnt(8)
    v_mfma_f32_16x16x32_bf16 v[48:51], v[80:83], v[112:115], v[48:51]
    ds_read_b64_tr_b16 v[76:77], v4 offset:7232
    v_mfma_f32_16x16x32_bf16 v[52:55], v[80:83], v[116:119], v[52:55]
    ds_read_b64_tr_b16 v[78:79], v4 offset:9792
    s_waitcnt lgkmcnt(8)
    v_mfma_f32_16x16x32_bf16 v[56:59], v[84:87], v[112:115], v[56:59]
    ds_read_b64_tr_b16 v[80:81], v4 offset:7264
    v_mfma_f32_16x16x32_bf16 v[60:63], v[84:87], v[116:119], v[60:63]
    ds_read_b64_tr_b16 v[82:83], v4 offset:9824
    s_waitcnt lgkmcnt(8)
    v_mfma_f32_16x16x32_bf16 v[64:67], v[88:91], v[112:115], v[64:67]
    ds_read_b64_tr_b16 v[84:85], v4 offset:7296
    v_mfma_f32_16x16x32_bf16 v[68:71], v[88:91], v[116:119], v[68:71]
    ds_read_b64_tr_b16 v[86:87], v4 offset:9856
    s_waitcnt lgkmcnt(8)
    v_mfma_f32_16x16x32_bf16 v[32:35], v[92:95], v[120:123], v[32:35]
    v_mfma_f32_16x16x32_bf16 v[36:39], v[92:95], v[124:127], v[36:39]
    s_waitcnt lgkmcnt(6)
    v_mfma_f32_16x16x32_bf16 v[40:43], v[72:75], v[120:123], v[40:43]
    v_mfma_f32_16x16x32_bf16 v[44:47], v[72:75], v[124:127], v[44:47]
    s_waitcnt lgkmcnt(4)
    v_mfma_f32_16x16x32_bf16 v[48:51], v[76:79], v[120:123], v[48:51]
    v_mfma_f32_16x16x32_bf16 v[52:55], v[76:79], v[124:127], v[52:55]
    s_waitcnt lgkmcnt(2)
    v_mfma_f32_16x16x32_bf16 v[56:59], v[80:83], v[120:123], v[56:59]
    v_mfma_f32_16x16x32_bf16 v[60:63], v[80:83], v[124:127], v[60:63]
    s_waitcnt lgkmcnt(0)
    v_mfma_f32_16x16x32_bf16 v[64:67], v[84:87], v[120:123], v[64:67]
    v_mfma_f32_16x16x32_bf16 v[68:71], v[84:87], v[124:127], v[68:71]
    v_and_b32 v126, 31, v1
    v_lshlrev_b32 v126, 2, v126
    buffer_load_dword v124, v126, s[32:35], s68 offen offset:512 sc1
    v_mov_b32 v80, 0xb5c1a2f1
    v_pk_fma_f32 v[72:73], v[32:33], s[74:75], v[80:81] op_sel_hi:[1,1,0]
    v_pk_fma_f32 v[74:75], v[34:35], s[74:75], v[80:81] op_sel_hi:[1,1,0]
    v_pk_fma_f32 v[76:77], v[36:37], s[74:75], v[80:81] op_sel_hi:[1,1,0]
    v_pk_fma_f32 v[78:79], v[38:39], s[74:75], v[80:81] op_sel_hi:[1,1,0]
    v_exp_f32_e64 v72, v72 clamp
    v_max_f32 v32, 0x358637bd, v32
    v_exp_f32_e64 v73, v73 clamp
    v_max_f32 v33, 0x358637bd, v33
    v_exp_f32_e64 v74, v74 clamp
    v_max_f32 v34, 0x358637bd, v34
    v_exp_f32_e64 v75, v75 clamp
    v_max_f32 v35, 0x358637bd, v35
    v_exp_f32_e64 v76, v76 clamp
    v_max_f32 v36, 0x358637bd, v36
    v_exp_f32_e64 v77, v77 clamp
    v_max_f32 v37, 0x358637bd, v37
    v_exp_f32_e64 v78, v78 clamp
    v_max_f32 v38, 0x358637bd, v38
    v_exp_f32_e64 v79, v79 clamp
    v_max_f32 v39, 0x358637bd, v39
    v_pk_add_f32 v[32:33], v[32:33], v[72:73]
    v_pk_add_f32 v[34:35], v[34:35], v[74:75]
    v_pk_add_f32 v[36:37], v[36:37], v[76:77]
    v_pk_add_f32 v[38:39], v[38:39], v[78:79]
    v_pk_fma_f32 v[72:73], v[40:41], s[74:75], v[80:81] op_sel_hi:[1,1,0]
    v_pk_fma_f32 v[74:75], v[42:43], s[74:75], v[80:81] op_sel_hi:[1,1,0]
    v_pk_fma_f32 v[76:77], v[44:45], s[74:75], v[80:81] op_sel_hi:[1,1,0]
    v_pk_fma_f32 v[78:79], v[46:47], s[74:75], v[80:81] op_sel_hi:[1,1,0]
    v_exp_f32_e64 v72, v72 clamp
    v_max_f32 v40, 0x358637bd, v40
    v_exp_f32_e64 v73, v73 clamp
    v_max_f32 v41, 0x358637bd, v41
    v_exp_f32_e64 v74, v74 clamp
    v_max_f32 v42, 0x358637bd, v42
    v_exp_f32_e64 v75, v75 clamp
    v_max_f32 v43, 0x358637bd, v43
    v_exp_f32_e64 v76, v76 clamp
    v_max_f32 v44, 0x358637bd, v44
    v_exp_f32_e64 v77, v77 clamp
    v_max_f32 v45, 0x358637bd, v45
    v_exp_f32_e64 v78, v78 clamp
    v_max_f32 v46, 0x358637bd, v46
    v_exp_f32_e64 v79, v79 clamp
    v_max_f32 v47, 0x358637bd, v47
    v_pk_add_f32 v[40:41], v[40:41], v[72:73]
    v_pk_add_f32 v[42:43], v[42:43], v[74:75]
    v_pk_add_f32 v[44:45], v[44:45], v[76:77]
    v_pk_add_f32 v[46:47], v[46:47], v[78:79]
    v_pk_fma_f32 v[72:73], v[48:49], s[74:75], v[80:81] op_sel_hi:[1,1,0]
    v_pk_fma_f32 v[74:75], v[50:51], s[74:75], v[80:81] op_sel_hi:[1,1,0]
    v_pk_fma_f32 v[76:77], v[52:53], s[74:75], v[80:81] op_sel_hi:[1,1,0]
    v_pk_fma_f32 v[78:79], v[54:55], s[74:75], v[80:81] op_sel_hi:[1,1,0]
    v_exp_f32_e64 v72, v72 clamp
    v_max_f32 v48, 0x358637bd, v48
    v_exp_f32_e64 v73, v73 clamp
    v_max_f32 v49, 0x358637bd, v49
    v_exp_f32_e64 v74, v74 clamp
    v_max_f32 v50, 0x358637bd, v50
    v_exp_f32_e64 v75, v75 clamp
    v_max_f32 v51, 0x358637bd, v51
    v_exp_f32_e64 v76, v76 clamp
    v_max_f32 v52, 0x358637bd, v52
    v_exp_f32_e64 v77, v77 clamp
    v_max_f32 v53, 0x358637bd, v53
    v_exp_f32_e64 v78, v78 clamp
    v_max_f32 v54, 0x358637bd, v54
    v_exp_f32_e64 v79, v79 clamp
    v_max_f32 v55, 0x358637bd, v55
    v_pk_add_f32 v[48:49], v[48:49], v[72:73]
    v_pk_add_f32 v[50:51], v[50:51], v[74:75]
    v_pk_add_f32 v[52:53], v[52:53], v[76:77]
    v_pk_add_f32 v[54:55], v[54:55], v[78:79]
    v_pk_fma_f32 v[72:73], v[56:57], s[74:75], v[80:81] op_sel_hi:[1,1,0]
    v_pk_fma_f32 v[74:75], v[58:59], s[74:75], v[80:81] op_sel_hi:[1,1,0]
    v_pk_fma_f32 v[76:77], v[60:61], s[74:75], v[80:81] op_sel_hi:[1,1,0]
    v_pk_fma_f32 v[78:79], v[62:63], s[74:75], v[80:81] op_sel_hi:[1,1,0]
    v_exp_f32_e64 v72, v72 clamp
    v_max_f32 v56, 0x358637bd, v56
    v_exp_f32_e64 v73, v73 clamp
    v_max_f32 v57, 0x358637bd, v57
    v_exp_f32_e64 v74, v74 clamp
    v_max_f32 v58, 0x358637bd, v58
    v_exp_f32_e64 v75, v75 clamp
    v_max_f32 v59, 0x358637bd, v59
    v_exp_f32_e64 v76, v76 clamp
    v_max_f32 v60, 0x358637bd, v60
    v_exp_f32_e64 v77, v77 clamp
    v_max_f32 v61, 0x358637bd, v61
    v_exp_f32_e64 v78, v78 clamp
    v_max_f32 v62, 0x358637bd, v62
    v_exp_f32_e64 v79, v79 clamp
    v_max_f32 v63, 0x358637bd, v63
    v_pk_add_f32 v[56:57], v[56:57], v[72:73]
    v_pk_add_f32 v[58:59], v[58:59], v[74:75]
    v_pk_add_f32 v[60:61], v[60:61], v[76:77]
    v_pk_add_f32 v[62:63], v[62:63], v[78:79]
    v_pk_fma_f32 v[72:73], v[64:65], s[74:75], v[80:81] op_sel_hi:[1,1,0]
    v_pk_fma_f32 v[74:75], v[66:67], s[74:75], v[80:81] op_sel_hi:[1,1,0]
    v_pk_fma_f32 v[76:77], v[68:69], s[74:75], v[80:81] op_sel_hi:[1,1,0]
    v_pk_fma_f32 v[78:79], v[70:71], s[74:75], v[80:81] op_sel_hi:[1,1,0]
    v_exp_f32_e64 v72, v72 clamp
    v_max_f32 v64, 0x358637bd, v64
    v_exp_f32_e64 v73, v73 clamp
    v_max_f32 v65, 0x358637bd, v65
    v_exp_f32_e64 v74, v74 clamp
    v_max_f32 v66, 0x358637bd, v66
    v_exp_f32_e64 v75, v75 clamp
    v_max_f32 v67, 0x358637bd, v67
    v_exp_f32_e64 v76, v76 clamp
    v_max_f32 v68, 0x358637bd, v68
    v_exp_f32_e64 v77, v77 clamp
    v_max_f32 v69, 0x358637bd, v69
    v_exp_f32_e64 v78, v78 clamp
    v_max_f32 v70, 0x358637bd, v70
    v_exp_f32_e64 v79, v79 clamp
    v_max_f32 v71, 0x358637bd, v71
    v_pk_add_f32 v[64:65], v[64:65], v[72:73]
    v_pk_add_f32 v[66:67], v[66:67], v[74:75]
    v_pk_add_f32 v[68:69], v[68:69], v[76:77]
    v_pk_add_f32 v[70:71], v[70:71], v[78:79]
    v_cvt_pk_bf16_f32 v32, v32, v33
    v_cvt_pk_bf16_f32 v33, v34, v35
    ds_write_b64 v22, v[32:33] offset:0
    v_cvt_pk_bf16_f32 v36, v36, v37
    v_cvt_pk_bf16_f32 v37, v38, v39
    ds_write_b64 v22, v[36:37] offset:640
    v_cvt_pk_bf16_f32 v40, v40, v41
    v_cvt_pk_bf16_f32 v41, v42, v43
    ds_write_b64 v23, v[40:41] offset:0
    v_cvt_pk_bf16_f32 v44, v44, v45
    v_cvt_pk_bf16_f32 v45, v46, v47
    ds_write_b64 v23, v[44:45] offset:640
    v_cvt_pk_bf16_f32 v48, v48, v49
    v_cvt_pk_bf16_f32 v49, v50, v51
    ds_write_b64 v24, v[48:49] offset:0
    v_cvt_pk_bf16_f32 v52, v52, v53
    v_cvt_pk_bf16_f32 v53, v54, v55
    ds_write_b64 v24, v[52:53] offset:640
    v_cvt_pk_bf16_f32 v56, v56, v57
    v_cvt_pk_bf16_f32 v57, v58, v59
    ds_write_b64 v25, v[56:57] offset:0
    v_cvt_pk_bf16_f32 v60, v60, v61
    v_cvt_pk_bf16_f32 v61, v62, v63
    ds_write_b64 v25, v[60:61] offset:640
    v_cvt_pk_bf16_f32 v64, v64, v65
    v_cvt_pk_bf16_f32 v65, v66, v67
    ds_write_b64 v26, v[64:65] offset:0
    v_cvt_pk_bf16_f32 v68, v68, v69
    v_cvt_pk_bf16_f32 v69, v70, v71
    ds_write_b64 v26, v[68:69] offset:640
    ds_read_b64 v[78:79], v5 offset:0
    ds_read_b64 v[80:81], v5 offset:8
    ds_read_b64 v[82:83], v6 offset:0
    ds_read_b64 v[90:91], v5 offset:5120
    ds_read_b64 v[92:93], v5 offset:5128
    ds_read_b64 v[94:95], v6 offset:5120
    v_and_b32 v117, 15, v1
    v_lshlrev_b32 v117, 2, v117
    v_and_b32 v119, 56, v117
    s_getreg_b32 s57, hwreg(HW_REG_XCC_ID)
    s_and_b32 s57, s57, 15
    s_add_u32 s57, s57, 1
    s_mov_b32 s61, 0
    s_waitcnt vmcnt(0)
    v_cmp_ne_u32 vcc, s57, v124
    s_cbranch_vccnz L_hsBb_slow
L_hsBb_ok:
    s_waitcnt lgkmcnt(0)
    s_barrier
    s_setprio 1
    ds_read_b128 v[96:99], v9 offset:0
    ds_read_b64 v[100:101], v11 offset:0
    ds_read_b128 v[106:109], v9 offset:1792
    ds_read_b64 v[110:111], v11 offset:1792
    s_waitcnt lgkmcnt(3)
    v_mfma_f32_32x32x16_bf16 v[32:47], v[96:99], v[78:81], 0
    s_waitcnt lgkmcnt(2)
    v_mfma_f32_32x32x8_bf16 v[32:47], v[100:101], v[82:83], v[32:47]
    s_waitcnt lgkmcnt(1)
    v_mfma_f32_32x32x16_bf16 v[48:63], v[106:109], v[90:93], 0
    s_waitcnt lgkmcnt(0)
    v_mfma_f32_32x32x8_bf16 v[48:63], v[110:111], v[94:95], v[48:63]
    s_nop 7
    v_add_f32 v44, 0x358637bd, v44
    v_rcp_f32 v44, v44
    s_nop 0
    v_pk_mul_f32 v[32:33], v[32:33], v[44:45] op_sel_hi:[1,0]
    v_pk_mul_f32 v[34:35], v[34:35], v[44:45] op_sel_hi:[1,0]
    v_pk_mul_f32 v[36:37], v[36:37], v[44:45] op_sel_hi:[1,0]
    v_pk_mul_f32 v[38:39], v[38:39], v[44:45] op_sel_hi:[1,0]
    v_pk_mul_f32 v[40:41], v[40:41], v[44:45] op_sel_hi:[1,0]
    v_pk_mul_f32 v[42:43], v[42:43], v[44:45] op_sel_hi:[1,0]
    v_cvt_pk_bf16_f32 v64, v32, v33
    v_cvt_pk_bf16_f32 v65, v34, v35
    v_cvt_pk_bf16_f32 v66, v36, v37
    v_cvt_pk_bf16_f32 v67, v38, v39
    v_cvt_pk_bf16_f32 v120, v40, v41
    v_cvt_pk_bf16_f32 v121, v42, v43
    v_add_f32 v60, 0x358637bd, v60
    v_rcp_f32 v60, v60
    s_nop 0
    v_pk_mul_f32 v[48:49], v[48:49], v[60:61] op_sel_hi:[1,0]
    v_pk_mul_f32 v[50:51], v[50:51], v[60:61] op_sel_hi:[1,0]
    v_pk_mul_f32 v[52:53], v[52:53], v[60:61] op_sel_hi:[1,0]
    v_pk_mul_f32 v[54:55], v[54:55], v[60:61] op_sel_hi:[1,0]
    v_pk_mul_f32 v[56:57], v[56:57], v[60:61] op_sel_hi:[1,0]
    v_pk_mul_f32 v[58:59], v[58:59], v[60:61] op_sel_hi:[1,0]
    v_cvt_pk_bf16_f32 v68, v48, v49
    v_cvt_pk_bf16_f32 v69, v50, v51
    v_cvt_pk_bf16_f32 v70, v52, v53
    v_cvt_pk_bf16_f32 v71, v54, v55
    v_permlane16_swap_b32 v64, v68
    v_permlane16_swap_b32 v65, v69
    v_permlane16_swap_b32 v66, v70
    v_permlane16_swap_b32 v67, v71
    v_cvt_pk_bf16_f32 v122, v56, v57
    v_cvt_pk_bf16_f32 v123, v58, v59
    s_cmp_eq_u32 s61, 0
    s_cbranch_scc0 L_o1Bb_far
    buffer_store_dwordx4 v[64:67], v7, s[36:39], s62 offen
    buffer_store_dwordx4 v[68:71], v15, s[36:39], s62 offen
    buffer_store_dwordx4 v[120:123], v13, s[36:39], s62 offen offset:1024
L_o1Bb_st:
    v_accvgpr_write_b32 a0, v64
    v_accvgpr_write_b32 a1, v65
    v_accvgpr_write_b32 a2, v66
    v_accvgpr_write_b32 a3, v67
    v_accvgpr_write_b32 a4, v68
    v_accvgpr_write_b32 a5, v69
    v_accvgpr_write_b32 a6, v70
    v_accvgpr_write_b32 a7, v71
    ds_read_b64_tr_b16 a[80:81], v2 offset:61440
    ds_read_b64_tr_b16 a[82:83], v2 offset:64000
    ds_read_b64_tr_b16 a[84:85], v2 offset:61472
    ds_read_b64_tr_b16 a[86:87], v2 offset:64032
    ds_read_b64_tr_b16 a[88:89], v2 offset:61504
    ds_read_b64_tr_b16 a[90:91], v2 offset:64064
    ds_read_b64_tr_b16 a[92:93], v2 offset:61536
    ds_read_b64_tr_b16 a[94:95], v2 offset:64096
    ds_read_b64_tr_b16 a[96:97], v2 offset:61568
    ds_read_b64_tr_b16 a[98:99], v2 offset:64128
    ds_read_b64_tr_b16 a[100:101], v3 offset:1024
    ds_read_b64_tr_b16 a[102:103], v3 offset:3584
    s_waitcnt vmcnt(0)
    v_mov_b32 v116, 1
    s_cmp_eq_u32 s61, 0
    s_cbranch_scc0 L_s2Bb_far
    s_mov_b64 exec, 1
    buffer_store_dword v116, off, s[32:35], s58 offset:1028
    s_mov_b64 exec, -1
L_s2Bb_st:
    ds_read_b64_tr_b16 a[104:105], v3 offset:1056
    ds_read_b64_tr_b16 a[106:107], v3 offset:3616
    ds_read_b64_tr_b16 a[108:109], v3 offset:1088
    ds_read_b64_tr_b16 a[110:111], v3 offset:3648
    ds_read_b64_tr_b16 a[112:113], v3 offset:1120
    ds_read_b64_tr_b16 a[114:115], v3 offset:3680
    ds_read_b64_tr_b16 a[116:117], v3 offset:1152
    ds_read_b64_tr_b16 a[118:119], v3 offset:3712
    ds_read_b64_tr_b16 a[120:121], v3 offset:6144
    ds_read_b64_tr_b16 a[122:123], v3 offset:8704
    ds_read_b64_tr_b16 a[124:125], v3 offset:6176
    ds_read_b64_tr_b16 a[126:127], v3 offset:8736
    ds_read_b64_tr_b16 v[96:97], v3 offset:6208
    ds_read_b64_tr_b16 v[98:99], v3 offset:8768
    ds_read_b64_tr_b16 v[100:101], v3 offset:6240
    ds_read_b64_tr_b16 v[102:103], v3 offset:8800
    buffer_load_dword v118, v119, s[32:35], s69 offen offset:1028 sc1
    ds_read_b64_tr_b16 v[104:105], v3 offset:6272
    ds_read_b64_tr_b16 v[106:107], v3 offset:8832
    ds_read_b64_tr_b16 v[108:109], v3 offset:11264
    ds_read_b64_tr_b16 v[110:111], v3 offset:13824
    ds_read_b64_tr_b16 v[112:113], v3 offset:11296
    ds_read_b64_tr_b16 v[114:115], v3 offset:13856
    ds_read_b64_tr_b16 v[72:73], v3 offset:11328
    ds_read_b64_tr_b16 v[74:75], v3 offset:13888
    ds_read_b64_tr_b16 v[76:77], v3 offset:11360
    ds_read_b64_tr_b16 v[78:79], v3 offset:13920
    ds_read_b64_tr_b16 v[80:81], v3 offset:11392
    ds_read_b64_tr_b16 v[82:83], v3 offset:13952
    ds_read_b64_tr_b16 v[84:85], v3 offset:16384
    ds_read_b64_tr_b16 v[86:87], v3 offset:18944
    ds_read_b64_tr_b16 v[88:89], v3 offset:16416
    ds_read_b64_tr_b16 v[90:91], v3 offset:18976
    s_waitcnt vmcnt(0)
    v_cmp_eq_u32 vcc, 0, v118
    s_cbranch_vccz L_f2Bb_ok
    s_mov_b32 s67, 0
L_f2Bb:
    buffer_load_dword v118, v119, s[32:35], s69 offen offset:1028 sc1
    s_add_u32 s67, s67, 1
    s_waitcnt vmcnt(0)
    v_cmp_eq_u32 vcc, 0, v118
    s_cmpk_ge_u32 s67, 20000
    s_cbranch_scc1 L_f2Bb_ok
    s_cbranch_vccnz L_f2Bb
L_f2Bb_ok:
    buffer_load_dwordx4 a[8:11], v7, s[36:39], s25 offen sc1
    buffer_load_dwordx4 a[12:15], v15, s[36:39], s25 offen sc1
    buffer_load_dwordx4 a[16:19], v7, s[36:39], s26 offen sc1
    buffer_load_dwordx4 a[20:23], v15, s[36:39], s26 offen sc1
    buffer_load_dwordx4 a[24:27], v7, s[36:39], s27 offen sc1
    buffer_load_dwordx4 a[28:31], v15, s[36:39], s27 offen sc1
    buffer_load_dwordx4 a[32:35], v7, s[36:39], s40 offen sc1
    buffer_load_dwordx4 a[36:39], v15, s[36:39], s40 offen sc1
    s_barrier
    s_waitcnt lgkmcnt(0)
    v_mfma_f32_16x16x32_bf16 v[32:35], a[80:83], a[0:3], 0
    v_mfma_f32_16x16x32_bf16 v[36:39], a[80:83], a[4:7], 0
    v_mfma_f32_16x16x32_bf16 v[40:43], a[84:87], a[0:3], 0
    v_mfma_f32_16x16x32_bf16 v[44:47], a[84:87], a[4:7], 0
    buffer_load_dwordx4 a[40:43], v7, s[36:39], s41 offen sc1
    v_mfma_f32_16x16x32_bf16 v[48:51], a[88:91], a[0:3], 0
    v_mfma_f32_16x16x32_bf16 v[52:55], a[88:91], a[4:7], 0
    v_mfma_f32_16x16x32_bf16 v[56:59], a[92:95], a[0:3], 0
    v_mfma_f32_16x16x32_bf16 v[60:63], a[92:95], a[4:7], 0
    buffer_load_dwordx4 a[44:47], v15, s[36:39], s41 offen sc1
    v_mfma_f32_16x16x32_bf16 v[64:67], a[96:99], a[0:3], 0
    v_mfma_f32_16x16x32_bf16 v[68:71], a[96:99], a[4:7], 0
    s_waitcnt vmcnt(9)
    v_mfma_f32_16x16x32_bf16 v[32:35], a[100:103], a[8:11], v[32:35]
    s_waitcnt vmcnt(8)
    v_mfma_f32_16x16x32_bf16 v[36:39], a[100:103], a[12:15], v[36:39]
    v_mfma_f32_16x16x32_bf16 v[40:43], a[104:107], a[8:11], v[40:43]
    v_mfma_f32_16x16x32_bf16 v[44:47], a[104:107], a[12:15], v[44:47]
    buffer_load_dwordx4 a[48:51], v7, s[36:39], s42 offen sc1
    v_mfma_f32_16x16x32_bf16 v[48:51], a[108:111], a[8:11], v[48:51]
    v_mfma_f32_16x16x32_bf16 v[52:55], a[108:111], a[12:15], v[52:55]
    v_mfma_f32_16x16x32_bf16 v[56:59], a[112:115], a[8:11], v[56:59]
    v_mfma_f32_16x16x32_bf16 v[60:63], a[112:115], a[12:15], v[60:63]
    buffer_load_dwordx4 a[52:55], v15, s[36:39], s42 offen sc1
    v_mfma_f32_16x16x32_bf16 v[64:67], a[116:119], a[8:11], v[64:67]
    v_mfma_f32_16x16x32_bf16 v[68:71], a[116:119], a[12:15], v[68:71]
    s_waitcnt vmcnt(9)
    v_mfma_f32_16x16x32_bf16 v[32:35], a[120:123], a[16:19], v[32:35]
    s_waitcnt vmcnt(8)
    v_mfma_f32_16x16x32_bf16 v[36:39], a[120:123], a[20:23], v[36:39]
    v_mfma_f32_16x16x32_bf16 v[40:43], a[124:127], a[16:19], v[40:43]
    v_mfma_f32_16x16x32_bf16 v[44:47], a[124:127], a[20:23], v[44:47]
    buffer_load_dwordx4 a[56:59], v7, s[36:39], s43 offen sc1
    v_mfma_f32_16x16x32_bf16 v[48:51], v[96:99], a[16:19], v[48:51]
    v_mfma_f32_16x16x32_bf16 v[52:55], v[96:99], a[20:23], v[52:55]
    v_mfma_f32_16x16x32_bf16 v[56:59], v[100:103], a[16:19], v[56:59]
    v_mfma_f32_16x16x32_bf16 v[60:63], v[100:103], a[20:23], v[60:63]
    buffer_load_dwordx4 a[60:63], v15, s[36:39], s43 offen sc1
    v_mfma_f32_16x16x32_bf16 v[64:67], v[104:107], a[16:19], v[64:67]
    v_mfma_f32_16x16x32_bf16 v[68:71], v[104:107], a[20:23], v[68:71]
    s_waitcnt vmcnt(9)
    v_mfma_f32_16x16x32_bf16 v[32:35], v[108:111], a[24:27], v[32:35]
    s_waitcnt vmcnt(8)
    v_mfma_f32_16x16x32_bf16 v[36:39], v[108:111], a[28:31], v[36:39]
    v_mfma_f32_16x16x32_bf16 v[40:43], v[112:115], a[24:27], v[40:43]
    v_mfma_f32_16x16x32_bf16 v[44:47], v[112:115], a[28:31], v[44:47]
    buffer_load_dwordx4 a[64:67], v16, s[36:39], s44 offen offset:1024 sc1
    v_mfma_f32_16x16x32_bf16 v[48:51], v[72:75], a[24:27], v[48:51]
    ds_read_b64_tr_b16 v[92:93], v3 offset:16448
    v_mfma_f32_16x16x32_bf16 v[52:55], v[72:75], a[28:31], v[52:55]
    ds_read_b64_tr_b16 v[94:95], v3 offset:19008
    v_mfma_f32_16x16x32_bf16 v[56:59], v[76:79], a[24:27], v[56:59]
    ds_read_b64_tr_b16 v[72:73], v3 offset:16480
    buffer_load_dwordx4 a[68:71], v17, s[36:39], s44 offen offset:1024 sc1
    v_mfma_f32_16x16x32_bf16 v[60:63], v[76:79], a[28:31], v[60:63]
    ds_read_b64_tr_b16 v[74:75], v3 offset:19040
    v_mfma_f32_16x16x32_bf16 v[64:67], v[80:83], a[24:27], v[64:67]
    ds_read_b64_tr_b16 v[76:77], v3 offset:16512
    v_mfma_f32_16x16x32_bf16 v[68:71], v[80:83], a[28:31], v[68:71]
    ds_read_b64_tr_b16 v[78:79], v3 offset:19072
    s_waitcnt vmcnt(9)
    v_mfma_f32_16x16x32_bf16 v[32:35], v[84:87], a[32:35], v[32:35]
    ds_read_b64_tr_b16 v[80:81], v3 offset:21504
    s_waitcnt vmcnt(8)
    v_mfma_f32_16x16x32_bf16 v[36:39], v[84:87], a[36:39], v[36:39]
    ds_read_b64_tr_b16 v[82:83], v3 offset:24064
    v_mfma_f32_16x16x32_bf16 v[40:43], v[88:91], a[32:35], v[40:43]
    ds_read_b64_tr_b16 v[84:85], v3 offset:21536
    buffer_load_dwordx4 a[72:75], v16, s[36:39], s45 offen offset:1024 sc1
    v_mfma_f32_16x16x32_bf16 v[44:47], v[88:91], a[36:39], v[44:47]
    ds_read_b64_tr_b16 v[86:87], v3 offset:24096
    s_waitcnt lgkmcnt(8)
    v_mfma_f32_16x16x32_bf16 v[48:51], v[92:95], a[32:35], v[48:51]
    ds_read_b64_tr_b16 v[88:89], v3 offset:21568
    v_mfma_f32_16x16x32_bf16 v[52:55], v[92:95], a[36:39], v[52:55]
    ds_read_b64_tr_b16 v[90:91], v3 offset:24128
    s_waitcnt lgkmcnt(8)
    v_mfma_f32_16x16x32_bf16 v[56:59], v[72:75], a[32:35], v[56:59]
    ds_read_b64_tr_b16 v[92:93], v3 offset:21600
    buffer_load_dwordx4 a[76:79], v17, s[36:39], s45 offen offset:1024 sc1
    v_mfma_f32_16x16x32_bf16 v[60:63], v[72:75], a[36:39], v[60:63]
    ds_read_b64_tr_b16 v[94:95], v3 offset:24160
    s_waitcnt lgkmcnt(8)
    v_mfma_f32_16x16x32_bf16 v[64:67], v[76:79], a[32:35], v[64:67]
    ds_read_b64_tr_b16 v[72:73], v3 offset:21632
    v_mfma_f32_16x16x32_bf16 v[68:71], v[76:79], a[36:39], v[68:71]
    ds_read_b64_tr_b16 v[74:75], v3 offset:24192
    s_waitcnt vmcnt(9) lgkmcnt(8)
    v_mfma_f32_16x16x32_bf16 v[32:35], v[80:83], a[40:43], v[32:35]
    ds_read_b64_tr_b16 v[76:77], v3 offset:26624
    s_waitcnt vmcnt(8)
    v_mfma_f32_16x16x32_bf16 v[36:39], v[80:83], a[44:47], v[36:39]
    ds_read_b64_tr_b16 v[78:79], v3 offset:29184
    s_waitcnt lgkmcnt(8)
    v_mfma_f32_16x16x32_bf16 v[40:43], v[84:87], a[40:43], v[40:43]
    ds_read_b64_tr_b16 v[80:81], v3 offset:26656
    v_mfma_f32_16x16x32_bf16 v[44:47], v[84:87], a[44:47], v[44:47]
    ds_read_b64_tr_b16 v[82:83], v3 offset:29216
    s_waitcnt lgkmcnt(8)
    v_mfma_f32_16x16x32_bf16 v[48:51], v[88:91], a[40:43], v[48:51]
    ds_read_b64_tr_b16 v[84:85], v3 offset:26688
    v_mfma_f32_16x16x32_bf16 v[52:55], v[88:91], a[44:47], v[52:55]
    ds_read_b64_tr_b16 v[86:87], v3 offset:29248
    s_waitcnt lgkmcnt(8)
    v_mfma_f32_16x16x32_bf16 v[56:59], v[92:95], a[40:43], v[56:59]
    ds_read_b64_tr_b16 v[88:89], v3 offset:26720
    v_mfma_f32_16x16x32_bf16 v[60:63], v[92:95], a[44:47], v[60:63]
    ds_read_b64_tr_b16 v[90:91], v3 offset:29280
    s_waitcnt lgkmcnt(8)
    v_mfma_f32_16x16x32_bf16 v[64:67], v[72:75], a[40:43], v[64:67]
    ds_read_b64_tr_b16 v[92:93], v3 offset:26752
    v_mfma_f32_16x16x32_bf16 v[68:71], v[72:75], a[44:47], v[68:71]
    ds_read_b64_tr_b16 v[94:95], v3 offset:29312
    s_waitcnt vmcnt(7) lgkmcnt(8)
    v_mfma_f32_16x16x32_bf16 v[32:35], v[76:79], a[48:51], v[32:35]
    ds_read_b64_tr_b16 v[72:73], v3 offset:31744
    s_waitcnt vmcnt(6)
    v_mfma_f32_16x16x32_bf16 v[36:39], v[76:79], a[52:55], v[36:39]
    ds_read_b64_tr_b16 v[74:75], v3 offset:34304
    s_waitcnt lgkmcnt(8)
    v_mfma_f32_16x16x32_bf16 v[40:43], v[80:83], a[48:51], v[40:43]
    ds_read_b64_tr_b16 v[76:77], v3 offset:31776
    v_mfma_f32_16x16x32_bf16 v[44:47], v[80:83], a[52:55], v[44:47]
    ds_read_b64_tr_b16 v[78:79], v3 offset:34336
    s_waitcnt lgkmcnt(8)
    v_mfma_f32_16x16x32_bf16 v[48:51], v[84:87], a[48:51], v[48:51]
    ds_read_b64_tr_b16 v[80:81], v3 offset:31808
    v_mfma_f32_16x16x32_bf16 v[52:55], v[84:87], a[52:55], v[52:55]
    ds_read_b64_tr_b16 v[82:83], v3 offset:34368
    s_waitcnt lgkmcnt(8)
    v_mfma_f32_16x16x32_bf16 v[56:59], v[88:91], a[48:51], v[56:59]
    ds_read_b64_tr_b16 v[84:85], v3 offset:31840
    v_mfma_f32_16x16x32_bf16 v[60:63], v[88:91], a[52:55], v[60:63]
    ds_read_b64_tr_b16 v[86:87], v3 offset:34400
    s_waitcnt lgkmcnt(8)
    v_mfma_f32_16x16x32_bf16 v[64:67], v[92:95], a[48:51], v[64:67]
    ds_read_b64_tr_b16 v[88:89], v3 offset:31872
    v_mfma_f32_16x16x32_bf16 v[68:71], v[92:95], a[52:55], v[68:71]
    ds_read_b64_tr_b16 v[90:91], v3 offset:34432
    s_waitcnt vmcnt(5) lgkmcnt(8)
    v_mfma_f32_16x16x32_bf16 v[32:35], v[72:75], a[56:59], v[32:35]
    ds_read_b64_tr_b16 v[92:93], v2 offset:0
    s_waitcnt vmcnt(4)
    v_mfma_f32_16x16x32_bf16 v[36:39], v[72:75], a[60:63], v[36:39]
    ds_read_b64_tr_b16 v[94:95], v2 offset:2560
    s_waitcnt lgkmcnt(8)
    v_mfma_f32_16x16x32_bf16 v[40:43], v[76:79], a[56:59], v[40:43]
    ds_read_b64_tr_b16 v[72:73], v2 offset:32
    v_mfma_f32_16x16x32_bf16 v[44:47], v[76:79], a[60:63], v[44:47]
    ds_read_b64_tr_b16 v[74:75], v2 offset:2592
    s_waitcnt lgkmcnt(8)
    v_mfma_f32_16x16x32_bf16 v[48:51], v[80:83], a[56:59], v[48:51]
    ds_read_b64_tr_b16 v[76:77], v2 offset:64
    v_mfma_f32_16x16x32_bf16 v[52:55], v[80:83], a[60:63], v[52:55]
    ds_read_b64_tr_b16 v[78:79], v2 offset:2624
    s_waitcnt lgkmcnt(8)
    v_mfma_f32_16x16x32_bf16 v[56:59], v[84:87], a[56:59], v[56:59]
    ds_read_b64_tr_b16 v[80:81], v2 offset:96
    v_mfma_f32_16x16x32_bf16 v[60:63], v[84:87], a[60:63], v[60:63]
    ds_read_b64_tr_b16 v[82:83], v2 offset:2656
    s_waitcnt lgkmcnt(8)
    v_mfma_f32_16x16x32_bf16 v[64:67], v[88:91], a[56:59], v[64:67]
    ds_read_b64_tr_b16 v[84:85], v2 offset:128
    v_mfma_f32_16x16x32_bf16 v[68:71], v[88:91], a[60:63], v[68:71]
    ds_read_b64_tr_b16 v[86:87], v2 offset:2688
    s_waitcnt vmcnt(0)
    v_mov_b32 v116, 1
    s_cmp_eq_u32 s61, 0
    s_cbranch_scc0 L_s3Bb_far
    s_mov_b64 exec, 1
    buffer_store_dword v116, off, s[32:35], s58 offset:2052
    s_mov_b64 exec, -1
L_s3Bb_st:
    s_waitcnt lgkmcnt(8)
    v_mfma_f32_16x16x32_bf16 v[32:35], v[92:95], a[64:67], v[32:35]
    ds_read_b64_tr_b16 v[88:89], v2 offset:5120
    v_mfma_f32_16x16x32_bf16 v[36:39], v[92:95], a[68:71], v[36:39]
    ds_read_b64_tr_b16 v[90:91], v2 offset:7680
    s_waitcnt lgkmcnt(8)
    v_mfma_f32_16x16x32_bf16 v[40:43], v[72:75], a[64:67], v[40:43]
    ds_read_b64_tr_b16 v[92:93], v2 offset:5152
    v_mfma_f32_16x16x32_bf16 v[44:47], v[72:75], a[68:71], v[44:47]
    ds_read_b64_tr_b16 v[94:95], v2 offset:7712
    s_waitcnt lgkmcnt(8)
    v_mfma_f32_16x16x32_bf16 v[48:51], v[76:79], a[64:67], v[48:51]
    ds_read_b64_tr_b16 v[72:73], v2 offset:5184
    v_mfma_f32_16x16x32_bf16 v[52:55], v[76:79], a[68:71], v[52:55]
    ds_read_b64_tr_b16 v[74:75], v2 offset:7744
    s_waitcnt lgkmcnt(8)
    v_mfma_f32_16x16x32_bf16 v[56:59], v[80:83], a[64:67], v[56:59]
    ds_read_b64_tr_b16 v[76:77], v2 offset:5216
    v_mfma_f32_16x16x32_bf16 v[60:63], v[80:83], a[68:71], v[60:63]
    ds_read_b64_tr_b16 v[78:79], v2 offset:7776
    s_waitcnt lgkmcnt(8)
    v_mfma_f32_16x16x32_bf16 v[64:67], v[84:87], a[64:67], v[64:67]
    ds_read_b64_tr_b16 v[80:81], v2 offset:5248
    v_mfma_f32_16x16x32_bf16 v[68:71], v[84:87], a[68:71], v[68:71]
    ds_read_b64_tr_b16 v[82:83], v2 offset:7808
    s_waitcnt lgkmcnt(8)
    v_mfma_f32_16x16x32_bf16 v[32:35], v[88:91], a[72:75], v[32:35]
    v_mfma_f32_16x16x32_bf16 v[36:39], v[88:91], a[76:79], v[36:39]
    s_waitcnt lgkmcnt(6)
    v_mfma_f32_16x16x32_bf16 v[40:43], v[92:95], a[72:75], v[40:43]
    v_mfma_f32_16x16x32_bf16 v[44:47], v[92:95], a[76:79], v[44:47]
    s_waitcnt lgkmcnt(4)
    v_mfma_f32_16x16x32_bf16 v[48:51], v[72:75], a[72:75], v[48:51]
    v_mfma_f32_16x16x32_bf16 v[52:55], v[72:75], a[76:79], v[52:55]
    s_waitcnt lgkmcnt(2)
    v_mfma_f32_16x16x32_bf16 v[56:59], v[76:79], a[72:75], v[56:59]
    v_mfma_f32_16x16x32_bf16 v[60:63], v[76:79], a[76:79], v[60:63]
    s_waitcnt lgkmcnt(0)
    v_mfma_f32_16x16x32_bf16 v[64:67], v[80:83], a[72:75], v[64:67]
    v_mfma_f32_16x16x32_bf16 v[68:71], v[80:83], a[76:79], v[68:71]
    s_setprio 0
    ds_write_b128 v18, v[32:35] offset:0
    ds_write_b128 v18, v[40:43] offset:1024
    ds_write_b128 v18, v[48:51] offset:2048
    ds_write_b128 v18, v[56:59] offset:3072
    s_nop 1
    ds_write_b128 v18, v[64:67] offset:4096
    ds_write_b128 v18, v[36:39] offset:5120
    ds_write_b128 v18, v[44:47] offset:6144
    ds_write_b128 v18, v[52:55] offset:7168
    ds_write_b128 v18, v[60:63] offset:8192
    ds_write_b128 v18, v[68:71] offset:9216
    s_waitcnt lgkmcnt(0)
    s_barrier
    s_endpgm
L_k0Aa_max:
    s_nop 7
    ds_read_b64 v[96:97], v8 offset:0
    ds_read_b64 v[98:99], v8 offset:512
    ds_read_b64 v[100:101], v8 offset:1024
    ds_read_b64 v[102:103], v5 offset:0
    ds_read_b64 v[104:105], v5 offset:8
    ds_read_b64 v[106:107], v6 offset:0
    s_waitcnt lgkmcnt(0)
    v_mfma_f32_32x32x16_bf16 v[56:71], v[96:99], v[102:105], 0
    v_mfma_f32_32x32x8_bf16 v[56:71], v[100:101], v[106:107], v[56:71]
    s_nop 11
    v_max3_f32 v66, v56, v57, v58
    v_max3_f32 v68, -v56, -v57, -v58
    v_max3_f32 v66, v66, v59, v60
    v_max3_f32 v68, v68, -v59, -v60
    v_max3_f32 v66, v66, v61, v62
    v_max3_f32 v68, v68, -v61, -v62
    v_max3_f32 v66, v66, v63, v64
    v_max3_f32 v68, v68, -v63, -v64
    v_max_f32_e64 v66, v66, v65
    v_max_f32_e64 v68, v68, -v65
    s_nop 1
    v_permlane32_swap_b32 v66, v68
    v_max_f32 v66, v66, v68
    v_mul_f32 v68, 1.0, v66
    v_mul_f32 v66, 1.0, v66
    s_nop 1
    v_permlane32_swap_b32 v66, v68
    v_pk_fma_f32 v[96:97], v[56:57], 1.0, v[66:67] op_sel_hi:[1,0,0] neg_lo:[0,0,1] neg_hi:[0,0,1]
    v_pk_fma_f32 v[56:57], v[56:57], 1.0, v[68:69] op_sel_hi:[1,0,0] neg_lo:[1,0,1] neg_hi:[1,0,1]
    v_pk_fma_f32 v[98:99], v[58:59], 1.0, v[66:67] op_sel_hi:[1,0,0] neg_lo:[0,0,1] neg_hi:[0,0,1]
    v_pk_fma_f32 v[58:59], v[58:59], 1.0, v[68:69] op_sel_hi:[1,0,0] neg_lo:[1,0,1] neg_hi:[1,0,1]
    v_pk_fma_f32 v[100:101], v[60:61], 1.0, v[66:67] op_sel_hi:[1,0,0] neg_lo:[0,0,1] neg_hi:[0,0,1]
    v_pk_fma_f32 v[60:61], v[60:61], 1.0, v[68:69] op_sel_hi:[1,0,0] neg_lo:[1,0,1] neg_hi:[1,0,1]
    v_pk_fma_f32 v[102:103], v[62:63], 1.0, v[66:67] op_sel_hi:[1,0,0] neg_lo:[0,0,1] neg_hi:[0,0,1]
    v_pk_fma_f32 v[62:63], v[62:63], 1.0, v[68:69] op_sel_hi:[1,0,0] neg_lo:[1,0,1] neg_hi:[1,0,1]
    v_pk_fma_f32 v[104:105], v[64:65], 1.0, v[66:67] op_sel_hi:[1,0,0] neg_lo:[0,0,1] neg_hi:[0,0,1]
    v_pk_fma_f32 v[64:65], v[64:65], 1.0, v[68:69] op_sel_hi:[1,0,0] neg_lo:[1,0,1] neg_hi:[1,0,1]
    v_exp_f32 v96, v96
    v_exp_f32 v56, v56
    v_exp_f32 v97, v97
    v_exp_f32 v57, v57
    v_exp_f32 v98, v98
    v_exp_f32 v58, v58
    v_exp_f32 v99, v99
    v_exp_f32 v59, v59
    v_exp_f32 v100, v100
    v_exp_f32 v60, v60
    v_exp_f32 v101, v101
    v_exp_f32 v61, v61
    v_exp_f32 v102, v102
    v_exp_f32 v62, v62
    v_exp_f32 v103, v103
    v_exp_f32 v63, v63
    v_exp_f32 v104, v104
    v_exp_f32 v64, v64
    v_exp_f32 v105, v105
    v_exp_f32 v65, v65
    v_pk_add_f32 v[66:67], v[96:97], v[98:99]
    v_pk_add_f32 v[68:69], v[56:57], v[58:59]
    v_pk_add_f32 v[66:67], v[66:67], v[100:101]
    v_pk_add_f32 v[68:69], v[68:69], v[60:61]
    v_pk_add_f32 v[66:67], v[66:67], v[102:103]
    v_pk_add_f32 v[68:69], v[68:69], v[62:63]
    v_pk_add_f32 v[66:67], v[66:67], v[104:105]
    v_pk_add_f32 v[68:69], v[68:69], v[64:65]
    v_add_f32 v66, v66, v67
    v_add_f32 v68, v68, v69
    s_nop 1
    v_permlane32_swap_b32 v66, v68
    v_add_f32 v66, v66, v68
    v_rcp_f32 v66, v66
    s_nop 1
    s_branch L_k0Aa_sum
L_k1Aa_max:
    s_nop 7
    ds_read_b64 v[108:109], v8 offset:1536
    ds_read_b64 v[110:111], v8 offset:2048
    ds_read_b64 v[112:113], v8 offset:2560
    ds_read_b64 v[114:115], v5 offset:5120
    ds_read_b64 v[116:117], v5 offset:5128
    ds_read_b64 v[118:119], v6 offset:5120
    s_waitcnt lgkmcnt(0)
    v_mfma_f32_32x32x16_bf16 v[72:87], v[108:111], v[114:117], 0
    v_mfma_f32_32x32x8_bf16 v[72:87], v[112:113], v[118:119], v[72:87]
    s_nop 11
    v_max3_f32 v82, v72, v73, v74
    v_max3_f32 v84, -v72, -v73, -v74
    v_max3_f32 v82, v82, v75, v76
    v_max3_f32 v84, v84, -v75, -v76
    v_max3_f32 v82, v82, v77, v78
    v_max3_f32 v84, v84, -v77, -v78
    v_max3_f32 v82, v82, v79, v80
    v_max3_f32 v84, v84, -v79, -v80
    v_max_f32_e64 v82, v82, v81
    v_max_f32_e64 v84, v84, -v81
    s_nop 1
    v_permlane32_swap_b32 v82, v84
    v_max_f32 v82, v82, v84
    v_mul_f32 v84, 1.0, v82
    v_mul_f32 v82, 1.0, v82
    s_nop 1
    v_permlane32_swap_b32 v82, v84
    v_pk_fma_f32 v[108:109], v[72:73], 1.0, v[82:83] op_sel_hi:[1,0,0] neg_lo:[0,0,1] neg_hi:[0,0,1]
    v_pk_fma_f32 v[72:73], v[72:73], 1.0, v[84:85] op_sel_hi:[1,0,0] neg_lo:[1,0,1] neg_hi:[1,0,1]
    v_pk_fma_f32 v[110:111], v[74:75], 1.0, v[82:83] op_sel_hi:[1,0,0] neg_lo:[0,0,1] neg_hi:[0,0,1]
    v_pk_fma_f32 v[74:75], v[74:75], 1.0, v[84:85] op_sel_hi:[1,0,0] neg_lo:[1,0,1] neg_hi:[1,0,1]
    v_pk_fma_f32 v[112:113], v[76:77], 1.0, v[82:83] op_sel_hi:[1,0,0] neg_lo:[0,0,1] neg_hi:[0,0,1]
    v_pk_fma_f32 v[76:77], v[76:77], 1.0, v[84:85] op_sel_hi:[1,0,0] neg_lo:[1,0,1] neg_hi:[1,0,1]
    v_pk_fma_f32 v[114:115], v[78:79], 1.0, v[82:83] op_sel_hi:[1,0,0] neg_lo:[0,0,1] neg_hi:[0,0,1]
    v_pk_fma_f32 v[78:79], v[78:79], 1.0, v[84:85] op_sel_hi:[1,0,0] neg_lo:[1,0,1] neg_hi:[1,0,1]
    v_pk_fma_f32 v[116:117], v[80:81], 1.0, v[82:83] op_sel_hi:[1,0,0] neg_lo:[0,0,1] neg_hi:[0,0,1]
    v_pk_fma_f32 v[80:81], v[80:81], 1.0, v[84:85] op_sel_hi:[1,0,0] neg_lo:[1,0,1] neg_hi:[1,0,1]
    v_exp_f32 v108, v108
    v_exp_f32 v72, v72
    v_exp_f32 v109, v109
    v_exp_f32 v73, v73
    v_exp_f32 v110, v110
    v_exp_f32 v74, v74
    v_exp_f32 v111, v111
    v_exp_f32 v75, v75
    v_exp_f32 v112, v112
    v_exp_f32 v76, v76
    v_exp_f32 v113, v113
    v_exp_f32 v77, v77
    v_exp_f32 v114, v114
    v_exp_f32 v78, v78
    v_exp_f32 v115, v115
    v_exp_f32 v79, v79
    v_exp_f32 v116, v116
    v_exp_f32 v80, v80
    v_exp_f32 v117, v117
    v_exp_f32 v81, v81
    v_pk_add_f32 v[82:83], v[108:109], v[110:111]
    v_pk_add_f32 v[84:85], v[72:73], v[74:75]
    v_pk_add_f32 v[82:83], v[82:83], v[112:113]
    v_pk_add_f32 v[84:85], v[84:85], v[76:77]
    v_pk_add_f32 v[82:83], v[82:83], v[114:115]
    v_pk_add_f32 v[84:85], v[84:85], v[78:79]
    v_pk_add_f32 v[82:83], v[82:83], v[116:117]
    v_pk_add_f32 v[84:85], v[84:85], v[80:81]
    v_add_f32 v82, v82, v83
    v_add_f32 v84, v84, v85
    s_nop 1
    v_permlane32_swap_b32 v82, v84
    v_add_f32 v82, v82, v84
    v_rcp_f32 v82, v82
    s_nop 1
    s_branch L_k1Aa_sum
L_hsAa_slow:
    s_mov_b32 s67, 0
L_hsAa_again:
    s_sleep 8
    s_nop 7
    v_and_b32 v126, 31, v1
    v_lshlrev_b32 v126, 2, v126
    buffer_load_dword v124, v126, s[32:35], s68 offen offset:512 sc1
    s_waitcnt vmcnt(0)
    v_cmp_ne_u32 vcc, s57, v124
    s_add_u32 s67, s67, 1
    s_cmp_lt_u32 s67, 4
    s_nop 3
    s_cbranch_vccz L_hsAa_ok
    s_cbranch_scc1 L_hsAa_again
    s_mov_b32 s61, 1
    s_branch L_hsAa_ok
L_alAa_slow:
    s_mov_b32 s67, 0
L_alAa_again:
    s_sleep 8
    s_nop 7
    v_and_b32 v126, 12, v126
    s_lshl_b32 s58, s48, 4
    buffer_load_dword v125, v126, s[44:47], s58 offen sc1
    s_waitcnt vmcnt(0)
    v_cmp_eq_u32 vcc, 0, v125
    s_add_u32 s67, s67, 1
    s_cmp_lt_u32 s67, 4000
    s_nop 3
    s_cbranch_vccz L_alAa_ok
    s_cbranch_scc1 L_alAa_again
    s_branch L_alAa_ok
L_pubAa_far:
    buffer_store_dwordx4 v[80:83], v50, s[36:39], s62 offen sc1
    buffer_store_dwordx4 v[84:87], v51, s[36:39], s62 offen sc1
    buffer_store_dwordx4 v[88:91], v52, s[36:39], s62 offen sc1
    s_branch L_pubAa_st
L_s1Aa_far:
    s_mov_b64 exec, 1
    buffer_store_dword v55, off, s[32:35], s58 offset:0 sc1
    s_mov_b64 exec, -1
    s_branch L_s1Aa_st
L_q0Aa_max:
    s_nop 7
    ds_read_b64 v[96:97], v8 offset:0
    ds_read_b64 v[98:99], v8 offset:512
    ds_read_b64 v[100:101], v8 offset:1024
    ds_read_b64 v[102:103], v5 offset:0
    ds_read_b64 v[104:105], v5 offset:8
    ds_read_b64 v[106:107], v6 offset:0
    s_waitcnt lgkmcnt(0)
    v_mfma_f32_32x32x16_bf16 v[56:71], v[96:99], v[102:105], 0
    v_mfma_f32_32x32x8_bf16 v[56:71], v[100:101], v[106:107], v[56:71]
    s_nop 11
    v_max3_f32 v66, v56, v57, v58
    v_max3_f32 v68, -v56, -v57, -v58
    v_max3_f32 v66, v66, v59, v60
    v_max3_f32 v68, v68, -v59, -v60
    v_max3_f32 v66, v66, v61, v62
    v_max3_f32 v68, v68, -v61, -v62
    v_max3_f32 v66, v66, v63, v64
    v_max3_f32 v68, v68, -v63, -v64
    v_max_f32_e64 v66, v66, v65
    v_max_f32_e64 v68, v68, -v65
    s_nop 1
    v_permlane32_swap_b32 v66, v68
    v_max_f32 v66, v66, v68
    v_mul_f32 v68, 1.0, v66
    v_mul_f32 v66, 1.0, v66
    s_nop 1
    v_permlane32_swap_b32 v66, v68
    v_pk_fma_f32 v[96:97], v[56:57], 1.0, v[66:67] op_sel_hi:[1,0,0] neg_lo:[0,0,1] neg_hi:[0,0,1]
    v_pk_fma_f32 v[56:57], v[56:57], 1.0, v[68:69] op_sel_hi:[1,0,0] neg_lo:[1,0,1] neg_hi:[1,0,1]
    v_pk_fma_f32 v[98:99], v[58:59], 1.0, v[66:67] op_sel_hi:[1,0,0] neg_lo:[0,0,1] neg_hi:[0,0,1]
    v_pk_fma_f32 v[58:59], v[58:59], 1.0, v[68:69] op_sel_hi:[1,0,0] neg_lo:[1,0,1] neg_hi:[1,0,1]
    v_pk_fma_f32 v[100:101], v[60:61], 1.0, v[66:67] op_sel_hi:[1,0,0] neg_lo:[0,0,1] neg_hi:[0,0,1]
    v_pk_fma_f32 v[60:61], v[60:61], 1.0, v[68:69] op_sel_hi:[1,0,0] neg_lo:[1,0,1] neg_hi:[1,0,1]
    v_pk_fma_f32 v[102:103], v[62:63], 1.0, v[66:67] op_sel_hi:[1,0,0] neg_lo:[0,0,1] neg_hi:[0,0,1]
    v_pk_fma_f32 v[62:63], v[62:63], 1.0, v[68:69] op_sel_hi:[1,0,0] neg_lo:[1,0,1] neg_hi:[1,0,1]
    v_pk_fma_f32 v[104:105], v[64:65], 1.0, v[66:67] op_sel_hi:[1,0,0] neg_lo:[0,0,1] neg_hi:[0,0,1]
    v_pk_fma_f32 v[64:65], v[64:65], 1.0, v[68:69] op_sel_hi:[1,0,0] neg_lo:[1,0,1] neg_hi:[1,0,1]
    v_exp_f32 v96, v96
    v_exp_f32 v56, v56
    v_exp_f32 v97, v97
    v_exp_f32 v57, v57
    v_exp_f32 v98, v98
    v_exp_f32 v58, v58
    v_exp_f32 v99, v99
    v_exp_f32 v59, v59
    v_exp_f32 v100, v100
    v_exp_f32 v60, v60
    v_exp_f32 v101, v101
    v_exp_f32 v61, v61
    v_exp_f32 v102, v102
    v_exp_f32 v62, v62
    v_exp_f32 v103, v103
    v_exp_f32 v63, v63
    v_exp_f32 v104, v104
    v_exp_f32 v64, v64
    v_exp_f32 v105, v105
    v_exp_f32 v65, v65
    v_pk_add_f32 v[66:67], v[96:97], v[98:99]
    v_pk_add_f32 v[68:69], v[56:57], v[58:59]
    v_pk_add_f32 v[66:67], v[66:67], v[100:101]
    v_pk_add_f32 v[68:69], v[68:69], v[60:61]
    v_pk_add_f32 v[66:67], v[66:67], v[102:103]
    v_pk_add_f32 v[68:69], v[68:69], v[62:63]
    v_pk_add_f32 v[66:67], v[66:67], v[104:105]
    v_pk_add_f32 v[68:69], v[68:69], v[64:65]
    v_add_f32 v66, v66, v67
    v_add_f32 v68, v68, v69
    s_nop 1
    v_permlane32_swap_b32 v66, v68
    v_add_f32 v66, v66, v68
    v_rcp_f32 v66, v66
    s_nop 1
    s_branch L_q0Aa_sum
L_q1Aa_max:
    s_nop 7
    ds_read_b64 v[108:109], v8 offset:1536
    ds_read_b64 v[110:111], v8 offset:2048
    ds_read_b64 v[112:113], v8 offset:2560
    ds_read_b64 v[114:115], v5 offset:5120
    ds_read_b64 v[116:117], v5 offset:5128
    ds_read_b64 v[118:119], v6 offset:5120
    s_waitcnt lgkmcnt(0)
    v_mfma_f32_32x32x16_bf16 v[72:87], v[108:111], v[114:117], 0
    v_mfma_f32_32x32x8_bf16 v[72:87], v[112:113], v[118:119], v[72:87]
    s_nop 11
    v_max3_f32 v82, v72, v73, v74
    v_max3_f32 v84, -v72, -v73, -v74
    v_max3_f32 v82, v82, v75, v76
    v_max3_f32 v84, v84, -v75, -v76
    v_max3_f32 v82, v82, v77, v78
    v_max3_f32 v84, v84, -v77, -v78
    v_max3_f32 v82, v82, v79, v80
    v_max3_f32 v84, v84, -v79, -v80
    v_max_f32_e64 v82, v82, v81
    v_max_f32_e64 v84, v84, -v81
    s_nop 1
    v_permlane32_swap_b32 v82, v84
    v_max_f32 v82, v82, v84
    v_mul_f32 v84, 1.0, v82
    v_mul_f32 v82, 1.0, v82
    s_nop 1
    v_permlane32_swap_b32 v82, v84
    v_pk_fma_f32 v[108:109], v[72:73], 1.0, v[82:83] op_sel_hi:[1,0,0] neg_lo:[0,0,1] neg_hi:[0,0,1]
    v_pk_fma_f32 v[72:73], v[72:73], 1.0, v[84:85] op_sel_hi:[1,0,0] neg_lo:[1,0,1] neg_hi:[1,0,1]
    v_pk_fma_f32 v[110:111], v[74:75], 1.0, v[82:83] op_sel_hi:[1,0,0] neg_lo:[0,0,1] neg_hi:[0,0,1]
    v_pk_fma_f32 v[74:75], v[74:75], 1.0, v[84:85] op_sel_hi:[1,0,0] neg_lo:[1,0,1] neg_hi:[1,0,1]
    v_pk_fma_f32 v[112:113], v[76:77], 1.0, v[82:83] op_sel_hi:[1,0,0] neg_lo:[0,0,1] neg_hi:[0,0,1]
    v_pk_fma_f32 v[76:77], v[76:77], 1.0, v[84:85] op_sel_hi:[1,0,0] neg_lo:[1,0,1] neg_hi:[1,0,1]
    v_pk_fma_f32 v[114:115], v[78:79], 1.0, v[82:83] op_sel_hi:[1,0,0] neg_lo:[0,0,1] neg_hi:[0,0,1]
    v_pk_fma_f32 v[78:79], v[78:79], 1.0, v[84:85] op_sel_hi:[1,0,0] neg_lo:[1,0,1] neg_hi:[1,0,1]
    v_pk_fma_f32 v[116:117], v[80:81], 1.0, v[82:83] op_sel_hi:[1,0,0] neg_lo:[0,0,1] neg_hi:[0,0,1]
    v_pk_fma_f32 v[80:81], v[80:81], 1.0, v[84:85] op_sel_hi:[1,0,0] neg_lo:[1,0,1] neg_hi:[1,0,1]
    v_exp_f32 v108, v108
    v_exp_f32 v72, v72
    v_exp_f32 v109, v109
    v_exp_f32 v73, v73
    v_exp_f32 v110, v110
    v_exp_f32 v74, v74
    v_exp_f32 v111, v111
    v_exp_f32 v75, v75
    v_exp_f32 v112, v112
    v_exp_f32 v76, v76
    v_exp_f32 v113, v113
    v_exp_f32 v77, v77
    v_exp_f32 v114, v114
    v_exp_f32 v78, v78
    v_exp_f32 v115, v115
    v_exp_f32 v79, v79
    v_exp_f32 v116, v116
    v_exp_f32 v80, v80
    v_exp_f32 v117, v117
    v_exp_f32 v81, v81
    v_pk_add_f32 v[82:83], v[108:109], v[110:111]
    v_pk_add_f32 v[84:85], v[72:73], v[74:75]
    v_pk_add_f32 v[82:83], v[82:83], v[112:113]
    v_pk_add_f32 v[84:85], v[84:85], v[76:77]
    v_pk_add_f32 v[82:83], v[82:83], v[114:115]
    v_pk_add_f32 v[84:85], v[84:85], v[78:79]
    v_pk_add_f32 v[82:83], v[82:83], v[116:117]
    v_pk_add_f32 v[84:85], v[84:85], v[80:81]
    v_add_f32 v82, v82, v83
    v_add_f32 v84, v84, v85
    s_nop 1
    v_permlane32_swap_b32 v82, v84
    v_add_f32 v82, v82, v84
    v_rcp_f32 v82, v82
    s_nop 1
    s_branch L_q1Aa_sum
L_o1Aa_far:
    buffer_store_dwordx4 v[88:91], v7, s[36:39], s62 offen sc1
    buffer_store_dwordx4 v[92:95], v15, s[36:39], s62 offen sc1
    buffer_store_dwordx4 v[124:127], v13, s[36:39], s62 offen offset:1024 sc1
    s_branch L_o1Aa_st
L_s2Aa_far:
    s_mov_b64 exec, 1
    buffer_store_dword v120, off, s[32:35], s58 offset:1024 sc1
    s_mov_b64 exec, -1
    s_branch L_s2Aa_st
L_s3Aa_far:
    s_mov_b64 exec, 1
    buffer_store_dword v120, off, s[32:35], s58 offset:2048 sc1
    s_mov_b64 exec, -1
    s_branch L_s3Aa_st
L_hsBa_slow:
    s_mov_b32 s67, 0
L_hsBa_again:
    s_sleep 8
    s_nop 7
    v_and_b32 v126, 31, v1
    v_lshlrev_b32 v126, 2, v126
    buffer_load_dword v124, v126, s[32:35], s68 offen offset:512 sc1
    s_waitcnt vmcnt(0)
    v_cmp_ne_u32 vcc, s57, v124
    s_add_u32 s67, s67, 1
    s_cmp_lt_u32 s67, 4
    s_nop 3
    s_cbranch_vccz L_hsBa_ok
    s_cbranch_scc1 L_hsBa_again
    s_mov_b32 s61, 1
    s_branch L_hsBa_ok
L_alBa_slow:
    s_mov_b32 s67, 0
L_alBa_again:
    s_sleep 8
    s_nop 7
    v_and_b32 v126, 12, v126
    s_lshl_b32 s58, s48, 4
    buffer_load_dword v125, v126, s[44:47], s58 offen sc1
    s_waitcnt vmcnt(0)
    v_cmp_eq_u32 vcc, 0, v125
    s_add_u32 s67, s67, 1
    s_cmp_lt_u32 s67, 4000
    s_nop 3
    s_cbranch_vccz L_alBa_ok
    s_cbranch_scc1 L_alBa_again
    s_branch L_alBa_ok
L_pubBa_far:
    buffer_store_dwordx4 v[80:83], v50, s[36:39], s62 offen sc1
    buffer_store_dwordx4 v[84:87], v52, s[36:39], s62 offen sc1
    s_branch L_pubBa_st
L_s1Ba_far:
    s_mov_b64 exec, 1
    buffer_store_dword v55, off, s[32:35], s58 offset:0 sc1
    s_mov_b64 exec, -1
    s_branch L_s1Ba_st
L_o1Ba_far:
    buffer_store_dwordx4 v[88:91], v7, s[36:39], s62 offen sc1
    buffer_store_dwordx4 v[92:95], v15, s[36:39], s62 offen sc1
    buffer_store_dwordx4 v[124:127], v13, s[36:39], s62 offen offset:1024 sc1
    s_branch L_o1Ba_st
L_s2Ba_far:
    s_mov_b64 exec, 1
    buffer_store_dword v120, off, s[32:35], s58 offset:1024 sc1
    s_mov_b64 exec, -1
    s_branch L_s2Ba_st
L_s3Ba_far:
    s_mov_b64 exec, 1
    buffer_store_dword v120, off, s[32:35], s58 offset:2048 sc1
    s_mov_b64 exec, -1
    s_branch L_s3Ba_st
L_ld_slow:
    s_mov_b32 s67, 0
L_ld_again:
    s_sleep 8
    s_nop 7
    s_and_b32 s58, s2, 7
    s_lshl_b32 s57, s51, 8
    s_lshl2_add_u32 s58, s58, s57
    buffer_load_dword v117, off, s[44:47], s58 sc1
    s_waitcnt vmcnt(0)
    v_cmp_eq_u32 vcc, s51, v117
    s_add_u32 s67, s67, 1
    s_cmp_lt_u32 s67, 4000
    s_nop 3
    s_cbranch_vccz L_ld_ok
    s_cbranch_scc1 L_ld_again
    s_branch L_ld_ok
L_k0Ab_max:
    s_nop 7
    ds_read_b64 v[72:73], v8 offset:0
    ds_read_b64 v[74:75], v8 offset:512
    ds_read_b64 v[76:77], v8 offset:1024
    ds_read_b64 v[78:79], v5 offset:0
    ds_read_b64 v[80:81], v5 offset:8
    ds_read_b64 v[82:83], v6 offset:0
    s_waitcnt lgkmcnt(0)
    v_mfma_f32_32x32x16_bf16 v[32:47], v[72:75], v[78:81], 0
    v_mfma_f32_32x32x8_bf16 v[32:47], v[76:77], v[82:83], v[32:47]
    s_nop 11
    v_max3_f32 v42, v32, v33, v34
    v_max3_f32 v44, -v32, -v33, -v34
    v_max3_f32 v42, v42, v35, v36
    v_max3_f32 v44, v44, -v35, -v36
    v_max3_f32 v42, v42, v37, v38
    v_max3_f32 v44, v44, -v37, -v38
    v_max3_f32 v42, v42, v39, v40
    v_max3_f32 v44, v44, -v39, -v40
    v_max_f32_e64 v42, v42, v41
    v_max_f32_e64 v44, v44, -v41
    s_nop 1
    v_permlane32_swap_b32 v42, v44
    v_max_f32 v42, v42, v44
    v_mul_f32 v44, 1.0, v42
    v_mul_f32 v42, 1.0, v42
    s_nop 1
    v_permlane32_swap_b32 v42, v44
    v_pk_fma_f32 v[72:73], v[32:33], 1.0, v[42:43] op_sel_hi:[1,0,0] neg_lo:[0,0,1] neg_hi:[0,0,1]
    v_pk_fma_f32 v[32:33], v[32:33], 1.0, v[44:45] op_sel_hi:[1,0,0] neg_lo:[1,0,1] neg_hi:[1,0,1]
    v_pk_fma_f32 v[74:75], v[34:35], 1.0, v[42:43] op_sel_hi:[1,0,0] neg_lo:[0,0,1] neg_hi:[0,0,1]
    v_pk_fma_f32 v[34:35], v[34:35], 1.0, v[44:45] op_sel_hi:[1,0,0] neg_lo:[1,0,1] neg_hi:[1,0,1]
    v_pk_fma_f32 v[76:77], v[36:37], 1.0, v[42:43] op_sel_hi:[1,0,0] neg_lo:[0,0,1] neg_hi:[0,0,1]
    v_pk_fma_f32 v[36:37], v[36:37], 1.0, v[44:45] op_sel_hi:[1,0,0] neg_lo:[1,0,1] neg_hi:[1,0,1]
    v_pk_fma_f32 v[78:79], v[38:39], 1.0, v[42:43] op_sel_hi:[1,0,0] neg_lo:[0,0,1] neg_hi:[0,0,1]
    v_pk_fma_f32 v[38:39], v[38:39], 1.0, v[44:45] op_sel_hi:[1,0,0] neg_lo:[1,0,1] neg_hi:[1,0,1]
    v_pk_fma_f32 v[80:81], v[40:41], 1.0, v[42:43] op_sel_hi:[1,0,0] neg_lo:[0,0,1] neg_hi:[0,0,1]
    v_pk_fma_f32 v[40:41], v[40:41], 1.0, v[44:45] op_sel_hi:[1,0,0] neg_lo:[1,0,1] neg_hi:[1,0,1]
    v_exp_f32 v72, v72
    v_exp_f32 v32, v32
    v_exp_f32 v73, v73
    v_exp_f32 v33, v33
    v_exp_f32 v74, v74
    v_exp_f32 v34, v34
    v_exp_f32 v75, v75
    v_exp_f32 v35, v35
    v_exp_f32 v76, v76
    v_exp_f32 v36, v36
    v_exp_f32 v77, v77
    v_exp_f32 v37, v37
    v_exp_f32 v78, v78
    v_exp_f32 v38, v38
    v_exp_f32 v79, v79
    v_exp_f32 v39, v39
    v_exp_f32 v80, v80
    v_exp_f32 v40, v40
    v_exp_f32 v81, v81
    v_exp_f32 v41, v41
    v_pk_add_f32 v[42:43], v[72:73], v[74:75]
    v_pk_add_f32 v[44:45], v[32:33], v[34:35]
    v_pk_add_f32 v[42:43], v[42:43], v[76:77]
    v_pk_add_f32 v[44:45], v[44:45], v[36:37]
    v_pk_add_f32 v[42:43], v[42:43], v[78:79]
    v_pk_add_f32 v[44:45], v[44:45], v[38:39]
    v_pk_add_f32 v[42:43], v[42:43], v[80:81]
    v_pk_add_f32 v[44:45], v[44:45], v[40:41]
    v_add_f32 v42, v42, v43
    v_add_f32 v44, v44, v45
    s_nop 1
    v_permlane32_swap_b32 v42, v44
    v_add_f32 v42, v42, v44
    v_rcp_f32 v42, v42
    s_nop 1
    s_branch L_k0Ab_sum
L_k1Ab_max:
    s_nop 7
    ds_read_b64 v[84:85], v8 offset:1536
    ds_read_b64 v[86:87], v8 offset:2048
    ds_read_b64 v[88:89], v8 offset:2560
    ds_read_b64 v[90:91], v5 offset:5120
    ds_read_b64 v[92:93], v5 offset:5128
    ds_read_b64 v[94:95], v6 offset:5120
    s_waitcnt lgkmcnt(0)
    v_mfma_f32_32x32x16_bf16 v[48:63], v[84:87], v[90:93], 0
    v_mfma_f32_32x32x8_bf16 v[48:63], v[88:89], v[94:95], v[48:63]
    s_nop 11
    v_max3_f32 v58, v48, v49, v50
    v_max3_f32 v60, -v48, -v49, -v50
    v_max3_f32 v58, v58, v51, v52
    v_max3_f32 v60, v60, -v51, -v52
    v_max3_f32 v58, v58, v53, v54
    v_max3_f32 v60, v60, -v53, -v54
    v_max3_f32 v58, v58, v55, v56
    v_max3_f32 v60, v60, -v55, -v56
    v_max_f32_e64 v58, v58, v57
    v_max_f32_e64 v60, v60, -v57
    s_nop 1
    v_permlane32_swap_b32 v58, v60
    v_max_f32 v58, v58, v60
    v_mul_f32 v60, 1.0, v58
    v_mul_f32 v58, 1.0, v58
    s_nop 1
    v_permlane32_swap_b32 v58, v60
    v_pk_fma_f32 v[84:85], v[48:49], 1.0, v[58:59] op_sel_hi:[1,0,0] neg_lo:[0,0,1] neg_hi:[0,0,1]
    v_pk_fma_f32 v[48:49], v[48:49], 1.0, v[60:61] op_sel_hi:[1,0,0] neg_lo:[1,0,1] neg_hi:[1,0,1]
    v_pk_fma_f32 v[86:87], v[50:51], 1.0, v[58:59] op_sel_hi:[1,0,0] neg_lo:[0,0,1] neg_hi:[0,0,1]
    v_pk_fma_f32 v[50:51], v[50:51], 1.0, v[60:61] op_sel_hi:[1,0,0] neg_lo:[1,0,1] neg_hi:[1,0,1]
    v_pk_fma_f32 v[88:89], v[52:53], 1.0, v[58:59] op_sel_hi:[1,0,0] neg_lo:[0,0,1] neg_hi:[0,0,1]
    v_pk_fma_f32 v[52:53], v[52:53], 1.0, v[60:61] op_sel_hi:[1,0,0] neg_lo:[1,0,1] neg_hi:[1,0,1]
    v_pk_fma_f32 v[90:91], v[54:55], 1.0, v[58:59] op_sel_hi:[1,0,0] neg_lo:[0,0,1] neg_hi:[0,0,1]
    v_pk_fma_f32 v[54:55], v[54:55], 1.0, v[60:61] op_sel_hi:[1,0,0] neg_lo:[1,0,1] neg_hi:[1,0,1]
    v_pk_fma_f32 v[92:93], v[56:57], 1.0, v[58:59] op_sel_hi:[1,0,0] neg_lo:[0,0,1] neg_hi:[0,0,1]
    v_pk_fma_f32 v[56:57], v[56:57], 1.0, v[60:61] op_sel_hi:[1,0,0] neg_lo:[1,0,1] neg_hi:[1,0,1]
    v_exp_f32 v84, v84
    v_exp_f32 v48, v48
    v_exp_f32 v85, v85
    v_exp_f32 v49, v49
    v_exp_f32 v86, v86
    v_exp_f32 v50, v50
    v_exp_f32 v87, v87
    v_exp_f32 v51, v51
    v_exp_f32 v88, v88
    v_exp_f32 v52, v52
    v_exp_f32 v89, v89
    v_exp_f32 v53, v53
    v_exp_f32 v90, v90
    v_exp_f32 v54, v54
    v_exp_f32 v91, v91
    v_exp_f32 v55, v55
    v_exp_f32 v92, v92
    v_exp_f32 v56, v56
    v_exp_f32 v93, v93
    v_exp_f32 v57, v57
    v_pk_add_f32 v[58:59], v[84:85], v[86:87]
    v_pk_add_f32 v[60:61], v[48:49], v[50:51]
    v_pk_add_f32 v[58:59], v[58:59], v[88:89]
    v_pk_add_f32 v[60:61], v[60:61], v[52:53]
    v_pk_add_f32 v[58:59], v[58:59], v[90:91]
    v_pk_add_f32 v[60:61], v[60:61], v[54:55]
    v_pk_add_f32 v[58:59], v[58:59], v[92:93]
    v_pk_add_f32 v[60:61], v[60:61], v[56:57]
    v_add_f32 v58, v58, v59
    v_add_f32 v60, v60, v61
    s_nop 1
    v_permlane32_swap_b32 v58, v60
    v_add_f32 v58, v58, v60
    v_rcp_f32 v58, v58
    s_nop 1
    s_branch L_k1Ab_sum
L_q0Ab_max:
    s_nop 7
    ds_read_b64 v[72:73], v8 offset:0
    ds_read_b64 v[74:75], v8 offset:512
    ds_read_b64 v[76:77], v8 offset:1024
    ds_read_b64 v[78:79], v5 offset:0
    ds_read_b64 v[80:81], v5 offset:8
    ds_read_b64 v[82:83], v6 offset:0
    s_waitcnt lgkmcnt(0)
    v_mfma_f32_32x32x16_bf16 v[32:47], v[72:75], v[78:81], 0
    v_mfma_f32_32x32x8_bf16 v[32:47], v[76:77], v[82:83], v[32:47]
    s_nop 11
    v_max3_f32 v42, v32, v33, v34
    v_max3_f32 v44, -v32, -v33, -v34
    v_max3_f32 v42, v42, v35, v36
    v_max3_f32 v44, v44, -v35, -v36
    v_max3_f32 v42, v42, v37, v38
    v_max3_f32 v44, v44, -v37, -v38
    v_max3_f32 v42, v42, v39, v40
    v_max3_f32 v44, v44, -v39, -v40
    v_max_f32_e64 v42, v42, v41
    v_max_f32_e64 v44, v44, -v41
    s_nop 1
    v_permlane32_swap_b32 v42, v44
    v_max_f32 v42, v42, v44
    v_mul_f32 v44, 1.0, v42
    v_mul_f32 v42, 1.0, v42
    s_nop 1
    v_permlane32_swap_b32 v42, v44
    v_pk_fma_f32 v[72:73], v[32:33], 1.0, v[42:43] op_sel_hi:[1,0,0] neg_lo:[0,0,1] neg_hi:[0,0,1]
    v_pk_fma_f32 v[32:33], v[32:33], 1.0, v[44:45] op_sel_hi:[1,0,0] neg_lo:[1,0,1] neg_hi:[1,0,1]
    v_pk_fma_f32 v[74:75], v[34:35], 1.0, v[42:43] op_sel_hi:[1,0,0] neg_lo:[0,0,1] neg_hi:[0,0,1]
    v_pk_fma_f32 v[34:35], v[34:35], 1.0, v[44:45] op_sel_hi:[1,0,0] neg_lo:[1,0,1] neg_hi:[1,0,1]
    v_pk_fma_f32 v[76:77], v[36:37], 1.0, v[42:43] op_sel_hi:[1,0,0] neg_lo:[0,0,1] neg_hi:[0,0,1]
    v_pk_fma_f32 v[36:37], v[36:37], 1.0, v[44:45] op_sel_hi:[1,0,0] neg_lo:[1,0,1] neg_hi:[1,0,1]
    v_pk_fma_f32 v[78:79], v[38:39], 1.0, v[42:43] op_sel_hi:[1,0,0] neg_lo:[0,0,1] neg_hi:[0,0,1]
    v_pk_fma_f32 v[38:39], v[38:39], 1.0, v[44:45] op_sel_hi:[1,0,0] neg_lo:[1,0,1] neg_hi:[1,0,1]
    v_pk_fma_f32 v[80:81], v[40:41], 1.0, v[42:43] op_sel_hi:[1,0,0] neg_lo:[0,0,1] neg_hi:[0,0,1]
    v_pk_fma_f32 v[40:41], v[40:41], 1.0, v[44:45] op_sel_hi:[1,0,0] neg_lo:[1,0,1] neg_hi:[1,0,1]
    v_exp_f32 v72, v72
    v_exp_f32 v32, v32
    v_exp_f32 v73, v73
    v_exp_f32 v33, v33
    v_exp_f32 v74, v74
    v_exp_f32 v34, v34
    v_exp_f32 v75, v75
    v_exp_f32 v35, v35
    v_exp_f32 v76, v76
    v_exp_f32 v36, v36
    v_exp_f32 v77, v77
    v_exp_f32 v37, v37
    v_exp_f32 v78, v78
    v_exp_f32 v38, v38
    v_exp_f32 v79, v79
    v_exp_f32 v39, v39
    v_exp_f32 v80, v80
    v_exp_f32 v40, v40
    v_exp_f32 v81, v81
    v_exp_f32 v41, v41
    v_pk_add_f32 v[42:43], v[72:73], v[74:75]
    v_pk_add_f32 v[44:45], v[32:33], v[34:35]
    v_pk_add_f32 v[42:43], v[42:43], v[76:77]
    v_pk_add_f32 v[44:45], v[44:45], v[36:37]
    v_pk_add_f32 v[42:43], v[42:43], v[78:79]
    v_pk_add_f32 v[44:45], v[44:45], v[38:39]
    v_pk_add_f32 v[42:43], v[42:43], v[80:81]
    v_pk_add_f32 v[44:45], v[44:45], v[40:41]
    v_add_f32 v42, v42, v43
    v_add_f32 v44, v44, v45
    s_nop 1
    v_permlane32_swap_b32 v42, v44
    v_add_f32 v42, v42, v44
    v_rcp_f32 v42, v42
    s_nop 1
    s_branch L_q0Ab_sum
L_q1Ab_max:
    s_nop 7
    ds_read_b64 v[84:85], v8 offset:1536
    ds_read_b64 v[86:87], v8 offset:2048
    ds_read_b64 v[88:89], v8 offset:2560
    ds_read_b64 v[90:91], v5 offset:5120
    ds_read_b64 v[92:93], v5 offset:5128
    ds_read_b64 v[94:95], v6 offset:5120
    s_waitcnt lgkmcnt(0)
    v_mfma_f32_32x32x16_bf16 v[48:63], v[84:87], v[90:93], 0
    v_mfma_f32_32x32x8_bf16 v[48:63], v[88:89], v[94:95], v[48:63]
    s_nop 11
    v_max3_f32 v58, v48, v49, v50
    v_max3_f32 v60, -v48, -v49, -v50
    v_max3_f32 v58, v58, v51, v52
    v_max3_f32 v60, v60, -v51, -v52
    v_max3_f32 v58, v58, v53, v54
    v_max3_f32 v60, v60, -v53, -v54
    v_max3_f32 v58, v58, v55, v56
    v_max3_f32 v60, v60, -v55, -v56
    v_max_f32_e64 v58, v58, v57
    v_max_f32_e64 v60, v60, -v57
    s_nop 1
    v_permlane32_swap_b32 v58, v60
    v_max_f32 v58, v58, v60
    v_mul_f32 v60, 1.0, v58
    v_mul_f32 v58, 1.0, v58
    s_nop 1
    v_permlane32_swap_b32 v58, v60
    v_pk_fma_f32 v[84:85], v[48:49], 1.0, v[58:59] op_sel_hi:[1,0,0] neg_lo:[0,0,1] neg_hi:[0,0,1]
    v_pk_fma_f32 v[48:49], v[48:49], 1.0, v[60:61] op_sel_hi:[1,0,0] neg_lo:[1,0,1] neg_hi:[1,0,1]
    v_pk_fma_f32 v[86:87], v[50:51], 1.0, v[58:59] op_sel_hi:[1,0,0] neg_lo:[0,0,1] neg_hi:[0,0,1]
    v_pk_fma_f32 v[50:51], v[50:51], 1.0, v[60:61] op_sel_hi:[1,0,0] neg_lo:[1,0,1] neg_hi:[1,0,1]
    v_pk_fma_f32 v[88:89], v[52:53], 1.0, v[58:59] op_sel_hi:[1,0,0] neg_lo:[0,0,1] neg_hi:[0,0,1]
    v_pk_fma_f32 v[52:53], v[52:53], 1.0, v[60:61] op_sel_hi:[1,0,0] neg_lo:[1,0,1] neg_hi:[1,0,1]
    v_pk_fma_f32 v[90:91], v[54:55], 1.0, v[58:59] op_sel_hi:[1,0,0] neg_lo:[0,0,1] neg_hi:[0,0,1]
    v_pk_fma_f32 v[54:55], v[54:55], 1.0, v[60:61] op_sel_hi:[1,0,0] neg_lo:[1,0,1] neg_hi:[1,0,1]
    v_pk_fma_f32 v[92:93], v[56:57], 1.0, v[58:59] op_sel_hi:[1,0,0] neg_lo:[0,0,1] neg_hi:[0,0,1]
    v_pk_fma_f32 v[56:57], v[56:57], 1.0, v[60:61] op_sel_hi:[1,0,0] neg_lo:[1,0,1] neg_hi:[1,0,1]
    v_exp_f32 v84, v84
    v_exp_f32 v48, v48
    v_exp_f32 v85, v85
    v_exp_f32 v49, v49
    v_exp_f32 v86, v86
    v_exp_f32 v50, v50
    v_exp_f32 v87, v87
    v_exp_f32 v51, v51
    v_exp_f32 v88, v88
    v_exp_f32 v52, v52
    v_exp_f32 v89, v89
    v_exp_f32 v53, v53
    v_exp_f32 v90, v90
    v_exp_f32 v54, v54
    v_exp_f32 v91, v91
    v_exp_f32 v55, v55
    v_exp_f32 v92, v92
    v_exp_f32 v56, v56
    v_exp_f32 v93, v93
    v_exp_f32 v57, v57
    v_pk_add_f32 v[58:59], v[84:85], v[86:87]
    v_pk_add_f32 v[60:61], v[48:49], v[50:51]
    v_pk_add_f32 v[58:59], v[58:59], v[88:89]
    v_pk_add_f32 v[60:61], v[60:61], v[52:53]
    v_pk_add_f32 v[58:59], v[58:59], v[90:91]
    v_pk_add_f32 v[60:61], v[60:61], v[54:55]
    v_pk_add_f32 v[58:59], v[58:59], v[92:93]
    v_pk_add_f32 v[60:61], v[60:61], v[56:57]
    v_add_f32 v58, v58, v59
    v_add_f32 v60, v60, v61
    s_nop 1
    v_permlane32_swap_b32 v58, v60
    v_add_f32 v58, v58, v60
    v_rcp_f32 v58, v58
    s_nop 1
    s_branch L_q1Ab_sum
L_hsAb_slow:
    s_mov_b32 s67, 0
L_hsAb_again:
    s_sleep 8
    s_nop 7
    v_and_b32 v126, 31, v1
    v_lshlrev_b32 v126, 2, v126
    buffer_load_dword v124, v126, s[32:35], s68 offen offset:512 sc1
    s_waitcnt vmcnt(0)
    v_cmp_ne_u32 vcc, s57, v124
    s_add_u32 s67, s67, 1
    s_cmp_lt_u32 s67, 4
    s_nop 3
    s_cbranch_vccz L_hsAb_ok
    s_cbranch_scc1 L_hsAb_again
    s_mov_b32 s61, 1
    s_branch L_hsAb_ok
L_o1Ab_far:
    buffer_store_dwordx4 v[64:67], v7, s[36:39], s62 offen sc1
    buffer_store_dwordx4 v[68:71], v15, s[36:39], s62 offen sc1
    buffer_store_dwordx4 v[120:123], v13, s[36:39], s62 offen offset:1024 sc1
    s_branch L_o1Ab_st
L_s2Ab_far:
    s_mov_b64 exec, 1
    buffer_store_dword v116, off, s[32:35], s58 offset:1028 sc1
    s_mov_b64 exec, -1
    s_branch L_s2Ab_st
L_s3Ab_far:
    s_mov_b64 exec, 1
    buffer_store_dword v116, off, s[32:35], s58 offset:2052 sc1
    s_mov_b64 exec, -1
    s_branch L_s3Ab_st
L_hsBb_slow:
    s_mov_b32 s67, 0
L_hsBb_again:
    s_sleep 8
    s_nop 7
    v_and_b32 v126, 31, v1
    v_lshlrev_b32 v126, 2, v126
    buffer_load_dword v124, v126, s[32:35], s68 offen offset:512 sc1
    s_waitcnt vmcnt(0)
    v_cmp_ne_u32 vcc, s57, v124
    s_add_u32 s67, s67, 1
    s_cmp_lt_u32 s67, 4
    s_nop 3
    s_cbranch_vccz L_hsBb_ok
    s_cbranch_scc1 L_hsBb_again
    s_mov_b32 s61, 1
    s_branch L_hsBb_ok
L_o1Bb_far:
    buffer_store_dwordx4 v[64:67], v7, s[36:39], s62 offen sc1
    buffer_store_dwordx4 v[68:71], v15, s[36:39], s62 offen sc1
    buffer_store_dwordx4 v[120:123], v13, s[36:39], s62 offen offset:1024 sc1
    s_branch L_o1Bb_st
L_s2Bb_far:
    s_mov_b64 exec, 1
    buffer_store_dword v116, off, s[32:35], s58 offset:1028 sc1
    s_mov_b64 exec, -1
    s_branch L_s2Bb_st
L_s3Bb_far:
    s_mov_b64 exec, 1
    buffer_store_dword v116, off, s[32:35], s58 offset:2052 sc1
    s_mov_b64 exec, -1
    s_branch L_s3Bb_st
L_pfend:
L_end:
    s_endpgm
.set CODE_BYTES, L_pfend - L_pc
.section .rodata,"a"
.p2align 6
.amdhsa_kernel concat_heads__linear_kernel_hedgehog__linear_attn_block__prompt_kernel
  .amdhsa_next_free_vgpr 256
  .amdhsa_next_free_sgpr 102
  .amdhsa_accum_offset 128
  .amdhsa_group_segment_fixed_size 0
  .amdhsa_kernarg_size 80
  .amdhsa_user_sgpr_count 2
  .amdhsa_user_sgpr_kernarg_segment_ptr 1
  .amdhsa_system_sgpr_workgroup_id_x 1
.end_amdhsa_kernel
```
